```python
import torch

def _softmax(x, axis=-1):
    return torch.softmax(x, dim=axis)
def _gelu(x):
    return torch.nn.functional.gelu(x, approximate="tanh")
def _silu(x):
    return torch.nn.functional.silu(x)
def _sigmoid(x):
    return torch.sigmoid(x)
def _layernorm(x, axis=-1, eps=1e-5):
    m = x.mean(dim=axis, keepdim=True)
    v = x.var(dim=axis, keepdim=True, unbiased=False)
    return (x - m) / torch.sqrt(v + eps)
def _scatter_add(tgt, idx, src, axis=0):
    return tgt.clone().index_add_(axis, idx, src)
def _segment_sum(src, seg, n):
    out = torch.zeros((n,) + src.shape[1:], dtype=src.dtype)
    return out.index_add_(0, seg, src)
def _pad(x, pw):
    flat = tuple(v for pair in reversed(pw) for v in pair)
    return torch.nn.functional.pad(x, flat)

kernel_name = 'parallel_sum__spectral_gfnet__glu_gated_bilinear__prompt'

def setup_inputs():

    _w = (lambda a: (lambda t: t.to(torch.bfloat16) if t.is_floating_point() else t)(torch.as_tensor(a)))
    def _A_setup():
        B, S, D = 1, 2048, 448
        Df = D // 2 + 1
        return {
            "x": _w((lambda *s: torch.randn(*s, dtype=torch.bfloat16) * 0.05)(B, S, D)),
            "w_r": _w((lambda *s: torch.randn(*s, dtype=torch.bfloat16) * 0.4)(S, Df) * 0.02),
            "w_i": _w((lambda *s: torch.randn(*s, dtype=torch.bfloat16) * 0.4)(S, Df) * 0.02),
        }
    _A_in = _A_setup()

    def _B_setup():
        B, S, D, F = 1, 2048, 448, 1792
        return {
            "x": _w((lambda *s: torch.randn(*s, dtype=torch.bfloat16) * 0.05)(B, S, D)),
            "w_gate": _w((lambda *s: torch.randn(*s, dtype=torch.bfloat16) * 0.2)(D, F) * (D ** -0.5)),
            "w_up": _w((lambda *s: torch.randn(*s, dtype=torch.bfloat16) * 0.2)(D, F) * (D ** -0.5)),
            "w_down": _w((lambda *s: torch.randn(*s, dtype=torch.bfloat16) * 0.2)(F, D) * (F ** -0.5)),
        }
    _B_in = _B_setup()

    return {
        "A_x": _A_in["x"],
        "A_w_r": _A_in["w_r"],
        "A_w_i": _A_in["w_i"],
        "B_x": _B_in["x"],
        "B_w_gate": _B_in["w_gate"],
        "B_w_up": _B_in["w_up"],
        "B_w_down": _B_in["w_down"],
    }

def reference(A_x, A_w_r, A_w_i, B_x, B_w_gate, B_w_up, B_w_down):
    def _A_ref(x, w_r, w_i):
        B, S, D = x.shape
        X = (lambda x, axes=(-2,-1): torch.fft.rfft2(x.float(), dim=axes))(x, axes=(-2, -1))
        W = w_r + 1j * w_i
        X = X * W
        y = (lambda x, s, axes=(-2,-1): torch.fft.irfft2(x, s=s, dim=axes).to(torch.bfloat16))(X, (S, D), axes=(-2, -1))
        return y

    def _B_ref(x, w_gate, w_up, w_down):
        g = torch.einsum("bsd,df->bsf", x, w_gate)
        u = torch.einsum("bsd,df->bsf", x, w_up)
        h = g * u
        return torch.einsum("bsf,fd->bsd", h, w_down)

    x = A_x
    xn = _layernorm(x, axis=-1)
    return x + _A_ref(xn, A_w_r, A_w_i) + _B_ref(xn, B_w_gate, B_w_up, B_w_down)
```

```asm
; @launch kernel=f_kernel grid=(256,1,1) block=(512,1,1) lds=163840
.amdgcn_target "amdgcn-amd-amdhsa--gfx950"
.text
.globl f_kernel
.p2align 8
.type f_kernel,@function
f_kernel:
  s_cmp_ge_u32 s2, 256
  s_cbranch_scc1 f_end
  s_load_dwordx2 s[4:5], s[0:1], 0
  s_load_dwordx4 s[8:11], s[0:1], 32
  s_load_dwordx4 s[56:59], s[0:1], 64
  v_lshrrev_b32 v2, 6, v0
  v_and_b32 v254, 63, v0
  v_readfirstlane_b32 s17, v2
  s_and_b32 s12, s2, 7
  s_lshr_b32 s13, s2, 3
  v_and_b32 v3, 15, v0
  v_min_u32 v3, 13, v3
  v_lshlrev_b32 v3, 7, v3
  v_lshrrev_b32 v2, 4, v254
  s_mov_b32 s35, 0x20000
  s_movk_i32 s36, 1792
  s_lshr_b32 s14, s12, 1
  s_and_b32 s15, s12, 1
  s_and_b32 s18, s13, 3
  s_lshl_b32 s51, s14, 1
  s_lshr_b32 s16, s13, 2
  s_lshl4_add_u32 s42, s14, s18
  s_cmp_ge_u32 s17, 4
  s_cbranch_scc1 f_hi
  s_lshl2_add_u32 s3, s13, s14
  s_lshl1_add_u32 s3, s3, s17
  s_mul_i32 s3, s3, 7168
  s_lshl4_add_u32 s19, s51, s13
  s_lshl3_add_u32 s19, s19, s15
  s_mul_i32 s19, s19, s36
  s_mov_b32 s34, 1605632
  s_waitcnt lgkmcnt(0)
  s_bitcmp1_b32 s17, 0
  s_cselect_b64 s[32:33], s[10:11], s[8:9]
  s_cmp_lt_u32 s17, 2
  s_cselect_b64 s[32:33], s[4:5], s[32:33]
  s_cselect_b32 s3, s3, s19
  s_cselect_b32 s36, s36, 3584
  s_cselect_b32 s34, 1835008, s34
  v_mad_u32_u24 v4, v2, s36, v3
  s_cmp_ge_u32 s16, 6
  s_cbranch_scc1 f_lo
  buffer_load_dword v255, v4, s[32:35], s3 offen
  s_branch f_lo
f_hi:
  s_getpc_b64 s[32:33]
f_pc:
  s_add_u32 s30, s32, tabF@rel32@lo+4
  s_addc_u32 s31, s33, tabF@rel32@hi+12
  s_mov_b32 s34, code_end-f_pc
  s_and_b32 s3, s13, 7
  s_and_b32 s19, s13, 15
  s_lshl4_add_u32 s19, s15, s19
  s_cmp_eq_u32 s17, 5
  s_cselect_b64 s[32:33], s[30:31], s[32:33]
  s_cselect_b32 s3, s19, s3
  s_cselect_b32 s34, 229376, s34
  s_mul_i32 s3, s3, 7168
  v_mad_u32_u24 v4, v2, s36, v3
  s_sub_u32 s61, s2, 192
  s_cmp_ge_u32 s17, 6
  s_cbranch_scc1 f_nt
  s_cmp_ge_u32 s13, 16
  s_cbranch_scc1 f_nt
  buffer_load_dword v255, v4, s[32:35], s3 offen
f_nt:
  s_lshl3_add_u32 s3, s15, s16
  s_lshl_b32 s3, s3, 7
  s_add_u32 s3, s3, s42
  s_lshl2_add_u32 s3, s17, s3
  s_mul_i32 s3, s3, 896
  v_and_b32 v12, 31, v254
  v_mul_u32_u24 v12, 28, v12
  v_lshrrev_b32 v13, 5, v254
  v_mul_u32_u24 v13, 57344, v13
  v_add_u32 v12, v12, v13
  s_mov_b32 s34, 1835008
  s_sub_u32 s3, s3, 16*896
  s_mov_b32 s26, 0x10000000
  s_mov_b32 s27, 0x20000
  s_cmp_lg_u32 s17, 6
  s_cselect_b32 s61, -1, s61
  s_waitcnt lgkmcnt(0)
  s_mov_b64 s[32:33], s[4:5]
  s_mov_b64 s[24:25], s[58:59]
  s_cmp_ge_u32 s61, 54
  s_cbranch_scc1 f_nc
  s_mul_i32 s19, s61, 6144
  s_add_u32 s19, s19, 19922944
  v_lshlrev_b32 v4, 4, v254
  v_add_u32 v5, 4096, v4
  v_mov_b64 v[8:9], 0
  v_mov_b64 v[10:11], 0
  buffer_store_dwordx4 v[8:11], v4, s[24:27], s19 offen offset:0 sc1
  buffer_store_dwordx4 v[8:11], v4, s[24:27], s19 offen offset:1024 sc1
  buffer_store_dwordx4 v[8:11], v4, s[24:27], s19 offen offset:2048 sc1
  buffer_store_dwordx4 v[8:11], v4, s[24:27], s19 offen offset:3072 sc1
  buffer_store_dwordx4 v[8:11], v5, s[24:27], s19 offen offset:0 sc1
  buffer_store_dwordx4 v[8:11], v5, s[24:27], s19 offen offset:1024 sc1
f_nc:
  buffer_load_dwordx4 v[0:3], v12, s[32:35], s3 offen
  buffer_load_dwordx3 v[4:6], v12, s[32:35], s3 offen offset:16
  s_cbranch_scc1 f_comp
  s_mov_b64 s[32:33], s[56:57]
  s_movk_i32 s34, 256
  s_lshl_b32 s3, s61, 2
  v_mov_b32 v8, 1
  s_mov_b64 exec, 1
  s_waitcnt vmcnt(2)
  buffer_store_dword v8, v254, s[32:35], s3 offen sc1
  s_mov_b64 exec, -1
  s_branch f_comp
f_lo:
  s_mov_b64 s[6:7], s[58:59]
  s_lshl2_add_u32 s14, s18, s14
  s_and_b32 s40, s17, 3
  s_cmp_eq_u32 s16, 0
  s_cbranch_scc1 fh_A
  s_lshl2_add_u32 s44, s40, s42
  s_mul_i32 s44, s44, 896
  v_lshrrev_b32 v252, 3, v254
  v_mul_u32_u24 v18, 57344, v252
  v_lshrrev_b32 v252, 4, v254
  v_and_b32 v253, 7, v254
  v_xor_b32 v252, v252, v253
  v_lshlrev_b32 v252, 4, v252
  v_xor_b32 v253, 64, v252
  v_add_u32 v19, v18, v253
  v_add_u32 v18, v18, v252
  v_add_u32 v19, 457728, v19
  v_add_u32 v20, 915456, v18
  v_add_u32 v21, 915456, v19
  s_mov_b32 s20, s4
  s_mov_b32 s21, s5
  s_mov_b32 s22, 1835008
  s_mov_b32 s23, 0x20000
  s_add_u32 s49, s44, 896
  s_lshl_b32 s48, s51, 7
  s_add_u32 s48, s48, s44
  s_mov_b32 s36, 3584
  s_mul_i32 s37, s15, 7
  s_add_u32 s37, s37, s16
  s_sub_u32 s37, s37, 1
  s_lshl_b32 s37, s37, 8
  s_mov_b32 s24, s8
  s_mov_b32 s25, s9
  s_mov_b32 s26, 1605632
  s_mov_b32 s27, 0x20000
  s_mov_b32 s28, s10
  s_mov_b32 s29, s11
  s_mov_b32 s30, 1605632
  s_mov_b32 s31, 0x20000
  v_bfe_u32 v252, v254, 2, 2
  s_lshl_b32 s38, s40, 3
  v_add_u32 v252, s38, v252
  v_mul_u32_u24 v16, s36, v252
  v_lshrrev_b32 v252, 4, v254
  v_lshl_add_u32 v16, v252, 6, v16
  v_and_b32 v252, 3, v254
  v_lshl_add_u32 v16, v252, 4, v16
  v_add_u32 v16, s37, v16
  v_add_u32 v17, 12288, v16
  s_mov_b32 s38, 114688
  s_mul_i32 s39, s51, 229376
  s_mov_b32 s50, 1605632
  s_lshl_b32 s41, s40, 12
  s_add_u32 m0, s41, 98304
  s_nop 0
  buffer_load_dwordx4 v18, s[20:23], s48 offen offset:0 lds
  buffer_load_dwordx4 v19, s[20:23], s48 offen offset:1024 lds
  buffer_load_dwordx4 v20, s[20:23], s48 offen offset:2048 lds
  buffer_load_dwordx4 v21, s[20:23], s48 offen offset:3072 lds
  s_add_u32 s48, s48, 128
  s_cmp_eq_u32 s48, s49
  s_cselect_b32 s48, s44, s48
  s_add_u32 m0, s41, 0
  s_nop 0
  buffer_load_dwordx4 v16, s[24:27], s39 offen offset:0 lds
  buffer_load_dwordx4 v17, s[24:27], s39 offen offset:2048 lds
  s_add_u32 m0, s41, 1024
  s_nop 0
  buffer_load_dwordx4 v16, s[28:31], s39 offen offset:0 lds
  buffer_load_dwordx4 v17, s[28:31], s39 offen offset:2048 lds
  s_add_u32 s39, s39, s38
  s_cmp_eq_u32 s39, s50
  s_cselect_b32 s39, 0, s39
  s_add_u32 m0, s41, 16384
  s_nop 0
  buffer_load_dwordx4 v16, s[24:27], s39 offen offset:0 lds
  buffer_load_dwordx4 v17, s[24:27], s39 offen offset:2048 lds
  s_add_u32 m0, s41, 17408
  s_nop 0
  buffer_load_dwordx4 v16, s[28:31], s39 offen offset:0 lds
  buffer_load_dwordx4 v17, s[28:31], s39 offen offset:2048 lds
  s_add_u32 s39, s39, s38
  s_cmp_eq_u32 s39, s50
  s_cselect_b32 s39, 0, s39
  s_add_u32 m0, s41, 114688
  s_nop 0
  buffer_load_dwordx4 v18, s[20:23], s48 offen offset:0 lds
  buffer_load_dwordx4 v19, s[20:23], s48 offen offset:1024 lds
  buffer_load_dwordx4 v20, s[20:23], s48 offen offset:2048 lds
  buffer_load_dwordx4 v21, s[20:23], s48 offen offset:3072 lds
  s_add_u32 s48, s48, 128
  s_cmp_eq_u32 s48, s49
  s_cselect_b32 s48, s44, s48
  s_load_dwordx2 s[32:33], s[0:1], 48
  s_mov_b32 s34, 1605632
  s_mov_b32 s35, 0x20000
  s_mov_b32 s52, s6
  s_mov_b32 s53, s7
  s_mov_b32 s54, 0x10000000
  s_mov_b32 s55, 0x20000
  v_lshrrev_b32 v252, 5, v254
  v_bfe_u32 v253, v254, 2, 2
  v_lshl_add_u32 v252, v252, 2, v253
  v_mul_u32_u24 v22, 896, v252
  v_bfe_u32 v252, v254, 4, 1
  v_lshl_add_u32 v22, v252, 6, v22
  v_and_b32 v252, 3, v254
  v_lshl_add_u32 v22, v252, 4, v22
  v_add_u32 v23, 6144, v22
  v_add_u32 v24, 12288, v22
  v_add_u32 v25, 18432, v22
  s_mul_i32 s43, s15, 802816
  s_mul_i32 s36, s40, 28672
  s_add_u32 s43, s43, s36
  s_lshl_b32 s36, s16, 7
  s_add_u32 s43, s43, s36
  s_sub_u32 s43, s43, 128
  s_add_u32 s37, s43, 802816
  s_mul_i32 s36, s16, 114688
  s_add_u32 s36, s36, s43
  s_sub_u32 s36, s36, 114688
  s_mov_b32 s8, s36
  s_lshl_b32 s9, s18, 2
  s_lshr_b32 s9, 0x6431, s9
  s_and_b32 s9, s9, 15
  s_mul_i32 s9, s9, 114688
  v_lshlrev_b32 v250, 4, v254
  s_mul_i32 s60, s15, 7
  s_add_u32 s60, s60, s16
  s_lshl2_add_u32 s60, s60, s40
  s_lshl_b32 s60, s60, 12
  s_add_u32 s60, s60, 20008960
  s_lshl_b32 s61, s14, 6
  s_add_u32 s61, s61, s40
  s_lshl_b32 s61, s61, 5
  s_add_u32 s61, s61, 19992576
  v_bfe_u32 v26, v254, 1, 4
  v_lshlrev_b32 v26, 7, v26
  v_and_b32 v252, 1, v254
  v_lshl_add_u32 v26, v252, 4, v26
  s_lshl_b32 s3, s40, 10
  s_add_u32 s3, s3, 0
  v_add_u32 v28, s3, v250
  s_lshl_b32 s3, s40, 9
  s_add_u32 s3, s3, 4096
  v_and_b32 v252, 31, v254
  v_lshl_add_u32 v29, v252, 4, s3
  s_waitcnt vmcnt(8) lgkmcnt(0)
  s_barrier
  s_add_u32 m0, s41, 32768
  s_nop 0
  buffer_load_dwordx4 v16, s[24:27], s39 offen offset:0 lds
  buffer_load_dwordx4 v17, s[24:27], s39 offen offset:2048 lds
  s_add_u32 m0, s41, 33792
  s_nop 0
  buffer_load_dwordx4 v16, s[28:31], s39 offen offset:0 lds
  buffer_load_dwordx4 v17, s[28:31], s39 offen offset:2048 lds
  s_add_u32 s39, s39, s38
  s_cmp_eq_u32 s39, s50
  s_cselect_b32 s39, 0, s39
  s_add_u32 m0, s41, 49152
  s_nop 0
  buffer_load_dwordx4 v16, s[24:27], s39 offen offset:0 lds
  buffer_load_dwordx4 v17, s[24:27], s39 offen offset:2048 lds
  s_add_u32 m0, s41, 50176
  s_nop 0
  buffer_load_dwordx4 v16, s[28:31], s39 offen offset:0 lds
  buffer_load_dwordx4 v17, s[28:31], s39 offen offset:2048 lds
  s_add_u32 s39, s39, s38
  s_cmp_eq_u32 s39, s50
  s_cselect_b32 s39, 0, s39
  s_waitcnt vmcnt(12)
  s_barrier
  s_add_u32 m0, s41, 131072
  s_nop 0
  buffer_load_dwordx4 v18, s[20:23], s48 offen offset:0 lds
  buffer_load_dwordx4 v19, s[20:23], s48 offen offset:1024 lds
  buffer_load_dwordx4 v20, s[20:23], s48 offen offset:2048 lds
  buffer_load_dwordx4 v21, s[20:23], s48 offen offset:3072 lds
  s_add_u32 s48, s48, 128
  s_cmp_eq_u32 s48, s49
  s_cselect_b32 s48, s44, s48
  s_add_u32 m0, s41, 65536
  s_nop 0
  buffer_load_dwordx4 v16, s[24:27], s39 offen offset:0 lds
  buffer_load_dwordx4 v17, s[24:27], s39 offen offset:2048 lds
  s_add_u32 m0, s41, 66560
  s_nop 0
  buffer_load_dwordx4 v16, s[28:31], s39 offen offset:0 lds
  buffer_load_dwordx4 v17, s[28:31], s39 offen offset:2048 lds
  s_add_u32 s39, s39, s38
  s_cmp_eq_u32 s39, s50
  s_cselect_b32 s39, 0, s39
  s_waitcnt vmcnt(12)
  s_barrier
  s_add_u32 m0, s41, 81920
  s_nop 0
  buffer_load_dwordx4 v16, s[24:27], s39 offen offset:0 lds
  buffer_load_dwordx4 v17, s[24:27], s39 offen offset:2048 lds
  s_add_u32 m0, s41, 82944
  s_nop 0
  buffer_load_dwordx4 v16, s[28:31], s39 offen offset:0 lds
  buffer_load_dwordx4 v17, s[28:31], s39 offen offset:2048 lds
  s_add_u32 s39, s39, s38
  s_cmp_eq_u32 s39, s50
  s_cselect_b32 s39, 0, s39
  s_add_u32 m0, s41, 147456
  s_nop 0
  buffer_load_dwordx4 v18, s[20:23], s48 offen offset:0 lds
  buffer_load_dwordx4 v19, s[20:23], s48 offen offset:1024 lds
  buffer_load_dwordx4 v20, s[20:23], s48 offen offset:2048 lds
  buffer_load_dwordx4 v21, s[20:23], s48 offen offset:3072 lds
  s_add_u32 s48, s48, 128
  s_cmp_eq_u32 s48, s49
  s_cselect_b32 s48, s44, s48
  s_waitcnt vmcnt(16)
  s_barrier
  s_add_u32 m0, s41, 0
  s_nop 0
  buffer_load_dwordx4 v16, s[24:27], s39 offen offset:0 lds
  buffer_load_dwordx4 v17, s[24:27], s39 offen offset:2048 lds
  s_add_u32 m0, s41, 1024
  s_nop 0
  buffer_load_dwordx4 v16, s[28:31], s39 offen offset:0 lds
  buffer_load_dwordx4 v17, s[28:31], s39 offen offset:2048 lds
  s_add_u32 s39, s39, s38
  s_cmp_eq_u32 s39, s50
  s_cselect_b32 s39, 0, s39
  s_add_u32 m0, s41, 16384
  s_nop 0
  buffer_load_dwordx4 v16, s[24:27], s39 offen offset:0 lds
  buffer_load_dwordx4 v17, s[24:27], s39 offen offset:2048 lds
  s_add_u32 m0, s41, 17408
  s_nop 0
  buffer_load_dwordx4 v16, s[28:31], s39 offen offset:0 lds
  buffer_load_dwordx4 v17, s[28:31], s39 offen offset:2048 lds
  s_add_u32 s39, s39, s38
  s_cmp_eq_u32 s39, s50
  s_cselect_b32 s39, 0, s39
  s_waitcnt vmcnt(16)
  s_barrier
  s_add_u32 m0, s41, 32768
  s_nop 0
  buffer_load_dwordx4 v16, s[24:27], s39 offen offset:0 lds
  buffer_load_dwordx4 v17, s[24:27], s39 offen offset:2048 lds
  s_add_u32 m0, s41, 33792
  s_nop 0
  buffer_load_dwordx4 v16, s[28:31], s39 offen offset:0 lds
  buffer_load_dwordx4 v17, s[28:31], s39 offen offset:2048 lds
  s_add_u32 s39, s39, s38
  s_cmp_eq_u32 s39, s50
  s_cselect_b32 s39, 0, s39
  s_add_u32 m0, s41, 98304
  s_nop 0
  buffer_load_dwordx4 v18, s[20:23], s48 offen offset:0 lds
  buffer_load_dwordx4 v19, s[20:23], s48 offen offset:1024 lds
  buffer_load_dwordx4 v20, s[20:23], s48 offen offset:2048 lds
  buffer_load_dwordx4 v21, s[20:23], s48 offen offset:3072 lds
  s_add_u32 s48, s48, 128
  s_cmp_eq_u32 s48, s49
  s_cselect_b32 s48, s44, s48
  s_waitcnt vmcnt(20)
  s_barrier
  s_add_u32 m0, s41, 49152
  s_nop 0
  buffer_load_dwordx4 v16, s[24:27], s39 offen offset:0 lds
  buffer_load_dwordx4 v17, s[24:27], s39 offen offset:2048 lds
  s_add_u32 m0, s41, 50176
  s_nop 0
  buffer_load_dwordx4 v16, s[28:31], s39 offen offset:0 lds
  buffer_load_dwordx4 v17, s[28:31], s39 offen offset:2048 lds
  s_add_u32 s39, s39, s38
  s_cmp_eq_u32 s39, s50
  s_cselect_b32 s39, 0, s39
  s_add_u32 m0, s41, 65536
  s_nop 0
  buffer_load_dwordx4 v16, s[24:27], s39 offen offset:0 lds
  buffer_load_dwordx4 v17, s[24:27], s39 offen offset:2048 lds
  s_add_u32 m0, s41, 66560
  s_nop 0
  buffer_load_dwordx4 v16, s[28:31], s39 offen offset:0 lds
  buffer_load_dwordx4 v17, s[28:31], s39 offen offset:2048 lds
  s_add_u32 s39, s39, s38
  s_cmp_eq_u32 s39, s50
  s_cselect_b32 s39, 0, s39
  s_waitcnt vmcnt(20)
  s_barrier
  s_add_u32 m0, s41, 114688
  s_nop 0
  buffer_load_dwordx4 v18, s[20:23], s48 offen offset:0 lds
  buffer_load_dwordx4 v19, s[20:23], s48 offen offset:1024 lds
  buffer_load_dwordx4 v20, s[20:23], s48 offen offset:2048 lds
  buffer_load_dwordx4 v21, s[20:23], s48 offen offset:3072 lds
  s_add_u32 s48, s48, 128
  s_cmp_eq_u32 s48, s49
  s_cselect_b32 s48, s44, s48
  s_add_u32 m0, s41, 81920
  s_nop 0
  buffer_load_dwordx4 v16, s[24:27], s39 offen offset:0 lds
  buffer_load_dwordx4 v17, s[24:27], s39 offen offset:2048 lds
  s_add_u32 m0, s41, 82944
  s_nop 0
  buffer_load_dwordx4 v16, s[28:31], s39 offen offset:0 lds
  buffer_load_dwordx4 v17, s[28:31], s39 offen offset:2048 lds
  s_add_u32 s39, s39, s38
  s_cmp_eq_u32 s39, s50
  s_cselect_b32 s39, 0, s39
  s_waitcnt vmcnt(24)
  s_barrier
  s_add_u32 m0, s41, 0
  s_nop 0
  buffer_load_dwordx4 v16, s[24:27], s39 offen offset:0 lds
  buffer_load_dwordx4 v17, s[24:27], s39 offen offset:2048 lds
  s_add_u32 m0, s41, 1024
  s_nop 0
  buffer_load_dwordx4 v16, s[28:31], s39 offen offset:0 lds
  buffer_load_dwordx4 v17, s[28:31], s39 offen offset:2048 lds
  s_add_u32 s39, s39, s38
  s_cmp_eq_u32 s39, s50
  s_cselect_b32 s39, 0, s39
  s_add_u32 m0, s41, 131072
  s_nop 0
  buffer_load_dwordx4 v18, s[20:23], s48 offen offset:0 lds
  buffer_load_dwordx4 v19, s[20:23], s48 offen offset:1024 lds
  buffer_load_dwordx4 v20, s[20:23], s48 offen offset:2048 lds
  buffer_load_dwordx4 v21, s[20:23], s48 offen offset:3072 lds
  s_add_u32 s48, s48, 128
  s_cmp_eq_u32 s48, s49
  s_cselect_b32 s48, s44, s48
  s_waitcnt vmcnt(24)
  s_barrier
  s_add_u32 m0, s41, 16384
  s_nop 0
  buffer_load_dwordx4 v16, s[24:27], s39 offen offset:0 lds
  buffer_load_dwordx4 v17, s[24:27], s39 offen offset:2048 lds
  s_add_u32 m0, s41, 17408
  s_nop 0
  buffer_load_dwordx4 v16, s[28:31], s39 offen offset:0 lds
  buffer_load_dwordx4 v17, s[28:31], s39 offen offset:2048 lds
  s_add_u32 s39, s39, s38
  s_cmp_eq_u32 s39, s50
  s_cselect_b32 s39, 0, s39
  s_waitcnt vmcnt(24)
  s_barrier
  buffer_load_dwordx4 v[32:35], v250, s[52:55], s60 offen offset:0 sc1
  buffer_load_dwordx4 v[36:39], v250, s[52:55], s60 offen offset:1024 sc1
  buffer_load_dwordx4 v[40:43], v250, s[52:55], s60 offen offset:2048 sc1
  buffer_load_dwordx4 v[44:47], v250, s[52:55], s60 offen offset:3072 sc1
  buffer_load_dwordx4 v[48:51], v26, s[52:55], s61 offen sc1
  s_add_u32 m0, s41, 32768
  s_nop 0
  buffer_load_dwordx4 v22, s[32:35], s36 offen offset:0 lds
  buffer_load_dwordx4 v23, s[32:35], s36 offen offset:1024 lds
  buffer_load_dwordx4 v24, s[32:35], s36 offen offset:2048 lds
  buffer_load_dwordx4 v25, s[32:35], s36 offen offset:3072 lds
  s_add_u32 s36, s36, s9
  s_cmp_ge_u32 s36, s37
  s_cselect_b32 s3, 802816, 0
  s_sub_u32 s36, s36, s3
  s_add_u32 m0, s41, 147456
  s_nop 0
  buffer_load_dwordx4 v22, s[32:35], s36 offen offset:0 lds
  buffer_load_dwordx4 v23, s[32:35], s36 offen offset:1024 lds
  buffer_load_dwordx4 v24, s[32:35], s36 offen offset:2048 lds
  buffer_load_dwordx4 v25, s[32:35], s36 offen offset:3072 lds
  s_add_u32 s36, s36, 114688
  s_cmp_ge_u32 s36, s37
  s_cselect_b32 s3, 802816, 0
  s_sub_u32 s36, s36, s3
  s_cmp_eq_u32 s36, s8
  s_cselect_b32 s3, 114688, 0
  s_add_u32 s36, s36, s3
  s_cmp_ge_u32 s36, s37
  s_cselect_b32 s3, 802816, 0
  s_sub_u32 s36, s36, s3
  s_and_b32 s44, s40, 1
  s_lshr_b32 s45, s40, 1
  v_lshrrev_b32 v252, 5, v254
  v_lshlrev_b32 v244, 9, v252
  v_bfe_u32 v252, v254, 2, 2
  v_lshl_add_u32 v244, v252, 6, v244
  v_bfe_u32 v252, v254, 4, 1
  v_lshl_add_u32 v244, v252, 5, v244
  v_and_b32 v252, 1, v254
  v_lshl_add_u32 v244, v252, 4, v244
  v_bfe_u32 v252, v254, 1, 1
  v_lshl_add_u32 v244, v252, 3, v244
  s_mul_i32 s46, s45, 8448
  v_add_u32 v244, s46, v244
  v_xor_b32 v247, 256, v244
  v_add_u32 v245, 65536, v244
  v_add_u32 v246, 131072, v244
  v_add_u32 v248, 65536, v247
  v_add_u32 v249, 131072, v247
  v_lshlrev_b32 v250, 4, v254
  s_xor_b32 s46, s15, 0
  s_lshl1_add_u32 s46, s46, s44
  s_lshl2_add_u32 s49, s14, s46
  s_mul_i32 s48, s49, 114688
  s_mul_i32 s46, s15, 57344
  s_add_u32 s48, s48, s46
  s_lshl_b32 s46, s45, 12
  s_add_u32 s48, s48, s46
  s_add_u32 s47, s48, 57344
  s_lshl_b32 s46, s16, 13
  s_add_u32 s46, s46, s48
  s_sub_u32 s46, s46, 8192
  s_mov_b32 s48, s46
  s_lshl_b32 s50, s18, 2
  s_lshr_b32 s50, 0x6431, s50
  s_and_b32 s50, s50, 15
  s_mul_i32 s50, s50, 8192
  s_load_dwordx2 s[24:25], s[0:1], 56
  s_lshl1_add_u32 s28, s16, s45
  s_lshl_b32 s28, s28, 6
  s_sub_u32 s28, s28, 128
  s_lshr_b32 s29, s49, 4
  s_and_b32 s30, s49, 15
  s_lshl2_add_u32 s29, s30, s29
  v_and_b32 v252, 31, v254
  v_lshlrev_b32 v242, 6, v252
  v_add_u32 v242, s29, v242
  v_mul_u32_u24 v251, 896, v242
  v_lshrrev_b32 v243, 5, v254
  v_lshl_add_u32 v251, v243, 4, v251
  buffer_load_dwordx4 v[56:59], v251, s[20:23], s28 offen offset:0
  buffer_load_dwordx4 v[60:63], v251, s[20:23], s28 offen offset:32
  s_xor_b32 s56, s2, 1
  s_lshl_b32 s57, s56, 14
  s_lshl_b32 s58, s44, 13
  s_add_u32 s57, s57, s58
  s_lshl_b32 s58, s45, 11
  s_add_u32 s57, s57, s58
  s_add_u32 s57, s57, 14680064
  s_add_u32 s58, s57, 4096
  s_lshl_b32 s56, s56, 7
  s_lshl3_add_u32 s56, s44, s56
  s_add_u32 s56, s56, 19955712
  s_mov_b32 s26, 1835008
  s_mov_b32 s27, 0x20000
  s_waitcnt vmcnt(31)
  s_barrier
  s_add_u32 m0, s41, 49152
  s_nop 0
  buffer_load_dwordx4 v22, s[32:35], s36 offen offset:0 lds
  buffer_load_dwordx4 v23, s[32:35], s36 offen offset:1024 lds
  buffer_load_dwordx4 v24, s[32:35], s36 offen offset:2048 lds
  buffer_load_dwordx4 v25, s[32:35], s36 offen offset:3072 lds
  s_add_u32 s36, s36, 114688
  s_cmp_ge_u32 s36, s37
  s_cselect_b32 s3, 802816, 0
  s_sub_u32 s36, s36, s3
  s_cmp_eq_u32 s36, s8
  s_cselect_b32 s3, 114688, 0
  s_add_u32 s36, s36, s3
  s_cmp_ge_u32 s36, s37
  s_cselect_b32 s3, 802816, 0
  s_sub_u32 s36, s36, s3
  v_cvt_f32_u32 v252, v242
  v_mul_f32 v252, 0x3a000000, v252
  v_cvt_f32_u32 v253, v243
  v_add_f32 v253, v253, v253
  v_mul_f32 v253, v253, v252
  v_mov_b32 v64, 0x00000000
  v_fma_f32 v64, v64, v252, v253
  v_fract_f32 v64, v64
  v_mov_b32 v65, 0x3f800000
  v_fma_f32 v65, v65, v252, v253
  v_fract_f32 v65, v65
  v_mov_b32 v66, 0x40800000
  v_fma_f32 v66, v66, v252, v253
  v_fract_f32 v66, v66
  v_mov_b32 v67, 0x40a00000
  v_fma_f32 v67, v67, v252, v253
  v_fract_f32 v67, v67
  v_mov_b32 v68, 0x41000000
  v_fma_f32 v68, v68, v252, v253
  v_fract_f32 v68, v68
  v_mov_b32 v69, 0x41100000
  v_fma_f32 v69, v69, v252, v253
  v_fract_f32 v69, v69
  v_mov_b32 v70, 0x41400000
  v_fma_f32 v70, v70, v252, v253
  v_fract_f32 v70, v70
  v_mov_b32 v71, 0x41500000
  v_fma_f32 v71, v71, v252, v253
  v_fract_f32 v71, v71
  v_cos_f32 v72, v64
  v_sin_f32 v64, v64
  v_cos_f32 v73, v65
  v_sin_f32 v65, v65
  v_cos_f32 v74, v66
  v_sin_f32 v66, v66
  v_cos_f32 v75, v67
  v_sin_f32 v67, v67
  v_cos_f32 v76, v68
  v_sin_f32 v68, v68
  v_cos_f32 v77, v69
  v_sin_f32 v69, v69
  v_cos_f32 v78, v70
  v_sin_f32 v70, v70
  v_cos_f32 v79, v71
  v_sin_f32 v71, v71
  v_lshlrev_b32 v252, 31, v254
  v_or_b32 v252, 1.0, v252
  v_cmp_gt_u32 vcc, 32, v254
  s_nop 1
  v_cndmask_b32 v64, v64, v252, vcc
  v_cvt_pk_bf16_f32 v228, v72, v64
  v_cvt_pk_bf16_f32 v229, v73, v65
  v_cvt_pk_bf16_f32 v230, v74, v66
  v_cvt_pk_bf16_f32 v231, v75, v67
  v_cvt_pk_bf16_f32 v232, v76, v68
  v_cvt_pk_bf16_f32 v233, v77, v69
  v_cvt_pk_bf16_f32 v234, v78, v70
  v_cvt_pk_bf16_f32 v235, v79, v71
  s_waitcnt vmcnt(31)
  s_barrier
  s_add_u32 m0, s41, 65536
  s_nop 0
  buffer_load_dwordx4 v22, s[32:35], s36 offen offset:0 lds
  buffer_load_dwordx4 v23, s[32:35], s36 offen offset:1024 lds
  buffer_load_dwordx4 v24, s[32:35], s36 offen offset:2048 lds
  buffer_load_dwordx4 v25, s[32:35], s36 offen offset:3072 lds
  s_add_u32 s36, s36, 114688
  s_cmp_ge_u32 s36, s37
  s_cselect_b32 s3, 802816, 0
  s_sub_u32 s36, s36, s3
  s_cmp_eq_u32 s36, s8
  s_cselect_b32 s3, 114688, 0
  s_add_u32 s36, s36, s3
  s_cmp_ge_u32 s36, s37
  s_cselect_b32 s3, 802816, 0
  s_sub_u32 s36, s36, s3
  s_add_u32 m0, s41, 98304
  s_nop 0
  buffer_load_dwordx4 v22, s[32:35], s36 offen offset:0 lds
  buffer_load_dwordx4 v23, s[32:35], s36 offen offset:1024 lds
  buffer_load_dwordx4 v24, s[32:35], s36 offen offset:2048 lds
  buffer_load_dwordx4 v25, s[32:35], s36 offen offset:3072 lds
  s_add_u32 s36, s36, 114688
  s_cmp_ge_u32 s36, s37
  s_cselect_b32 s3, 802816, 0
  s_sub_u32 s36, s36, s3
  s_cmp_eq_u32 s36, s8
  s_cselect_b32 s3, 114688, 0
  s_add_u32 s36, s36, s3
  s_cmp_ge_u32 s36, s37
  s_cselect_b32 s3, 802816, 0
  s_sub_u32 s36, s36, s3
  s_lshr_b32 s96, s40, 1
  s_lshl1_add_u32 s96, s16, s96
  s_lshl_b32 s96, s96, 6
  s_add_u32 s96, s96, 321
  v_and_b32 v191, 19, v254
  v_and_b32 v252, 4, v254
  v_lshl_add_u32 v191, v252, 1, v191
  v_bfe_u32 v252, v254, 3, 1
  v_lshl_add_u32 v191, v252, 2, v191
  v_lshl_add_u32 v191, v191, 1, s96
  v_mov_b32 v192, v191
  v_subrev_u32 v252, 896, v192
  v_min_u32 v192, v192, v252
  v_add_u32 v193, v192, v192
  v_subrev_u32 v252, 896, v193
  v_min_u32 v193, v193, v252
  v_add_u32 v194, v193, v192
  v_subrev_u32 v252, 896, v194
  v_min_u32 v194, v194, v252
  v_add_u32 v191, v193, v193
  v_subrev_u32 v252, 896, v191
  v_min_u32 v191, v191, v252
  v_add_u32 v195, v191, v191
  v_subrev_u32 v252, 896, v195
  v_min_u32 v195, v195, v252
  v_cmp_gt_u32 vcc, 32, v254
  s_nop 1
  v_cndmask_b32 v191, v191, 0, vcc
  v_cvt_f32_u32 v191, v191
  v_cvt_f32_u32 v192, v192
  v_cvt_f32_u32 v193, v193
  v_cvt_f32_u32 v194, v194
  v_cvt_f32_u32 v195, v195
  v_mul_f32 v191, 0x3a924925, v191
  v_mul_f32 v192, 0x3a924925, v192
  v_mul_f32 v193, 0x3a924925, v193
  v_mul_f32 v194, 0x3a924925, v194
  v_mul_f32 v195, 0x3a924925, v195
  v_lshlrev_b32 v252, 31, v254
  v_or_b32 v252, 1.0, v252
  v_cndmask_b32 v144, 0, v252, vcc
  v_mov_b32 v145, 0
  v_mov_b64 v[146:147], 0
  v_and_b32 v252, 31, v254
  v_bfe_u32 v253, v254, 1, 3
  v_xor_b32 v253, v253, v243
  v_lshlrev_b32 v253, 4, v253
  v_lshl_add_u32 v236, v252, 7, v253
  s_lshl_b32 s59, s44, 12
  v_add_u32 v236, s59, v236
  v_xor_b32 v237, 32, v236
  v_xor_b32 v238, 64, v236
  v_xor_b32 v239, 96, v236
  v_lshlrev_b32 v240, 5, v252
  v_lshl_add_u32 v240, v243, 4, v240
  s_lshl_b32 s59, s44, 10
  v_add_u32 v240, s59, v240
  s_lshl_b32 s59, s40, 12
  s_add_u32 s59, s59, 147456
  v_add_u32 v241, s59, v250
  v_xor_b32 v242, 8192, v241
  v_and_b32 v243, 1, v254
  v_lshlrev_b32 v243, 2, v243
  s_waitcnt vmcnt(31)
  s_barrier
  s_add_u32 m0, s41, 81920
  s_nop 0
  buffer_load_dwordx4 v22, s[32:35], s36 offen offset:0 lds
  buffer_load_dwordx4 v23, s[32:35], s36 offen offset:1024 lds
  buffer_load_dwordx4 v24, s[32:35], s36 offen offset:2048 lds
  buffer_load_dwordx4 v25, s[32:35], s36 offen offset:3072 lds
  s_add_u32 s36, s36, 114688
  s_cmp_ge_u32 s36, s37
  s_cselect_b32 s3, 802816, 0
  s_sub_u32 s36, s36, s3
  s_cmp_eq_u32 s36, s8
  s_cselect_b32 s3, 114688, 0
  s_add_u32 s36, s36, s3
  s_cmp_ge_u32 s36, s37
  s_cselect_b32 s3, 802816, 0
  s_sub_u32 s36, s36, s3
  s_waitcnt vmcnt(26)
  s_mov_b32 s3, 0
fl_av:
  v_min_u32 v252, v51, v32
  v_min3_u32 v253, v33, v34, v35
  v_min3_u32 v252, v252, v36, v37
  v_min3_u32 v253, v253, v38, v39
  v_min3_u32 v252, v252, v40, v41
  v_min3_u32 v253, v253, v42, v43
  v_min3_u32 v252, v252, v44, v45
  v_min3_u32 v253, v253, v46, v47
  v_min_u32 v252, v252, v253
  v_cmp_eq_u32 vcc, 0, v252
  s_add_u32 s3, s3, 1
  s_cbranch_vccz fl_ak
  buffer_load_dwordx4 v[32:35], v250, s[52:55], s60 offen offset:0 sc1
  buffer_load_dwordx4 v[36:39], v250, s[52:55], s60 offen offset:1024 sc1
  buffer_load_dwordx4 v[40:43], v250, s[52:55], s60 offen offset:2048 sc1
  buffer_load_dwordx4 v[44:47], v250, s[52:55], s60 offen offset:3072 sc1
  buffer_load_dwordx4 v[48:51], v26, s[52:55], s61 offen sc1
  s_waitcnt vmcnt(0)
  s_cmp_lt_u32 s3, 200000
  s_cbranch_scc1 fl_av
fl_ak:
  v_add_f32 v32, v32, v40
  v_add_f32 v33, v33, v41
  v_add_f32 v34, v34, v42
  v_add_f32 v35, v35, v43
  v_add_f32 v36, v36, v44
  v_add_f32 v37, v37, v45
  v_add_f32 v38, v38, v46
  v_add_f32 v39, v39, v47
  v_add_f32 v32, v32, v36
  v_add_f32 v33, v33, v37
  v_add_f32 v34, v34, v38
  v_add_f32 v35, v35, v39
  v_add_f32 v32, v32, v34
  v_add_f32 v33, v33, v35
  v_add_f32 v32, v32, v33
  v_cmp_gt_u32 vcc, 32, v254
  v_and_b32 v33, 0xffff0000, v32
  v_sub_f32 v32, v32, v33
  v_and_b32 v34, 0xffff0000, v32
  v_sub_f32 v32, v32, v34
  v_cvt_pk_bf16_f32 v33, v33, v34
  v_cvt_pk_bf16_f32 v34, v32, 0
  v_cndmask_b32 v52, 0, v33, vcc
  v_cndmask_b32 v54, v33, 0, vcc
  v_cndmask_b32 v53, 0, v34, vcc
  v_cndmask_b32 v55, v34, 0, vcc
  s_waitcnt vmcnt(18)
  s_barrier
  ds_write_b128 v29, v[48:51]
  ds_write_b128 v28, v[52:55]
  s_add_u32 m0, s41, 114688
  s_nop 0
  buffer_load_dwordx4 v22, s[32:35], s36 offen offset:0 lds
  buffer_load_dwordx4 v23, s[32:35], s36 offen offset:1024 lds
  buffer_load_dwordx4 v24, s[32:35], s36 offen offset:2048 lds
  buffer_load_dwordx4 v25, s[32:35], s36 offen offset:3072 lds
  s_add_u32 s36, s36, 114688
  s_cmp_ge_u32 s36, s37
  s_cselect_b32 s3, 802816, 0
  s_sub_u32 s36, s36, s3
  s_cmp_eq_u32 s36, s8
  s_cselect_b32 s3, 114688, 0
  s_add_u32 s36, s36, s3
  s_cmp_ge_u32 s36, s37
  s_cselect_b32 s3, 802816, 0
  s_sub_u32 s36, s36, s3
  s_waitcnt lgkmcnt(0)
  s_barrier
  ds_read_b64_tr_b16 v[196:197], v244 offset:32768
  ds_read_b64_tr_b16 v[198:199], v244 offset:33792
  ds_read_b64_tr_b16 v[200:201], v247 offset:32768
  ds_read_b64_tr_b16 v[202:203], v247 offset:33792
  ds_read_b64_tr_b16 v[204:205], v244 offset:34816
  ds_read_b64_tr_b16 v[206:207], v244 offset:35840
  ds_read_b64_tr_b16 v[208:209], v247 offset:34816
  ds_read_b64_tr_b16 v[210:211], v247 offset:35840
  ds_read_b64_tr_b16 v[212:213], v244 offset:36864
  ds_read_b64_tr_b16 v[214:215], v244 offset:37888
  ds_read_b64_tr_b16 v[216:217], v247 offset:36864
  ds_read_b64_tr_b16 v[218:219], v247 offset:37888
  ds_read_b64_tr_b16 v[220:221], v244 offset:38912
  ds_read_b64_tr_b16 v[222:223], v244 offset:39936
  ds_read_b64_tr_b16 v[224:225], v247 offset:38912
  ds_read_b64_tr_b16 v[226:227], v247 offset:39936
  v_add_f32 v184, v191, v192
  v_add_f32 v185, v191, v193
  v_add_f32 v186, v191, v194
  v_cos_f32 v187, v191
  v_sin_f32 v252, v191
  v_cos_f32 v188, v184
  v_sin_f32 v184, v184
  v_cos_f32 v189, v185
  v_sin_f32 v185, v185
  v_cos_f32 v190, v186
  v_sin_f32 v186, v186
  v_add_f32 v191, v191, v195
  v_fract_f32 v191, v191
  v_cvt_pk_bf16_f32 v148, v187, v252
  v_cvt_pk_bf16_f32 v149, v188, v184
  v_cvt_pk_bf16_f32 v150, v189, v185
  v_cvt_pk_bf16_f32 v151, v190, v186
  v_add_f32 v184, v191, v192
  v_add_f32 v185, v191, v193
  v_add_f32 v186, v191, v194
  v_cos_f32 v187, v191
  v_sin_f32 v252, v191
  v_cos_f32 v188, v184
  v_sin_f32 v184, v184
  v_cos_f32 v189, v185
  v_sin_f32 v185, v185
  v_cos_f32 v190, v186
  v_sin_f32 v186, v186
  v_add_f32 v191, v191, v195
  v_fract_f32 v191, v191
  v_cvt_pk_bf16_f32 v152, v187, v252
  v_cvt_pk_bf16_f32 v153, v188, v184
  v_cvt_pk_bf16_f32 v154, v189, v185
  v_cvt_pk_bf16_f32 v155, v190, v186
  v_add_f32 v184, v191, v192
  v_add_f32 v185, v191, v193
  v_add_f32 v186, v191, v194
  v_cos_f32 v187, v191
  v_sin_f32 v252, v191
  v_cos_f32 v188, v184
  v_sin_f32 v184, v184
  v_cos_f32 v189, v185
  v_sin_f32 v185, v185
  v_cos_f32 v190, v186
  v_sin_f32 v186, v186
  v_add_f32 v191, v191, v195
  v_fract_f32 v191, v191
  v_cvt_pk_bf16_f32 v156, v187, v252
  v_cvt_pk_bf16_f32 v157, v188, v184
  v_cvt_pk_bf16_f32 v158, v189, v185
  v_cvt_pk_bf16_f32 v159, v190, v186
  v_add_f32 v184, v191, v192
  v_add_f32 v185, v191, v193
  v_add_f32 v186, v191, v194
  v_cos_f32 v187, v191
  v_sin_f32 v252, v191
  v_cos_f32 v188, v184
  v_sin_f32 v184, v184
  v_cos_f32 v189, v185
  v_sin_f32 v185, v185
  v_cos_f32 v190, v186
  v_sin_f32 v186, v186
  v_add_f32 v191, v191, v195
  v_fract_f32 v191, v191
  v_cvt_pk_bf16_f32 v160, v187, v252
  v_cvt_pk_bf16_f32 v161, v188, v184
  v_cvt_pk_bf16_f32 v162, v189, v185
  v_cvt_pk_bf16_f32 v163, v190, v186
  v_add_f32 v184, v191, v192
  v_add_f32 v185, v191, v193
  v_add_f32 v186, v191, v194
  v_cos_f32 v187, v191
  v_sin_f32 v252, v191
  v_cos_f32 v188, v184
  v_sin_f32 v184, v184
  v_cos_f32 v189, v185
  v_sin_f32 v185, v185
  v_cos_f32 v190, v186
  v_sin_f32 v186, v186
  v_add_f32 v191, v191, v195
  v_fract_f32 v191, v191
  v_cvt_pk_bf16_f32 v164, v187, v252
  v_cvt_pk_bf16_f32 v165, v188, v184
  v_cvt_pk_bf16_f32 v166, v189, v185
  v_cvt_pk_bf16_f32 v167, v190, v186
  v_add_f32 v184, v191, v192
  v_add_f32 v185, v191, v193
  v_add_f32 v186, v191, v194
  v_cos_f32 v187, v191
  v_sin_f32 v252, v191
  v_cos_f32 v188, v184
  v_sin_f32 v184, v184
  v_cos_f32 v189, v185
  v_sin_f32 v185, v185
  v_cos_f32 v190, v186
  v_sin_f32 v186, v186
  v_add_f32 v191, v191, v195
  v_fract_f32 v191, v191
  v_cvt_pk_bf16_f32 v168, v187, v252
  v_cvt_pk_bf16_f32 v169, v188, v184
  v_cvt_pk_bf16_f32 v170, v189, v185
  v_cvt_pk_bf16_f32 v171, v190, v186
  v_add_f32 v184, v191, v192
  v_add_f32 v185, v191, v193
  v_add_f32 v186, v191, v194
  v_cos_f32 v187, v191
  v_sin_f32 v252, v191
  v_cos_f32 v188, v184
  v_sin_f32 v184, v184
  v_cos_f32 v189, v185
  v_sin_f32 v185, v185
  v_cos_f32 v190, v186
  v_sin_f32 v186, v186
  v_add_f32 v191, v191, v195
  v_fract_f32 v191, v191
  v_cvt_pk_bf16_f32 v172, v187, v252
  v_cvt_pk_bf16_f32 v173, v188, v184
  v_cvt_pk_bf16_f32 v174, v189, v185
  v_cvt_pk_bf16_f32 v175, v190, v186
  v_add_f32 v184, v191, v192
  v_add_f32 v185, v191, v193
  v_add_f32 v186, v191, v194
  v_cos_f32 v187, v191
  v_sin_f32 v252, v191
  v_cos_f32 v188, v184
  v_sin_f32 v184, v184
  v_cos_f32 v189, v185
  v_sin_f32 v185, v185
  v_cos_f32 v190, v186
  v_sin_f32 v186, v186
  v_add_f32 v191, v191, v195
  v_fract_f32 v191, v191
  v_cvt_pk_bf16_f32 v176, v187, v252
  v_cvt_pk_bf16_f32 v177, v188, v184
  v_cvt_pk_bf16_f32 v178, v189, v185
  v_cvt_pk_bf16_f32 v179, v190, v186
  v_add_f32 v184, v191, v192
  v_add_f32 v185, v191, v193
  v_add_f32 v186, v191, v194
  v_cos_f32 v187, v191
  v_sin_f32 v252, v191
  v_cos_f32 v188, v184
  v_sin_f32 v184, v184
  v_cos_f32 v189, v185
  v_sin_f32 v185, v185
  v_cos_f32 v190, v186
  v_sin_f32 v186, v186
  v_add_f32 v191, v191, v195
  v_fract_f32 v191, v191
  v_cvt_pk_bf16_f32 v180, v187, v252
  v_cvt_pk_bf16_f32 v181, v188, v184
  v_cvt_pk_bf16_f32 v182, v189, v185
  v_cvt_pk_bf16_f32 v183, v190, v186
  s_waitcnt vmcnt(0) lgkmcnt(0)
  v_lshlrev_b32 v0, 16, v56
  v_and_b32 v1, 0xffff0000, v56
  v_lshlrev_b32 v2, 16, v57
  v_and_b32 v3, 0xffff0000, v57
  v_lshlrev_b32 v4, 16, v58
  v_and_b32 v5, 0xffff0000, v58
  v_lshlrev_b32 v6, 16, v59
  v_and_b32 v7, 0xffff0000, v59
  v_lshlrev_b32 v8, 16, v60
  v_and_b32 v9, 0xffff0000, v60
  v_lshlrev_b32 v10, 16, v61
  v_and_b32 v11, 0xffff0000, v61
  v_lshlrev_b32 v12, 16, v62
  v_and_b32 v13, 0xffff0000, v62
  v_lshlrev_b32 v14, 16, v63
  v_and_b32 v15, 0xffff0000, v63
  s_barrier
  buffer_load_dwordx4 v[32:35], v250, s[52:55], s46 offen offset:0 sc1
  buffer_load_dwordx4 v[36:39], v250, s[52:55], s46 offen offset:1024 sc1
  buffer_load_dwordx4 v[40:43], v250, s[52:55], s46 offen offset:2048 sc1
  buffer_load_dwordx4 v[44:47], v250, s[52:55], s46 offen offset:3072 sc1
  s_add_u32 s46, s46, s50
  s_cmp_ge_u32 s46, s47
  s_cselect_b32 s3, 57344, 0
  s_sub_u32 s46, s46, s3
  s_waitcnt vmcnt(3)
  v_mfma_f32_32x32x16_bf16 v[0:15], v[196:199], v[32:35], v[0:15]
  v_mfma_f32_32x32x16_bf16 v[16:31], v[200:203], v[32:35], 0
  s_waitcnt vmcnt(2)
  v_mfma_f32_32x32x16_bf16 v[0:15], v[204:207], v[36:39], v[0:15]
  ds_read_b64_tr_b16 v[196:197], v246 offset:16384
  ds_read_b64_tr_b16 v[198:199], v246 offset:17408
  v_mfma_f32_32x32x16_bf16 v[16:31], v[208:211], v[36:39], v[16:31]
  ds_read_b64_tr_b16 v[200:201], v249 offset:16384
  ds_read_b64_tr_b16 v[202:203], v249 offset:17408
  s_waitcnt vmcnt(1)
  v_mfma_f32_32x32x16_bf16 v[0:15], v[212:215], v[40:43], v[0:15]
  ds_read_b64_tr_b16 v[204:205], v246 offset:18432
  ds_read_b64_tr_b16 v[206:207], v246 offset:19456
  v_mfma_f32_32x32x16_bf16 v[16:31], v[216:219], v[40:43], v[16:31]
  ds_read_b64_tr_b16 v[208:209], v249 offset:18432
  ds_read_b64_tr_b16 v[210:211], v249 offset:19456
  s_waitcnt vmcnt(0)
  v_mfma_f32_32x32x16_bf16 v[0:15], v[220:223], v[44:47], v[0:15]
  ds_read_b64_tr_b16 v[212:213], v246 offset:20480
  ds_read_b64_tr_b16 v[214:215], v246 offset:21504
  v_mfma_f32_32x32x16_bf16 v[16:31], v[224:227], v[44:47], v[16:31]
  ds_read_b64_tr_b16 v[216:217], v249 offset:20480
  ds_read_b64_tr_b16 v[218:219], v249 offset:21504
  v_add_f32 v184, v191, v192
  v_add_f32 v185, v191, v193
  v_add_f32 v186, v191, v194
  v_cos_f32 v187, v191
  v_sin_f32 v252, v191
  v_cos_f32 v188, v184
  v_sin_f32 v184, v184
  v_cos_f32 v189, v185
  v_sin_f32 v185, v185
  v_cos_f32 v190, v186
  v_sin_f32 v186, v186
  v_add_f32 v191, v191, v195
  v_fract_f32 v191, v191
  v_cvt_pk_bf16_f32 v32, v187, v252
  v_cvt_pk_bf16_f32 v33, v188, v184
  v_cvt_pk_bf16_f32 v34, v189, v185
  v_cvt_pk_bf16_f32 v35, v190, v186
  v_add_f32 v184, v191, v192
  v_add_f32 v185, v191, v193
  v_add_f32 v186, v191, v194
  v_cos_f32 v187, v191
  v_sin_f32 v252, v191
  v_cos_f32 v188, v184
  v_sin_f32 v184, v184
  v_cos_f32 v189, v185
  v_sin_f32 v185, v185
  v_cos_f32 v190, v186
  v_sin_f32 v186, v186
  v_add_f32 v191, v191, v195
  v_fract_f32 v191, v191
  v_cvt_pk_bf16_f32 v36, v187, v252
  v_cvt_pk_bf16_f32 v37, v188, v184
  v_cvt_pk_bf16_f32 v38, v189, v185
  v_cvt_pk_bf16_f32 v39, v190, v186
  v_add_f32 v184, v191, v192
  v_add_f32 v185, v191, v193
  v_add_f32 v186, v191, v194
  v_cos_f32 v187, v191
  v_sin_f32 v252, v191
  v_cos_f32 v188, v184
  v_sin_f32 v184, v184
  v_cos_f32 v189, v185
  v_sin_f32 v185, v185
  v_cos_f32 v190, v186
  v_sin_f32 v186, v186
  v_add_f32 v191, v191, v195
  v_fract_f32 v191, v191
  v_cvt_pk_bf16_f32 v40, v187, v252
  v_cvt_pk_bf16_f32 v41, v188, v184
  v_cvt_pk_bf16_f32 v42, v189, v185
  v_cvt_pk_bf16_f32 v43, v190, v186
  v_add_f32 v184, v191, v192
  v_add_f32 v185, v191, v193
  v_add_f32 v186, v191, v194
  v_cos_f32 v187, v191
  v_sin_f32 v252, v191
  v_cos_f32 v188, v184
  v_sin_f32 v184, v184
  v_cos_f32 v189, v185
  v_sin_f32 v185, v185
  v_cos_f32 v190, v186
  v_sin_f32 v186, v186
  v_add_f32 v191, v191, v195
  v_fract_f32 v191, v191
  v_cvt_pk_bf16_f32 v44, v187, v252
  v_cvt_pk_bf16_f32 v45, v188, v184
  v_cvt_pk_bf16_f32 v46, v189, v185
  v_cvt_pk_bf16_f32 v47, v190, v186
  s_barrier
  buffer_load_dwordx4 v[48:51], v250, s[52:55], s46 offen offset:0 sc1
  buffer_load_dwordx4 v[52:55], v250, s[52:55], s46 offen offset:1024 sc1
  buffer_load_dwordx4 v[56:59], v250, s[52:55], s46 offen offset:2048 sc1
  buffer_load_dwordx4 v[60:63], v250, s[52:55], s46 offen offset:3072 sc1
  s_add_u32 s46, s46, 8192
  s_cmp_ge_u32 s46, s47
  s_cselect_b32 s3, 57344, 0
  s_sub_u32 s46, s46, s3
  s_cmp_eq_u32 s46, s48
  s_cselect_b32 s3, 8192, 0
  s_add_u32 s46, s46, s3
  s_cmp_ge_u32 s46, s47
  s_cselect_b32 s3, 57344, 0
  s_sub_u32 s46, s46, s3
  buffer_load_dwordx4 v[64:67], v250, s[52:55], s46 offen offset:0 sc1
  buffer_load_dwordx4 v[68:71], v250, s[52:55], s46 offen offset:1024 sc1
  buffer_load_dwordx4 v[72:75], v250, s[52:55], s46 offen offset:2048 sc1
  buffer_load_dwordx4 v[76:79], v250, s[52:55], s46 offen offset:3072 sc1
  s_add_u32 s46, s46, 8192
  s_cmp_ge_u32 s46, s47
  s_cselect_b32 s3, 57344, 0
  s_sub_u32 s46, s46, s3
  s_cmp_eq_u32 s46, s48
  s_cselect_b32 s3, 8192, 0
  s_add_u32 s46, s46, s3
  s_cmp_ge_u32 s46, s47
  s_cselect_b32 s3, 57344, 0
  s_sub_u32 s46, s46, s3
  buffer_load_dwordx4 v[80:83], v250, s[52:55], s46 offen offset:0 sc1
  buffer_load_dwordx4 v[84:87], v250, s[52:55], s46 offen offset:1024 sc1
  buffer_load_dwordx4 v[88:91], v250, s[52:55], s46 offen offset:2048 sc1
  buffer_load_dwordx4 v[92:95], v250, s[52:55], s46 offen offset:3072 sc1
  s_add_u32 s46, s46, 8192
  s_cmp_ge_u32 s46, s47
  s_cselect_b32 s3, 57344, 0
  s_sub_u32 s46, s46, s3
  s_cmp_eq_u32 s46, s48
  s_cselect_b32 s3, 8192, 0
  s_add_u32 s46, s46, s3
  s_cmp_ge_u32 s46, s47
  s_cselect_b32 s3, 57344, 0
  s_sub_u32 s46, s46, s3
  s_waitcnt vmcnt(11) lgkmcnt(8)
  v_mfma_f32_32x32x16_bf16 v[0:15], v[196:199], v[48:51], v[0:15]
  ds_read_b64_tr_b16 v[220:221], v246 offset:22528
  ds_read_b64_tr_b16 v[222:223], v246 offset:23552
  v_add_f32 v184, v191, v192
  v_add_f32 v185, v191, v193
  v_add_f32 v186, v191, v194
  v_cos_f32 v187, v191
  v_sin_f32 v252, v191
  v_cos_f32 v188, v184
  v_sin_f32 v184, v184
  v_mfma_f32_32x32x16_bf16 v[16:31], v[200:203], v[48:51], v[16:31]
  ds_read_b64_tr_b16 v[224:225], v249 offset:22528
  ds_read_b64_tr_b16 v[226:227], v249 offset:23552
  buffer_load_dwordx4 v[96:99], v250, s[52:55], s46 offen offset:0 sc1
  buffer_load_dwordx4 v[100:103], v250, s[52:55], s46 offen offset:1024 sc1
  v_cos_f32 v189, v185
  v_sin_f32 v185, v185
  v_cos_f32 v190, v186
  v_sin_f32 v186, v186
  v_add_f32 v191, v191, v195
  v_fract_f32 v191, v191
  v_cvt_pk_bf16_f32 v48, v187, v252
  v_cvt_pk_bf16_f32 v49, v188, v184
  v_cvt_pk_bf16_f32 v50, v189, v185
  v_cvt_pk_bf16_f32 v51, v190, v186
  s_waitcnt vmcnt(12) lgkmcnt(8)
  v_mfma_f32_32x32x16_bf16 v[0:15], v[204:207], v[52:55], v[0:15]
  ds_read_b64_tr_b16 v[196:197], v244 offset:49152
  ds_read_b64_tr_b16 v[198:199], v244 offset:50176
  v_add_f32 v184, v191, v192
  v_add_f32 v185, v191, v193
  v_add_f32 v186, v191, v194
  v_cos_f32 v187, v191
  v_sin_f32 v252, v191
  v_cos_f32 v188, v184
  v_sin_f32 v184, v184
  v_mfma_f32_32x32x16_bf16 v[16:31], v[208:211], v[52:55], v[16:31]
  ds_read_b64_tr_b16 v[200:201], v247 offset:49152
  ds_read_b64_tr_b16 v[202:203], v247 offset:50176
  buffer_load_dwordx4 v[104:107], v250, s[52:55], s46 offen offset:2048 sc1
  buffer_load_dwordx4 v[108:111], v250, s[52:55], s46 offen offset:3072 sc1
  s_add_u32 s46, s46, 8192
  s_cmp_ge_u32 s46, s47
  s_cselect_b32 s3, 57344, 0
  s_sub_u32 s46, s46, s3
  s_cmp_eq_u32 s46, s48
  s_cselect_b32 s3, 8192, 0
  s_add_u32 s46, s46, s3
  s_cmp_ge_u32 s46, s47
  s_cselect_b32 s3, 57344, 0
  s_sub_u32 s46, s46, s3
  v_cos_f32 v189, v185
  v_sin_f32 v185, v185
  v_cos_f32 v190, v186
  v_sin_f32 v186, v186
  v_add_f32 v191, v191, v195
  v_fract_f32 v191, v191
  v_cvt_pk_bf16_f32 v52, v187, v252
  v_cvt_pk_bf16_f32 v53, v188, v184
  v_cvt_pk_bf16_f32 v54, v189, v185
  v_cvt_pk_bf16_f32 v55, v190, v186
  s_waitcnt vmcnt(13) lgkmcnt(8)
  v_mfma_f32_32x32x16_bf16 v[0:15], v[212:215], v[56:59], v[0:15]
  ds_read_b64_tr_b16 v[204:205], v244 offset:51200
  ds_read_b64_tr_b16 v[206:207], v244 offset:52224
  v_add_f32 v184, v191, v192
  v_add_f32 v185, v191, v193
  v_add_f32 v186, v191, v194
  v_cos_f32 v187, v191
  v_sin_f32 v252, v191
  v_cos_f32 v188, v184
  v_sin_f32 v184, v184
  v_mfma_f32_32x32x16_bf16 v[16:31], v[216:219], v[56:59], v[16:31]
  ds_read_b64_tr_b16 v[208:209], v247 offset:51200
  ds_read_b64_tr_b16 v[210:211], v247 offset:52224
  buffer_load_dwordx4 v[112:115], v250, s[52:55], s46 offen offset:0 sc1
  buffer_load_dwordx4 v[116:119], v250, s[52:55], s46 offen offset:1024 sc1
  v_cos_f32 v189, v185
  v_sin_f32 v185, v185
  v_cos_f32 v190, v186
  v_sin_f32 v186, v186
  v_add_f32 v191, v191, v195
  v_fract_f32 v191, v191
  v_cvt_pk_bf16_f32 v56, v187, v252
  v_cvt_pk_bf16_f32 v57, v188, v184
  v_cvt_pk_bf16_f32 v58, v189, v185
  v_cvt_pk_bf16_f32 v59, v190, v186
  s_waitcnt vmcnt(14) lgkmcnt(8)
  v_mfma_f32_32x32x16_bf16 v[0:15], v[220:223], v[60:63], v[0:15]
  ds_read_b64_tr_b16 v[212:213], v244 offset:53248
  ds_read_b64_tr_b16 v[214:215], v244 offset:54272
  v_add_f32 v184, v191, v192
  v_add_f32 v185, v191, v193
  v_add_f32 v186, v191, v194
  v_cos_f32 v187, v191
  v_sin_f32 v252, v191
  v_cos_f32 v188, v184
  v_sin_f32 v184, v184
  v_mfma_f32_32x32x16_bf16 v[16:31], v[224:227], v[60:63], v[16:31]
  ds_read_b64_tr_b16 v[216:217], v247 offset:53248
  ds_read_b64_tr_b16 v[218:219], v247 offset:54272
  buffer_load_dwordx4 v[120:123], v250, s[52:55], s46 offen offset:2048 sc1
  buffer_load_dwordx4 v[124:127], v250, s[52:55], s46 offen offset:3072 sc1
  s_add_u32 s46, s46, 8192
  s_cmp_ge_u32 s46, s47
  s_cselect_b32 s3, 57344, 0
  s_sub_u32 s46, s46, s3
  s_cmp_eq_u32 s46, s48
  s_cselect_b32 s3, 8192, 0
  s_add_u32 s46, s46, s3
  s_cmp_ge_u32 s46, s47
  s_cselect_b32 s3, 57344, 0
  s_sub_u32 s46, s46, s3
  v_cos_f32 v189, v185
  v_sin_f32 v185, v185
  v_cos_f32 v190, v186
  v_sin_f32 v186, v186
  v_add_f32 v191, v191, v195
  v_fract_f32 v191, v191
  v_cvt_pk_bf16_f32 v60, v187, v252
  v_cvt_pk_bf16_f32 v61, v188, v184
  v_cvt_pk_bf16_f32 v62, v189, v185
  v_cvt_pk_bf16_f32 v63, v190, v186
  s_waitcnt vmcnt(15) lgkmcnt(8)
  v_mfma_f32_32x32x16_bf16 v[0:15], v[196:199], v[64:67], v[0:15]
  ds_read_b64_tr_b16 v[220:221], v244 offset:55296
  ds_read_b64_tr_b16 v[222:223], v244 offset:56320
  v_add_f32 v184, v191, v192
  v_add_f32 v185, v191, v193
  v_add_f32 v186, v191, v194
  v_cos_f32 v187, v191
  v_sin_f32 v252, v191
  v_cos_f32 v188, v184
  v_sin_f32 v184, v184
  v_mfma_f32_32x32x16_bf16 v[16:31], v[200:203], v[64:67], v[16:31]
  ds_read_b64_tr_b16 v[224:225], v247 offset:55296
  ds_read_b64_tr_b16 v[226:227], v247 offset:56320
  buffer_load_dwordx4 v[128:131], v250, s[52:55], s46 offen offset:0 sc1
  buffer_load_dwordx4 v[132:135], v250, s[52:55], s46 offen offset:1024 sc1
  v_cos_f32 v189, v185
  v_sin_f32 v185, v185
  v_cos_f32 v190, v186
  v_sin_f32 v186, v186
  v_add_f32 v191, v191, v195
  v_fract_f32 v191, v191
  v_cvt_pk_bf16_f32 v64, v187, v252
  v_cvt_pk_bf16_f32 v65, v188, v184
  v_cvt_pk_bf16_f32 v66, v189, v185
  v_cvt_pk_bf16_f32 v67, v190, v186
  s_waitcnt vmcnt(16) lgkmcnt(8)
  v_mfma_f32_32x32x16_bf16 v[0:15], v[204:207], v[68:71], v[0:15]
  ds_read_b64_tr_b16 v[196:197], v245 offset:0
  ds_read_b64_tr_b16 v[198:199], v245 offset:1024
  v_add_f32 v184, v191, v192
  v_add_f32 v185, v191, v193
  v_add_f32 v186, v191, v194
  v_cos_f32 v187, v191
  v_sin_f32 v252, v191
  v_cos_f32 v188, v184
  v_sin_f32 v184, v184
  v_mfma_f32_32x32x16_bf16 v[16:31], v[208:211], v[68:71], v[16:31]
  ds_read_b64_tr_b16 v[200:201], v248 offset:0
  ds_read_b64_tr_b16 v[202:203], v248 offset:1024
  buffer_load_dwordx4 v[136:139], v250, s[52:55], s46 offen offset:2048 sc1
  buffer_load_dwordx4 v[140:143], v250, s[52:55], s46 offen offset:3072 sc1
  v_cos_f32 v189, v185
  v_sin_f32 v185, v185
  v_cos_f32 v190, v186
  v_sin_f32 v186, v186
  v_add_f32 v191, v191, v195
  v_fract_f32 v191, v191
  v_cvt_pk_bf16_f32 v68, v187, v252
  v_cvt_pk_bf16_f32 v69, v188, v184
  v_cvt_pk_bf16_f32 v70, v189, v185
  v_cvt_pk_bf16_f32 v71, v190, v186
  s_waitcnt vmcnt(17) lgkmcnt(8)
  v_mfma_f32_32x32x16_bf16 v[0:15], v[212:215], v[72:75], v[0:15]
  ds_read_b64_tr_b16 v[204:205], v245 offset:2048
  ds_read_b64_tr_b16 v[206:207], v245 offset:3072
  v_add_f32 v184, v191, v192
  v_add_f32 v185, v191, v193
  v_add_f32 v186, v191, v194
  v_cos_f32 v187, v191
  v_sin_f32 v252, v191
  v_cos_f32 v188, v184
  v_sin_f32 v184, v184
  v_mfma_f32_32x32x16_bf16 v[16:31], v[216:219], v[72:75], v[16:31]
  ds_read_b64_tr_b16 v[208:209], v248 offset:2048
  ds_read_b64_tr_b16 v[210:211], v248 offset:3072
  v_cos_f32 v189, v185
  v_sin_f32 v185, v185
  v_cos_f32 v190, v186
  v_sin_f32 v186, v186
  v_add_f32 v191, v191, v195
  v_fract_f32 v191, v191
  v_cvt_pk_bf16_f32 v72, v187, v252
  v_cvt_pk_bf16_f32 v73, v188, v184
  v_cvt_pk_bf16_f32 v74, v189, v185
  v_cvt_pk_bf16_f32 v75, v190, v186
  s_waitcnt vmcnt(16) lgkmcnt(8)
  v_mfma_f32_32x32x16_bf16 v[0:15], v[220:223], v[76:79], v[0:15]
  ds_read_b64_tr_b16 v[212:213], v245 offset:4096
  ds_read_b64_tr_b16 v[214:215], v245 offset:5120
  v_add_f32 v184, v191, v192
  v_add_f32 v185, v191, v193
  v_add_f32 v186, v191, v194
  v_cos_f32 v187, v191
  v_sin_f32 v252, v191
  v_cos_f32 v188, v184
  v_sin_f32 v184, v184
  v_mfma_f32_32x32x16_bf16 v[16:31], v[224:227], v[76:79], v[16:31]
  ds_read_b64_tr_b16 v[216:217], v248 offset:4096
  ds_read_b64_tr_b16 v[218:219], v248 offset:5120
  v_cos_f32 v189, v185
  v_sin_f32 v185, v185
  v_cos_f32 v190, v186
  v_sin_f32 v186, v186
  v_add_f32 v191, v191, v195
  v_fract_f32 v191, v191
  v_cvt_pk_bf16_f32 v76, v187, v252
  v_cvt_pk_bf16_f32 v77, v188, v184
  v_cvt_pk_bf16_f32 v78, v189, v185
  v_cvt_pk_bf16_f32 v79, v190, v186
  s_waitcnt vmcnt(15) lgkmcnt(8)
  v_mfma_f32_32x32x16_bf16 v[0:15], v[196:199], v[80:83], v[0:15]
  ds_read_b64_tr_b16 v[220:221], v245 offset:6144
  ds_read_b64_tr_b16 v[222:223], v245 offset:7168
  v_add_f32 v184, v191, v192
  v_add_f32 v185, v191, v193
  v_add_f32 v186, v191, v194
  v_cos_f32 v187, v191
  v_sin_f32 v252, v191
  v_cos_f32 v188, v184
  v_sin_f32 v184, v184
  v_mfma_f32_32x32x16_bf16 v[16:31], v[200:203], v[80:83], v[16:31]
  ds_read_b64_tr_b16 v[224:225], v248 offset:6144
  ds_read_b64_tr_b16 v[226:227], v248 offset:7168
  v_cos_f32 v189, v185
  v_sin_f32 v185, v185
  v_cos_f32 v190, v186
  v_sin_f32 v186, v186
  v_add_f32 v191, v191, v195
  v_fract_f32 v191, v191
  v_cvt_pk_bf16_f32 v80, v187, v252
  v_cvt_pk_bf16_f32 v81, v188, v184
  v_cvt_pk_bf16_f32 v82, v189, v185
  v_cvt_pk_bf16_f32 v83, v190, v186
  s_waitcnt vmcnt(14) lgkmcnt(8)
  v_mfma_f32_32x32x16_bf16 v[0:15], v[204:207], v[84:87], v[0:15]
  ds_read_b64_tr_b16 v[196:197], v245 offset:32768
  ds_read_b64_tr_b16 v[198:199], v245 offset:33792
  v_add_f32 v184, v191, v192
  v_add_f32 v185, v191, v193
  v_add_f32 v186, v191, v194
  v_cos_f32 v187, v191
  v_sin_f32 v252, v191
  v_cos_f32 v188, v184
  v_sin_f32 v184, v184
  v_mfma_f32_32x32x16_bf16 v[16:31], v[208:211], v[84:87], v[16:31]
  ds_read_b64_tr_b16 v[200:201], v248 offset:32768
  ds_read_b64_tr_b16 v[202:203], v248 offset:33792
  v_cos_f32 v189, v185
  v_sin_f32 v185, v185
  v_cos_f32 v190, v186
  v_sin_f32 v186, v186
  v_add_f32 v191, v191, v195
  v_fract_f32 v191, v191
  v_cvt_pk_bf16_f32 v84, v187, v252
  v_cvt_pk_bf16_f32 v85, v188, v184
  v_cvt_pk_bf16_f32 v86, v189, v185
  v_cvt_pk_bf16_f32 v87, v190, v186
  s_waitcnt vmcnt(13) lgkmcnt(8)
  v_mfma_f32_32x32x16_bf16 v[0:15], v[212:215], v[88:91], v[0:15]
  ds_read_b64_tr_b16 v[204:205], v245 offset:34816
  ds_read_b64_tr_b16 v[206:207], v245 offset:35840
  v_add_f32 v184, v191, v192
  v_add_f32 v185, v191, v193
  v_add_f32 v186, v191, v194
  v_cos_f32 v187, v191
  v_sin_f32 v252, v191
  v_cos_f32 v188, v184
  v_sin_f32 v184, v184
  v_mfma_f32_32x32x16_bf16 v[16:31], v[216:219], v[88:91], v[16:31]
  ds_read_b64_tr_b16 v[208:209], v248 offset:34816
  ds_read_b64_tr_b16 v[210:211], v248 offset:35840
  v_cos_f32 v189, v185
  v_sin_f32 v185, v185
  v_cos_f32 v190, v186
  v_sin_f32 v186, v186
  v_add_f32 v191, v191, v195
  v_fract_f32 v191, v191
  v_cvt_pk_bf16_f32 v88, v187, v252
  v_cvt_pk_bf16_f32 v89, v188, v184
  v_cvt_pk_bf16_f32 v90, v189, v185
  v_cvt_pk_bf16_f32 v91, v190, v186
  s_waitcnt vmcnt(12) lgkmcnt(8)
  v_mfma_f32_32x32x16_bf16 v[0:15], v[220:223], v[92:95], v[0:15]
  ds_read_b64_tr_b16 v[212:213], v245 offset:36864
  ds_read_b64_tr_b16 v[214:215], v245 offset:37888
  v_add_f32 v184, v191, v192
  v_add_f32 v185, v191, v193
  v_add_f32 v186, v191, v194
  v_cos_f32 v187, v191
  v_sin_f32 v252, v191
  v_cos_f32 v188, v184
  v_sin_f32 v184, v184
  v_mfma_f32_32x32x16_bf16 v[16:31], v[224:227], v[92:95], v[16:31]
  ds_read_b64_tr_b16 v[216:217], v248 offset:36864
  ds_read_b64_tr_b16 v[218:219], v248 offset:37888
  v_cos_f32 v189, v185
  v_sin_f32 v185, v185
  v_cos_f32 v190, v186
  v_sin_f32 v186, v186
  v_add_f32 v191, v191, v195
  v_fract_f32 v191, v191
  v_cvt_pk_bf16_f32 v92, v187, v252
  v_cvt_pk_bf16_f32 v93, v188, v184
  v_cvt_pk_bf16_f32 v94, v189, v185
  v_cvt_pk_bf16_f32 v95, v190, v186
  s_waitcnt vmcnt(11) lgkmcnt(8)
  v_mfma_f32_32x32x16_bf16 v[0:15], v[196:199], v[96:99], v[0:15]
  ds_read_b64_tr_b16 v[220:221], v245 offset:38912
  ds_read_b64_tr_b16 v[222:223], v245 offset:39936
  v_add_f32 v184, v191, v192
  v_add_f32 v185, v191, v193
  v_add_f32 v186, v191, v194
  v_cos_f32 v187, v191
  v_sin_f32 v252, v191
  v_cos_f32 v188, v184
  v_sin_f32 v184, v184
  v_mfma_f32_32x32x16_bf16 v[16:31], v[200:203], v[96:99], v[16:31]
  ds_read_b64_tr_b16 v[224:225], v248 offset:38912
  ds_read_b64_tr_b16 v[226:227], v248 offset:39936
  v_cos_f32 v189, v185
  v_sin_f32 v185, v185
  v_cos_f32 v190, v186
  v_sin_f32 v186, v186
  v_add_f32 v191, v191, v195
  v_fract_f32 v191, v191
  v_cvt_pk_bf16_f32 v96, v187, v252
  v_cvt_pk_bf16_f32 v97, v188, v184
  v_cvt_pk_bf16_f32 v98, v189, v185
  v_cvt_pk_bf16_f32 v99, v190, v186
  s_waitcnt vmcnt(10) lgkmcnt(8)
  v_mfma_f32_32x32x16_bf16 v[0:15], v[204:207], v[100:103], v[0:15]
  ds_read_b64_tr_b16 v[196:197], v245 offset:16384
  ds_read_b64_tr_b16 v[198:199], v245 offset:17408
  v_add_f32 v184, v191, v192
  v_add_f32 v185, v191, v193
  v_add_f32 v186, v191, v194
  v_cos_f32 v187, v191
  v_sin_f32 v252, v191
  v_cos_f32 v188, v184
  v_sin_f32 v184, v184
  v_mfma_f32_32x32x16_bf16 v[16:31], v[208:211], v[100:103], v[16:31]
  ds_read_b64_tr_b16 v[200:201], v248 offset:16384
  ds_read_b64_tr_b16 v[202:203], v248 offset:17408
  v_cos_f32 v189, v185
  v_sin_f32 v185, v185
  v_cos_f32 v190, v186
  v_sin_f32 v186, v186
  v_add_f32 v191, v191, v195
  v_fract_f32 v191, v191
  v_cvt_pk_bf16_f32 v100, v187, v252
  v_cvt_pk_bf16_f32 v101, v188, v184
  v_cvt_pk_bf16_f32 v102, v189, v185
  v_cvt_pk_bf16_f32 v103, v190, v186
  s_waitcnt vmcnt(9) lgkmcnt(8)
  v_mfma_f32_32x32x16_bf16 v[0:15], v[212:215], v[104:107], v[0:15]
  ds_read_b64_tr_b16 v[204:205], v245 offset:18432
  ds_read_b64_tr_b16 v[206:207], v245 offset:19456
  v_add_f32 v184, v191, v192
  v_add_f32 v185, v191, v193
  v_add_f32 v186, v191, v194
  v_cos_f32 v187, v191
  v_sin_f32 v252, v191
  v_cos_f32 v188, v184
  v_sin_f32 v184, v184
  v_mfma_f32_32x32x16_bf16 v[16:31], v[216:219], v[104:107], v[16:31]
  ds_read_b64_tr_b16 v[208:209], v248 offset:18432
  ds_read_b64_tr_b16 v[210:211], v248 offset:19456
  v_cos_f32 v189, v185
  v_sin_f32 v185, v185
  v_cos_f32 v190, v186
  v_sin_f32 v186, v186
  v_add_f32 v191, v191, v195
  v_fract_f32 v191, v191
  v_cvt_pk_bf16_f32 v104, v187, v252
  v_cvt_pk_bf16_f32 v105, v188, v184
  v_cvt_pk_bf16_f32 v106, v189, v185
  v_cvt_pk_bf16_f32 v107, v190, v186
  s_waitcnt vmcnt(8) lgkmcnt(8)
  v_mfma_f32_32x32x16_bf16 v[0:15], v[220:223], v[108:111], v[0:15]
  ds_read_b64_tr_b16 v[212:213], v245 offset:20480
  ds_read_b64_tr_b16 v[214:215], v245 offset:21504
  v_mfma_f32_32x32x16_bf16 v[16:31], v[224:227], v[108:111], v[16:31]
  ds_read_b64_tr_b16 v[216:217], v248 offset:20480
  ds_read_b64_tr_b16 v[218:219], v248 offset:21504
  s_waitcnt vmcnt(7) lgkmcnt(8)
  v_mfma_f32_32x32x16_bf16 v[0:15], v[196:199], v[112:115], v[0:15]
  ds_read_b64_tr_b16 v[220:221], v245 offset:22528
  ds_read_b64_tr_b16 v[222:223], v245 offset:23552
  v_mfma_f32_32x32x16_bf16 v[16:31], v[200:203], v[112:115], v[16:31]
  ds_read_b64_tr_b16 v[224:225], v248 offset:22528
  ds_read_b64_tr_b16 v[226:227], v248 offset:23552
  buffer_load_dword v255, v243, s[52:55], s56 offen sc1
  s_waitcnt vmcnt(7) lgkmcnt(8)
  v_mfma_f32_32x32x16_bf16 v[0:15], v[204:207], v[116:119], v[0:15]
  ds_read_b64_tr_b16 v[196:197], v245 offset:49152
  ds_read_b64_tr_b16 v[198:199], v245 offset:50176
  v_mfma_f32_32x32x16_bf16 v[16:31], v[208:211], v[116:119], v[16:31]
  ds_read_b64_tr_b16 v[200:201], v248 offset:49152
  ds_read_b64_tr_b16 v[202:203], v248 offset:50176
  s_waitcnt vmcnt(6) lgkmcnt(8)
  v_mfma_f32_32x32x16_bf16 v[0:15], v[212:215], v[120:123], v[0:15]
  ds_read_b64_tr_b16 v[204:205], v245 offset:51200
  ds_read_b64_tr_b16 v[206:207], v245 offset:52224
  v_mfma_f32_32x32x16_bf16 v[16:31], v[216:219], v[120:123], v[16:31]
  ds_read_b64_tr_b16 v[208:209], v248 offset:51200
  ds_read_b64_tr_b16 v[210:211], v248 offset:52224
  s_waitcnt vmcnt(5) lgkmcnt(8)
  v_mfma_f32_32x32x16_bf16 v[0:15], v[220:223], v[124:127], v[0:15]
  ds_read_b64_tr_b16 v[212:213], v245 offset:53248
  ds_read_b64_tr_b16 v[214:215], v245 offset:54272
  v_mfma_f32_32x32x16_bf16 v[16:31], v[224:227], v[124:127], v[16:31]
  ds_read_b64_tr_b16 v[216:217], v248 offset:53248
  ds_read_b64_tr_b16 v[218:219], v248 offset:54272
  s_waitcnt vmcnt(4) lgkmcnt(8)
  v_mfma_f32_32x32x16_bf16 v[0:15], v[196:199], v[128:131], v[0:15]
  ds_read_b64_tr_b16 v[220:221], v245 offset:55296
  ds_read_b64_tr_b16 v[222:223], v245 offset:56320
  v_mfma_f32_32x32x16_bf16 v[16:31], v[200:203], v[128:131], v[16:31]
  ds_read_b64_tr_b16 v[224:225], v248 offset:55296
  ds_read_b64_tr_b16 v[226:227], v248 offset:56320
  s_waitcnt vmcnt(3) lgkmcnt(8)
  v_mfma_f32_32x32x16_bf16 v[0:15], v[204:207], v[132:135], v[0:15]
  v_mfma_f32_32x32x16_bf16 v[16:31], v[208:211], v[132:135], v[16:31]
  s_waitcnt vmcnt(2) lgkmcnt(4)
  v_mfma_f32_32x32x16_bf16 v[0:15], v[212:215], v[136:139], v[0:15]
  v_mfma_f32_32x32x16_bf16 v[16:31], v[216:219], v[136:139], v[16:31]
  s_waitcnt vmcnt(1) lgkmcnt(0)
  v_mfma_f32_32x32x16_bf16 v[0:15], v[220:223], v[140:143], v[0:15]
  v_mfma_f32_32x32x16_bf16 v[16:31], v[224:227], v[140:143], v[16:31]
  s_waitcnt vmcnt(0)
  s_mov_b32 s3, 0
  s_branch pl1_chk
pl1:
  buffer_load_dword v255, v243, s[52:55], s56 offen sc1
  s_waitcnt vmcnt(0)
pl1_chk:
  v_cmp_eq_u32 vcc, 0, v255
  s_add_u32 s3, s3, 1
  s_cbranch_vccz pl1_ok
  s_sleep 8
  s_cmp_lt_u32 s3, 200000
  s_cbranch_scc1 pl1
pl1_ok:
  buffer_load_dwordx4 v[196:199], v250, s[52:55], s57 offen offset:0 sc1
  buffer_load_dwordx4 v[200:203], v250, s[52:55], s57 offen offset:1024 sc1
  buffer_load_dwordx4 v[204:207], v250, s[52:55], s58 offen offset:0 sc1
  buffer_load_dwordx4 v[208:211], v250, s[52:55], s58 offen offset:1024 sc1
  s_barrier
  ds_write_b128 v241, v[16:19] offset:0
  ds_write_b128 v241, v[20:23] offset:1024
  ds_write_b128 v241, v[24:27] offset:2048
  ds_write_b128 v241, v[28:31] offset:3072
  ds_read_b128 v[108:111], v236 offset:0
  ds_read_b128 v[112:115], v237 offset:0
  ds_read_b128 v[116:119], v238 offset:0
  ds_read_b128 v[120:123], v239 offset:0
  ds_read_b128 v[124:127], v236 offset:8192
  ds_read_b128 v[128:131], v237 offset:8192
  ds_read_b128 v[132:135], v238 offset:8192
  s_waitcnt lgkmcnt(6)
  v_mfma_f32_32x32x16_bf16 v[16:31], v[108:111], v[148:151], 0
  ds_read_b128 v[136:139], v239 offset:8192
  s_waitcnt lgkmcnt(6)
  v_mfma_f32_32x32x16_bf16 v[16:31], v[112:115], v[152:155], v[16:31]
  s_barrier
  ds_read_b128 v[108:111], v236 offset:16384
  ds_read_b128 v[212:215], v242 offset:0
  s_waitcnt lgkmcnt(7)
  v_mfma_f32_32x32x16_bf16 v[16:31], v[116:119], v[156:159], v[16:31]
  ds_read_b128 v[112:115], v237 offset:16384
  ds_read_b128 v[216:219], v242 offset:1024
  s_waitcnt lgkmcnt(8)
  v_mfma_f32_32x32x16_bf16 v[16:31], v[120:123], v[160:163], v[16:31]
  ds_read_b128 v[116:119], v238 offset:16384
  ds_read_b128 v[220:223], v242 offset:2048
  s_waitcnt lgkmcnt(9)
  v_mfma_f32_32x32x16_bf16 v[16:31], v[124:127], v[164:167], v[16:31]
  ds_read_b128 v[120:123], v239 offset:16384
  ds_read_b128 v[224:227], v242 offset:3072
  s_waitcnt lgkmcnt(10)
  v_mfma_f32_32x32x16_bf16 v[16:31], v[128:131], v[168:171], v[16:31]
  ds_read_b128 v[124:127], v236 offset:24576
  s_waitcnt lgkmcnt(10)
  v_mfma_f32_32x32x16_bf16 v[16:31], v[132:135], v[172:175], v[16:31]
  ds_read_b128 v[128:131], v237 offset:24576
  s_waitcnt lgkmcnt(10)
  v_mfma_f32_32x32x16_bf16 v[16:31], v[136:139], v[176:179], v[16:31]
  ds_read_b128 v[132:135], v238 offset:24576
  s_waitcnt lgkmcnt(10)
  v_mfma_f32_32x32x16_bf16 v[16:31], v[108:111], v[180:183], v[16:31]
  ds_read_b128 v[136:139], v239 offset:24576
  s_waitcnt lgkmcnt(9)
  v_mfma_f32_32x32x16_bf16 v[16:31], v[112:115], v[32:35], v[16:31]
  ds_read_b128 v[108:111], v236 offset:32768
  s_waitcnt lgkmcnt(8)
  v_mfma_f32_32x32x16_bf16 v[16:31], v[116:119], v[36:39], v[16:31]
  ds_read_b128 v[112:115], v237 offset:32768
  s_waitcnt lgkmcnt(7)
  v_mfma_f32_32x32x16_bf16 v[16:31], v[120:123], v[40:43], v[16:31]
  ds_read_b128 v[116:119], v238 offset:32768
  s_waitcnt lgkmcnt(6)
  v_mfma_f32_32x32x16_bf16 v[16:31], v[124:127], v[44:47], v[16:31]
  ds_read_b128 v[120:123], v239 offset:32768
  v_add_f32 v0, v0, v212
  v_add_f32 v1, v1, v213
  v_add_f32 v2, v2, v214
  v_add_f32 v3, v3, v215
  v_add_f32 v4, v4, v216
  s_waitcnt lgkmcnt(6)
  v_mfma_f32_32x32x16_bf16 v[16:31], v[128:131], v[48:51], v[16:31]
  s_barrier
  v_add_u32 v236, 131072, v236
  ds_read_b128 v[124:127], v236 offset:0
  v_add_f32 v5, v5, v217
  v_add_f32 v6, v6, v218
  v_add_f32 v7, v7, v219
  v_add_f32 v8, v8, v220
  v_add_f32 v9, v9, v221
  s_waitcnt lgkmcnt(6)
  v_mfma_f32_32x32x16_bf16 v[16:31], v[132:135], v[52:55], v[16:31]
  v_add_u32 v237, 131072, v237
  ds_read_b128 v[128:131], v237 offset:0
  v_add_f32 v10, v10, v222
  v_add_f32 v11, v11, v223
  v_add_f32 v12, v12, v224
  v_add_f32 v13, v13, v225
  v_add_f32 v14, v14, v226
  s_waitcnt lgkmcnt(6)
  v_mfma_f32_32x32x16_bf16 v[16:31], v[136:139], v[56:59], v[16:31]
  v_add_u32 v238, 131072, v238
  ds_read_b128 v[132:135], v238 offset:0
  v_add_f32 v15, v15, v227
  s_waitcnt vmcnt(0)
  v_lshlrev_b32 v184, 16, v196
  v_and_b32 v185, 0xffff0000, v196
  v_add_f32 v0, v0, v184
  s_waitcnt lgkmcnt(6)
  v_mfma_f32_32x32x16_bf16 v[16:31], v[108:111], v[60:63], v[16:31]
  v_add_u32 v239, 131072, v239
  ds_read_b128 v[136:139], v239 offset:0
  v_add_f32 v1, v1, v185
  v_lshlrev_b32 v186, 16, v197
  v_and_b32 v187, 0xffff0000, v197
  v_add_f32 v2, v2, v186
  v_add_f32 v3, v3, v187
  s_waitcnt lgkmcnt(6)
  v_mfma_f32_32x32x16_bf16 v[16:31], v[112:115], v[64:67], v[16:31]
  ds_read_b128 v[108:111], v236 offset:8192
  v_lshlrev_b32 v184, 16, v198
  v_and_b32 v185, 0xffff0000, v198
  v_add_f32 v4, v4, v184
  v_add_f32 v5, v5, v185
  v_lshlrev_b32 v186, 16, v199
  s_waitcnt lgkmcnt(6)
  v_mfma_f32_32x32x16_bf16 v[16:31], v[116:119], v[68:71], v[16:31]
  ds_read_b128 v[112:115], v237 offset:8192
  v_and_b32 v187, 0xffff0000, v199
  v_add_f32 v6, v6, v186
  v_add_f32 v7, v7, v187
  v_lshlrev_b32 v184, 16, v200
  v_and_b32 v185, 0xffff0000, v200
  s_waitcnt lgkmcnt(6)
  v_mfma_f32_32x32x16_bf16 v[16:31], v[120:123], v[72:75], v[16:31]
  ds_read_b128 v[116:119], v238 offset:8192
  v_add_f32 v8, v8, v184
  v_add_f32 v9, v9, v185
  v_lshlrev_b32 v186, 16, v201
  v_and_b32 v187, 0xffff0000, v201
  v_add_f32 v10, v10, v186
  s_waitcnt lgkmcnt(6)
  v_mfma_f32_32x32x16_bf16 v[16:31], v[124:127], v[76:79], v[16:31]
  ds_read_b128 v[120:123], v239 offset:8192
  v_add_f32 v11, v11, v187
  v_lshlrev_b32 v184, 16, v202
  v_and_b32 v185, 0xffff0000, v202
  v_add_f32 v12, v12, v184
  v_add_f32 v13, v13, v185
  s_waitcnt lgkmcnt(6)
  v_mfma_f32_32x32x16_bf16 v[16:31], v[128:131], v[80:83], v[16:31]
  ds_read_b128 v[124:127], v240 offset:40960
  v_lshlrev_b32 v186, 16, v203
  v_and_b32 v187, 0xffff0000, v203
  v_add_f32 v14, v14, v186
  v_add_f32 v15, v15, v187
  v_lshlrev_b32 v184, 16, v204
  s_waitcnt lgkmcnt(6)
  v_mfma_f32_32x32x16_bf16 v[16:31], v[132:135], v[84:87], v[16:31]
  v_and_b32 v185, 0xffff0000, v204
  v_add_f32 v0, v0, v184
  v_add_f32 v1, v1, v185
  v_lshlrev_b32 v186, 16, v205
  v_and_b32 v187, 0xffff0000, v205
  s_waitcnt lgkmcnt(5)
  v_mfma_f32_32x32x16_bf16 v[16:31], v[136:139], v[88:91], v[16:31]
  v_add_f32 v2, v2, v186
  v_add_f32 v3, v3, v187
  v_lshlrev_b32 v184, 16, v206
  v_and_b32 v185, 0xffff0000, v206
  v_add_f32 v4, v4, v184
  s_waitcnt lgkmcnt(4)
  v_mfma_f32_32x32x16_bf16 v[16:31], v[108:111], v[92:95], v[16:31]
  v_add_f32 v5, v5, v185
  v_lshlrev_b32 v186, 16, v207
  v_and_b32 v187, 0xffff0000, v207
  v_add_f32 v6, v6, v186
  v_add_f32 v7, v7, v187
  s_waitcnt lgkmcnt(3)
  v_mfma_f32_32x32x16_bf16 v[16:31], v[112:115], v[96:99], v[16:31]
  v_lshlrev_b32 v184, 16, v208
  v_and_b32 v185, 0xffff0000, v208
  v_add_f32 v8, v8, v184
  v_add_f32 v9, v9, v185
  v_lshlrev_b32 v186, 16, v209
  s_waitcnt lgkmcnt(2)
  v_mfma_f32_32x32x16_bf16 v[16:31], v[116:119], v[100:103], v[16:31]
  v_and_b32 v187, 0xffff0000, v209
  v_add_f32 v10, v10, v186
  v_add_f32 v11, v11, v187
  v_lshlrev_b32 v184, 16, v210
  v_and_b32 v185, 0xffff0000, v210
  s_waitcnt lgkmcnt(1)
  v_mfma_f32_32x32x16_bf16 v[16:31], v[120:123], v[104:107], v[16:31]
  v_add_f32 v12, v12, v184
  v_add_f32 v13, v13, v185
  v_lshlrev_b32 v186, 16, v211
  v_and_b32 v187, 0xffff0000, v211
  v_add_f32 v14, v14, v186
  s_waitcnt lgkmcnt(0)
  v_mfma_f32_32x32x16_bf16 v[16:31], v[124:127], v[144:147], v[16:31]
  v_add_f32 v15, v15, v187
  s_nop 7
  s_nop 2
  v_cvt_pk_bf16_f32 v212, v16, v17
  v_cvt_pk_bf16_f32 v213, v18, v19
  v_cvt_pk_bf16_f32 v214, v20, v21
  v_cvt_pk_bf16_f32 v215, v22, v23
  s_nop 1
  v_mfma_f32_32x32x16_bf16 v[0:15], v[212:215], v[228:231], v[0:15]
  v_cvt_pk_bf16_f32 v216, v24, v25
  v_cvt_pk_bf16_f32 v217, v26, v27
  v_cvt_pk_bf16_f32 v218, v28, v29
  v_cvt_pk_bf16_f32 v219, v30, v31
  s_nop 1
  v_mfma_f32_32x32x16_bf16 v[0:15], v[216:219], v[232:235], v[0:15]
  s_nop 7
  s_nop 3
  v_cvt_pk_bf16_f32 v220, v0, v1
  v_cvt_pk_bf16_f32 v221, v2, v3
  v_cvt_pk_bf16_f32 v222, v4, v5
  v_cvt_pk_bf16_f32 v223, v6, v7
  buffer_store_dwordx4 v[220:223], v251, s[24:27], s28 offen offset:0
  v_cvt_pk_bf16_f32 v224, v8, v9
  v_cvt_pk_bf16_f32 v225, v10, v11
  v_cvt_pk_bf16_f32 v226, v12, v13
  v_cvt_pk_bf16_f32 v227, v14, v15
  buffer_store_dwordx4 v[224:227], v251, s[24:27], s28 offen offset:32
  s_endpgm
fh_A:
  s_lshl2_add_u32 s44, s40, s42
  s_mul_i32 s44, s44, 896
  v_lshrrev_b32 v252, 3, v254
  v_mul_u32_u24 v6, 57344, v252
  v_lshrrev_b32 v252, 4, v254
  v_and_b32 v253, 7, v254
  v_xor_b32 v252, v252, v253
  v_lshlrev_b32 v252, 4, v252
  v_xor_b32 v253, 64, v252
  v_add_u32 v7, v6, v253
  v_add_u32 v6, v6, v252
  v_add_u32 v7, 458752, v7
  v_add_u32 v8, 917504, v6
  v_add_u32 v9, 917504, v7
  s_mov_b32 s20, s4
  s_mov_b32 s21, s5
  s_mov_b32 s22, 1835008
  s_mov_b32 s23, 0x20000
  s_mov_b32 s53, s44
  buffer_load_dwordx4 v[32:35], v6, s[20:23], s53 offen offset:0
  buffer_load_dwordx4 v[36:39], v7, s[20:23], s53 offen offset:0
  buffer_load_dwordx4 v[40:43], v8, s[20:23], s53 offen offset:0
  buffer_load_dwordx4 v[44:47], v9, s[20:23], s53 offen offset:0
  buffer_load_dwordx4 v[48:51], v6, s[20:23], s53 offen offset:768
  buffer_load_dwordx4 v[52:55], v7, s[20:23], s53 offen offset:768
  buffer_load_dwordx4 v[56:59], v8, s[20:23], s53 offen offset:768
  buffer_load_dwordx4 v[60:63], v9, s[20:23], s53 offen offset:768
  s_movk_i32 s58, 256
  s_mov_b32 s59, 0x20000
  v_min_u32 v241, 53, v254
  v_lshlrev_b32 v241, 2, v241
  s_mov_b32 s24, s6
  s_mov_b32 s25, s7
  s_mov_b32 s26, 0x10000000
  s_mov_b32 s27, 0x20000
  v_bfe_u32 v242, v254, 1, 4
  v_lshlrev_b32 v242, 7, v242
  v_and_b32 v252, 1, v254
  v_lshl_add_u32 v242, v252, 4, v242
  s_lshl_b32 s52, s14, 6
  s_add_u32 s52, s52, s40
  s_lshl_b32 s52, s52, 5
  s_add_u32 s52, s52, 19992576
  s_load_dwordx4 s[36:39], s[0:1], 8
  s_lshl_b32 s41, s40, 12
  v_lshl_add_u32 v10, v254, 4, s41
  v_add_u32 v11, 65536, v10
  s_lshl_b32 s45, s40, 7
  s_add_u32 s45, s45, 122880
  v_and_b32 v4, 31, v254
  v_lshl_add_u32 v4, v4, 2, s45
  s_lshl2_add_u32 s14, s12, s13
  s_and_b32 s15, s14, 1
  s_lshr_b32 s14, s14, 1
  s_and_b32 s16, s14, 1
  s_mul_i32 s18, s15, 7
  s_add_u32 s18, s18, s17
  s_sub_u32 s44, 0, s14
  s_cmp_eq_u32 s14, 0
  s_cselect_b32 s44, 16, s44
  v_and_b32 v244, 15, v254
  v_lshrrev_b32 v245, 4, v254
  s_lshl_b32 s45, s40, 5
  s_cmp_eq_u32 s14, 0
  s_cselect_b32 s47, 0.5, 0
  s_cselect_b32 s41, 0.5, 0x3e800000
  s_mul_i32 s46, s40, 1536
  s_add_u32 s46, s46, 139264
  v_lshlrev_b32 v252, 4, v254
  v_add_u32 v252, s46, v252
  v_lshlrev_b32 v253, 3, v254
  v_add_u32 v253, s46, v253
  v_mul_u32_u24 v246, 32, v244
  v_add_u32 v246, s14, v246
  v_mul_u32_u24 v247, 16, v245
  v_add_u32 v247, s40, v247
  v_cvt_f32_i32 v246, v246
  v_cvt_f32_u32 v247, v247
  v_mul_f32 v246, 0x3a000000, v246
  v_mul_f32 v247, v246, v247
  v_mul_f32 v246, 4.0, v246
  v_fract_f32 v160, v247
  v_add_f32 v247, v246, v247
  v_fract_f32 v161, v247
  v_add_f32 v247, v246, v247
  v_fract_f32 v162, v247
  v_add_f32 v247, v246, v247
  v_fract_f32 v163, v247
  v_cos_f32 v164, v160
  v_sin_f32 v168, v160
  v_cos_f32 v165, v161
  v_sin_f32 v169, v161
  v_cos_f32 v166, v162
  v_sin_f32 v170, v162
  v_cos_f32 v167, v163
  v_sin_f32 v171, v163
  v_cvt_pk_bf16_f32 v174, v164, v165
  v_cvt_pk_bf16_f32 v175, v166, v167
  v_cvt_pk_bf16_f32 v172, -v168, -v169
  v_cvt_pk_bf16_f32 v173, -v170, -v171
  v_cvt_pk_bf16_f32 v176, v168, v169
  v_cvt_pk_bf16_f32 v177, v170, v171
  ds_write_b128 v252, v[172:175] offset:0
  ds_write_b64 v253, v[176:177] offset:1024
  v_mul_u32_u24 v246, 32, v244
  v_add_u32 v246, s44, v246
  v_mul_u32_u24 v247, 16, v245
  v_add_u32 v247, s40, v247
  v_cvt_f32_i32 v246, v246
  v_cvt_f32_u32 v247, v247
  v_mul_f32 v246, 0x3a000000, v246
  v_mul_f32 v247, v246, v247
  v_mul_f32 v246, 4.0, v246
  v_fract_f32 v180, v247
  v_add_f32 v247, v246, v247
  v_fract_f32 v181, v247
  v_add_f32 v247, v246, v247
  v_fract_f32 v182, v247
  v_add_f32 v247, v246, v247
  v_fract_f32 v183, v247
  v_cos_f32 v184, v180
  v_sin_f32 v188, v180
  v_cos_f32 v185, v181
  v_sin_f32 v189, v181
  v_cos_f32 v186, v182
  v_sin_f32 v190, v182
  v_cos_f32 v187, v183
  v_sin_f32 v191, v183
  v_cvt_pk_bf16_f32 v194, v184, v185
  v_cvt_pk_bf16_f32 v195, v186, v187
  v_cvt_pk_bf16_f32 v192, -v188, -v189
  v_cvt_pk_bf16_f32 v193, -v190, -v191
  v_cvt_pk_bf16_f32 v196, v188, v189
  v_cvt_pk_bf16_f32 v197, v190, v191
  ds_write_b128 v252, v[192:195] offset:6144
  ds_write_b64 v253, v[196:197] offset:7168
  v_mul_u32_u24 v246, 128, v244
  v_add_u32 v246, s45, v246
  v_mul_u32_u24 v247, 4, v245
  v_cvt_f32_i32 v246, v246
  v_cvt_f32_u32 v247, v247
  v_mul_f32 v246, 0x3a000000, v246
  v_mul_f32 v247, v246, v247
  v_fract_f32 v160, v247
  v_add_f32 v247, v246, v247
  v_fract_f32 v161, v247
  v_add_f32 v247, v246, v247
  v_fract_f32 v162, v247
  v_add_f32 v247, v246, v247
  v_fract_f32 v163, v247
  v_cos_f32 v164, v160
  v_sin_f32 v168, v160
  v_cos_f32 v165, v161
  v_sin_f32 v169, v161
  v_cos_f32 v166, v162
  v_sin_f32 v170, v162
  v_cos_f32 v167, v163
  v_sin_f32 v171, v163
  v_cvt_pk_bf16_f32 v174, v164, v165
  v_cvt_pk_bf16_f32 v175, v166, v167
  v_cvt_pk_bf16_f32 v172, -v168, -v169
  v_cvt_pk_bf16_f32 v173, -v170, -v171
  v_cvt_pk_bf16_f32 v176, v168, v169
  v_cvt_pk_bf16_f32 v177, v170, v171
  ds_write_b128 v252, v[172:175] offset:12288
  ds_write_b64 v253, v[176:177] offset:13312
  v_mul_u32_u24 v246, 128, v244
  v_add_u32 v246, s45, v246
  v_mul_u32_u24 v247, 4, v245
  v_cvt_f32_i32 v246, v246
  v_cvt_f32_u32 v247, v247
  v_mul_f32 v246, 0x3a000000, v246
  v_mul_f32 v247, v246, v247
  v_fma_f32 v247, v246, s47, v247
  v_add_f32 v247, s41, v247
  v_fract_f32 v180, v247
  v_add_f32 v247, v246, v247
  v_fract_f32 v181, v247
  v_add_f32 v247, v246, v247
  v_fract_f32 v182, v247
  v_add_f32 v247, v246, v247
  v_fract_f32 v183, v247
  v_cos_f32 v184, v180
  v_sin_f32 v188, v180
  v_cos_f32 v185, v181
  v_sin_f32 v189, v181
  v_cos_f32 v186, v182
  v_sin_f32 v190, v182
  v_cos_f32 v187, v183
  v_sin_f32 v191, v183
  v_cvt_pk_bf16_f32 v194, v184, v185
  v_cvt_pk_bf16_f32 v195, v186, v187
  v_cvt_pk_bf16_f32 v192, -v188, -v189
  v_cvt_pk_bf16_f32 v193, -v190, -v191
  v_cvt_pk_bf16_f32 v196, v188, v189
  v_cvt_pk_bf16_f32 v197, v190, v191
  ds_write_b128 v252, v[192:195] offset:18432
  ds_write_b64 v253, v[196:197] offset:19456
  s_cmp_ge_u32 s17, 2
  s_cselect_b32 s47, s44, s14
  s_cselect_b32 s54, 34816, 0
  s_add_u32 s54, s54, 2048
  s_mul_i32 s48, s15, 224
  s_lshl_b32 s49, s47, 1
  s_and_b32 s49, s49, 15
  s_sub_u32 s48, s48, s49
  s_and_b32 s49, s17, 1
  s_mul_i32 s49, s49, 17408
  s_add_u32 s54, s54, s49
  s_movk_i32 s49, 450
  v_lshlrev_b32 v246, 5, v245
  v_add_u32 v246, s47, v246
  v_lshlrev_b32 v247, 4, v244
  v_add_u32 v247, s48, v247
  v_and_b32 v224, 2047, v246
  v_add_u32 v246, 128, v246
  v_mad_u32_u24 v224, v224, s49, v247
  v_and_b32 v225, 2047, v246
  v_add_u32 v246, 128, v246
  v_mad_u32_u24 v225, v225, s49, v247
  v_and_b32 v226, 2047, v246
  v_add_u32 v246, 128, v246
  v_mad_u32_u24 v226, v226, s49, v247
  v_and_b32 v227, 2047, v246
  v_add_u32 v246, 128, v246
  v_mad_u32_u24 v227, v227, s49, v247
  v_and_b32 v228, 2047, v246
  v_add_u32 v246, 128, v246
  v_mad_u32_u24 v228, v228, s49, v247
  v_and_b32 v229, 2047, v246
  v_add_u32 v246, 128, v246
  v_mad_u32_u24 v229, v229, s49, v247
  v_and_b32 v230, 2047, v246
  v_add_u32 v246, 128, v246
  v_mad_u32_u24 v230, v230, s49, v247
  v_and_b32 v231, 2047, v246
  v_add_u32 v246, 128, v246
  v_mad_u32_u24 v231, v231, s49, v247
  v_and_b32 v232, 2047, v246
  v_add_u32 v246, 128, v246
  v_mad_u32_u24 v232, v232, s49, v247
  v_and_b32 v233, 2047, v246
  v_add_u32 v246, 128, v246
  v_mad_u32_u24 v233, v233, s49, v247
  v_and_b32 v234, 2047, v246
  v_add_u32 v246, 128, v246
  v_mad_u32_u24 v234, v234, s49, v247
  v_and_b32 v235, 2047, v246
  v_add_u32 v246, 128, v246
  v_mad_u32_u24 v235, v235, s49, v247
  v_and_b32 v236, 2047, v246
  v_add_u32 v246, 128, v246
  v_mad_u32_u24 v236, v236, s49, v247
  v_and_b32 v237, 2047, v246
  v_add_u32 v246, 128, v246
  v_mad_u32_u24 v237, v237, s49, v247
  v_and_b32 v238, 2047, v246
  v_add_u32 v246, 128, v246
  v_mad_u32_u24 v238, v238, s49, v247
  v_and_b32 v239, 2047, v246
  v_mad_u32_u24 v239, v239, s49, v247
  s_mov_b32 s46, 0xffff0000
  s_waitcnt vmcnt(3)
  buffer_load_dwordx4 v[64:67], v6, s[20:23], s53 offen offset:128
  buffer_load_dwordx4 v[68:71], v7, s[20:23], s53 offen offset:128
  buffer_load_dwordx4 v[72:75], v8, s[20:23], s53 offen offset:128
  buffer_load_dwordx4 v[76:79], v9, s[20:23], s53 offen offset:128
  buffer_load_dwordx4 v[80:83], v6, s[20:23], s53 offen offset:640
  buffer_load_dwordx4 v[84:87], v7, s[20:23], s53 offen offset:640
  buffer_load_dwordx4 v[88:91], v8, s[20:23], s53 offen offset:640
  buffer_load_dwordx4 v[92:95], v9, s[20:23], s53 offen offset:640
  v_lshlrev_b32 v164, 16, v51
  v_and_b32 v51, s46, v51
  v_lshlrev_b32 v165, 16, v50
  v_and_b32 v50, s46, v50
  v_lshlrev_b32 v166, 16, v49
  v_and_b32 v49, s46, v49
  v_lshlrev_b32 v167, 16, v48
  v_and_b32 v48, s46, v48
  v_lshlrev_b32 v160, 16, v32
  v_and_b32 v32, s46, v32
  v_lshlrev_b32 v161, 16, v33
  v_and_b32 v33, s46, v33
  v_lshlrev_b32 v162, 16, v34
  v_and_b32 v34, s46, v34
  v_lshlrev_b32 v163, 16, v35
  v_and_b32 v35, s46, v35
  v_add_f32_dpp v168, v51, v160 row_half_mirror row_mask:0xf bank_mask:0xf
  v_sub_f32_dpp v51, v51, v160 row_half_mirror row_mask:0xf bank_mask:0xf
  v_add_f32_dpp v172, v164, v32 row_half_mirror row_mask:0xf bank_mask:0xf
  v_sub_f32_dpp v164, v164, v32 row_half_mirror row_mask:0xf bank_mask:0xf
  v_add_f32_dpp v169, v50, v161 row_half_mirror row_mask:0xf bank_mask:0xf
  v_sub_f32_dpp v50, v50, v161 row_half_mirror row_mask:0xf bank_mask:0xf
  v_add_f32_dpp v173, v165, v33 row_half_mirror row_mask:0xf bank_mask:0xf
  v_sub_f32_dpp v165, v165, v33 row_half_mirror row_mask:0xf bank_mask:0xf
  v_add_f32_dpp v170, v49, v162 row_half_mirror row_mask:0xf bank_mask:0xf
  v_sub_f32_dpp v49, v49, v162 row_half_mirror row_mask:0xf bank_mask:0xf
  v_add_f32_dpp v174, v166, v34 row_half_mirror row_mask:0xf bank_mask:0xf
  v_sub_f32_dpp v166, v166, v34 row_half_mirror row_mask:0xf bank_mask:0xf
  v_add_f32_dpp v171, v48, v163 row_half_mirror row_mask:0xf bank_mask:0xf
  v_sub_f32_dpp v48, v48, v163 row_half_mirror row_mask:0xf bank_mask:0xf
  v_add_f32_dpp v175, v167, v35 row_half_mirror row_mask:0xf bank_mask:0xf
  v_sub_f32_dpp v167, v167, v35 row_half_mirror row_mask:0xf bank_mask:0xf
  v_cvt_pk_bf16_f32 v32, v168, v172
  v_cvt_pk_bf16_f32 v33, v169, v173
  v_cvt_pk_bf16_f32 v34, v170, v174
  v_cvt_pk_bf16_f32 v35, v171, v175
  ds_write_b128 v10, v[32:35] offset:0
  v_cvt_pk_bf16_f32 v160, v51, v164
  v_cvt_pk_bf16_f32 v161, v50, v165
  v_cvt_pk_bf16_f32 v162, v49, v166
  v_cvt_pk_bf16_f32 v163, v48, v167
  ds_write_b128 v10, v[160:163] offset:16384
  s_waitcnt vmcnt(10)
  v_lshlrev_b32 v180, 16, v55
  v_and_b32 v55, s46, v55
  v_lshlrev_b32 v181, 16, v54
  v_and_b32 v54, s46, v54
  v_lshlrev_b32 v182, 16, v53
  v_and_b32 v53, s46, v53
  v_lshlrev_b32 v183, 16, v52
  v_and_b32 v52, s46, v52
  v_lshlrev_b32 v176, 16, v36
  v_and_b32 v36, s46, v36
  v_lshlrev_b32 v177, 16, v37
  v_and_b32 v37, s46, v37
  v_lshlrev_b32 v178, 16, v38
  v_and_b32 v38, s46, v38
  v_lshlrev_b32 v179, 16, v39
  v_and_b32 v39, s46, v39
  v_add_f32_dpp v184, v55, v176 row_half_mirror row_mask:0xf bank_mask:0xf
  v_sub_f32_dpp v55, v55, v176 row_half_mirror row_mask:0xf bank_mask:0xf
  v_add_f32_dpp v188, v180, v36 row_half_mirror row_mask:0xf bank_mask:0xf
  v_sub_f32_dpp v180, v180, v36 row_half_mirror row_mask:0xf bank_mask:0xf
  v_add_f32_dpp v185, v54, v177 row_half_mirror row_mask:0xf bank_mask:0xf
  v_sub_f32_dpp v54, v54, v177 row_half_mirror row_mask:0xf bank_mask:0xf
  v_add_f32_dpp v189, v181, v37 row_half_mirror row_mask:0xf bank_mask:0xf
  v_sub_f32_dpp v181, v181, v37 row_half_mirror row_mask:0xf bank_mask:0xf
  v_add_f32_dpp v186, v53, v178 row_half_mirror row_mask:0xf bank_mask:0xf
  v_sub_f32_dpp v53, v53, v178 row_half_mirror row_mask:0xf bank_mask:0xf
  v_add_f32_dpp v190, v182, v38 row_half_mirror row_mask:0xf bank_mask:0xf
  v_sub_f32_dpp v182, v182, v38 row_half_mirror row_mask:0xf bank_mask:0xf
  v_add_f32_dpp v187, v52, v179 row_half_mirror row_mask:0xf bank_mask:0xf
  v_sub_f32_dpp v52, v52, v179 row_half_mirror row_mask:0xf bank_mask:0xf
  v_add_f32_dpp v191, v183, v39 row_half_mirror row_mask:0xf bank_mask:0xf
  v_sub_f32_dpp v183, v183, v39 row_half_mirror row_mask:0xf bank_mask:0xf
  v_cvt_pk_bf16_f32 v36, v184, v188
  v_cvt_pk_bf16_f32 v37, v185, v189
  v_cvt_pk_bf16_f32 v38, v186, v190
  v_cvt_pk_bf16_f32 v39, v187, v191
  ds_write_b128 v10, v[36:39] offset:1024
  v_cvt_pk_bf16_f32 v176, v55, v180
  v_cvt_pk_bf16_f32 v177, v54, v181
  v_cvt_pk_bf16_f32 v178, v53, v182
  v_cvt_pk_bf16_f32 v179, v52, v183
  ds_write_b128 v10, v[176:179] offset:17408
  s_waitcnt vmcnt(9)
  v_lshlrev_b32 v196, 16, v59
  v_and_b32 v59, s46, v59
  v_lshlrev_b32 v197, 16, v58
  v_and_b32 v58, s46, v58
  v_lshlrev_b32 v198, 16, v57
  v_and_b32 v57, s46, v57
  v_lshlrev_b32 v199, 16, v56
  v_and_b32 v56, s46, v56
  v_lshlrev_b32 v192, 16, v40
  v_and_b32 v40, s46, v40
  v_lshlrev_b32 v193, 16, v41
  v_and_b32 v41, s46, v41
  v_lshlrev_b32 v194, 16, v42
  v_and_b32 v42, s46, v42
  v_lshlrev_b32 v195, 16, v43
  v_and_b32 v43, s46, v43
  v_add_f32_dpp v200, v59, v192 row_half_mirror row_mask:0xf bank_mask:0xf
  v_sub_f32_dpp v59, v59, v192 row_half_mirror row_mask:0xf bank_mask:0xf
  v_add_f32_dpp v204, v196, v40 row_half_mirror row_mask:0xf bank_mask:0xf
  v_sub_f32_dpp v196, v196, v40 row_half_mirror row_mask:0xf bank_mask:0xf
  v_add_f32_dpp v201, v58, v193 row_half_mirror row_mask:0xf bank_mask:0xf
  v_sub_f32_dpp v58, v58, v193 row_half_mirror row_mask:0xf bank_mask:0xf
  v_add_f32_dpp v205, v197, v41 row_half_mirror row_mask:0xf bank_mask:0xf
  v_sub_f32_dpp v197, v197, v41 row_half_mirror row_mask:0xf bank_mask:0xf
  v_add_f32_dpp v202, v57, v194 row_half_mirror row_mask:0xf bank_mask:0xf
  v_sub_f32_dpp v57, v57, v194 row_half_mirror row_mask:0xf bank_mask:0xf
  v_add_f32_dpp v206, v198, v42 row_half_mirror row_mask:0xf bank_mask:0xf
  v_sub_f32_dpp v198, v198, v42 row_half_mirror row_mask:0xf bank_mask:0xf
  v_add_f32_dpp v203, v56, v195 row_half_mirror row_mask:0xf bank_mask:0xf
  v_sub_f32_dpp v56, v56, v195 row_half_mirror row_mask:0xf bank_mask:0xf
  v_add_f32_dpp v207, v199, v43 row_half_mirror row_mask:0xf bank_mask:0xf
  v_sub_f32_dpp v199, v199, v43 row_half_mirror row_mask:0xf bank_mask:0xf
  v_cvt_pk_bf16_f32 v40, v200, v204
  v_cvt_pk_bf16_f32 v41, v201, v205
  v_cvt_pk_bf16_f32 v42, v202, v206
  v_cvt_pk_bf16_f32 v43, v203, v207
  ds_write_b128 v10, v[40:43] offset:2048
  v_cvt_pk_bf16_f32 v192, v59, v196
  v_cvt_pk_bf16_f32 v193, v58, v197
  v_cvt_pk_bf16_f32 v194, v57, v198
  v_cvt_pk_bf16_f32 v195, v56, v199
  ds_write_b128 v10, v[192:195] offset:18432
  s_waitcnt vmcnt(8)
  v_lshlrev_b32 v212, 16, v63
  v_and_b32 v63, s46, v63
  v_lshlrev_b32 v213, 16, v62
  v_and_b32 v62, s46, v62
  v_lshlrev_b32 v214, 16, v61
  v_and_b32 v61, s46, v61
  v_lshlrev_b32 v215, 16, v60
  v_and_b32 v60, s46, v60
  v_lshlrev_b32 v208, 16, v44
  v_and_b32 v44, s46, v44
  v_lshlrev_b32 v209, 16, v45
  v_and_b32 v45, s46, v45
  v_lshlrev_b32 v210, 16, v46
  v_and_b32 v46, s46, v46
  v_lshlrev_b32 v211, 16, v47
  v_and_b32 v47, s46, v47
  v_add_f32_dpp v216, v63, v208 row_half_mirror row_mask:0xf bank_mask:0xf
  v_sub_f32_dpp v63, v63, v208 row_half_mirror row_mask:0xf bank_mask:0xf
  v_add_f32_dpp v220, v212, v44 row_half_mirror row_mask:0xf bank_mask:0xf
  v_sub_f32_dpp v212, v212, v44 row_half_mirror row_mask:0xf bank_mask:0xf
  v_add_f32_dpp v217, v62, v209 row_half_mirror row_mask:0xf bank_mask:0xf
  v_sub_f32_dpp v62, v62, v209 row_half_mirror row_mask:0xf bank_mask:0xf
  v_add_f32_dpp v221, v213, v45 row_half_mirror row_mask:0xf bank_mask:0xf
  v_sub_f32_dpp v213, v213, v45 row_half_mirror row_mask:0xf bank_mask:0xf
  v_add_f32_dpp v218, v61, v210 row_half_mirror row_mask:0xf bank_mask:0xf
  v_sub_f32_dpp v61, v61, v210 row_half_mirror row_mask:0xf bank_mask:0xf
  v_add_f32_dpp v222, v214, v46 row_half_mirror row_mask:0xf bank_mask:0xf
  v_sub_f32_dpp v214, v214, v46 row_half_mirror row_mask:0xf bank_mask:0xf
  v_add_f32_dpp v219, v60, v211 row_half_mirror row_mask:0xf bank_mask:0xf
  v_sub_f32_dpp v60, v60, v211 row_half_mirror row_mask:0xf bank_mask:0xf
  v_add_f32_dpp v223, v215, v47 row_half_mirror row_mask:0xf bank_mask:0xf
  v_sub_f32_dpp v215, v215, v47 row_half_mirror row_mask:0xf bank_mask:0xf
  v_cvt_pk_bf16_f32 v44, v216, v220
  v_cvt_pk_bf16_f32 v45, v217, v221
  v_cvt_pk_bf16_f32 v46, v218, v222
  v_cvt_pk_bf16_f32 v47, v219, v223
  ds_write_b128 v10, v[44:47] offset:3072
  v_cvt_pk_bf16_f32 v208, v63, v212
  v_cvt_pk_bf16_f32 v209, v62, v213
  v_cvt_pk_bf16_f32 v210, v61, v214
  v_cvt_pk_bf16_f32 v211, v60, v215
  ds_write_b128 v10, v[208:211] offset:19456
  s_waitcnt lgkmcnt(0)
  s_barrier
  s_waitcnt vmcnt(3)
  buffer_load_dwordx4 v[96:99], v6, s[20:23], s53 offen offset:256
  buffer_load_dwordx4 v[100:103], v7, s[20:23], s53 offen offset:256
  buffer_load_dwordx4 v[104:107], v8, s[20:23], s53 offen offset:256
  buffer_load_dwordx4 v[108:111], v9, s[20:23], s53 offen offset:256
  buffer_load_dwordx4 v[112:115], v6, s[20:23], s53 offen offset:512
  buffer_load_dwordx4 v[116:119], v7, s[20:23], s53 offen offset:512
  buffer_load_dwordx4 v[120:123], v8, s[20:23], s53 offen offset:512
  buffer_load_dwordx4 v[124:127], v9, s[20:23], s53 offen offset:512
  v_lshlrev_b32 v164, 16, v83
  v_and_b32 v83, s46, v83
  v_lshlrev_b32 v165, 16, v82
  v_and_b32 v82, s46, v82
  v_lshlrev_b32 v166, 16, v81
  v_and_b32 v81, s46, v81
  v_lshlrev_b32 v167, 16, v80
  v_and_b32 v80, s46, v80
  v_lshlrev_b32 v160, 16, v64
  v_and_b32 v64, s46, v64
  v_lshlrev_b32 v161, 16, v65
  v_and_b32 v65, s46, v65
  v_lshlrev_b32 v162, 16, v66
  v_and_b32 v66, s46, v66
  v_lshlrev_b32 v163, 16, v67
  v_and_b32 v67, s46, v67
  v_add_f32_dpp v168, v83, v160 row_half_mirror row_mask:0xf bank_mask:0xf
  v_sub_f32_dpp v83, v83, v160 row_half_mirror row_mask:0xf bank_mask:0xf
  v_add_f32_dpp v172, v164, v64 row_half_mirror row_mask:0xf bank_mask:0xf
  v_sub_f32_dpp v164, v164, v64 row_half_mirror row_mask:0xf bank_mask:0xf
  v_add_f32_dpp v169, v82, v161 row_half_mirror row_mask:0xf bank_mask:0xf
  v_sub_f32_dpp v82, v82, v161 row_half_mirror row_mask:0xf bank_mask:0xf
  v_add_f32_dpp v173, v165, v65 row_half_mirror row_mask:0xf bank_mask:0xf
  v_sub_f32_dpp v165, v165, v65 row_half_mirror row_mask:0xf bank_mask:0xf
  v_add_f32_dpp v170, v81, v162 row_half_mirror row_mask:0xf bank_mask:0xf
  v_sub_f32_dpp v81, v81, v162 row_half_mirror row_mask:0xf bank_mask:0xf
  v_add_f32_dpp v174, v166, v66 row_half_mirror row_mask:0xf bank_mask:0xf
  v_sub_f32_dpp v166, v166, v66 row_half_mirror row_mask:0xf bank_mask:0xf
  v_add_f32_dpp v171, v80, v163 row_half_mirror row_mask:0xf bank_mask:0xf
  v_sub_f32_dpp v80, v80, v163 row_half_mirror row_mask:0xf bank_mask:0xf
  v_add_f32_dpp v175, v167, v67 row_half_mirror row_mask:0xf bank_mask:0xf
  v_sub_f32_dpp v167, v167, v67 row_half_mirror row_mask:0xf bank_mask:0xf
  v_cvt_pk_bf16_f32 v64, v168, v172
  v_cvt_pk_bf16_f32 v65, v169, v173
  v_cvt_pk_bf16_f32 v66, v170, v174
  v_cvt_pk_bf16_f32 v67, v171, v175
  ds_write_b128 v10, v[64:67] offset:32768
  v_cvt_pk_bf16_f32 v160, v83, v164
  v_cvt_pk_bf16_f32 v161, v82, v165
  v_cvt_pk_bf16_f32 v162, v81, v166
  v_cvt_pk_bf16_f32 v163, v80, v167
  ds_write_b128 v10, v[160:163] offset:49152
  s_waitcnt vmcnt(10)
  v_lshlrev_b32 v180, 16, v87
  v_and_b32 v87, s46, v87
  v_lshlrev_b32 v181, 16, v86
  v_and_b32 v86, s46, v86
  v_lshlrev_b32 v182, 16, v85
  v_and_b32 v85, s46, v85
  v_lshlrev_b32 v183, 16, v84
  v_and_b32 v84, s46, v84
  v_lshlrev_b32 v176, 16, v68
  v_and_b32 v68, s46, v68
  v_lshlrev_b32 v177, 16, v69
  v_and_b32 v69, s46, v69
  v_lshlrev_b32 v178, 16, v70
  v_and_b32 v70, s46, v70
  v_lshlrev_b32 v179, 16, v71
  v_and_b32 v71, s46, v71
  v_add_f32_dpp v184, v87, v176 row_half_mirror row_mask:0xf bank_mask:0xf
  v_sub_f32_dpp v87, v87, v176 row_half_mirror row_mask:0xf bank_mask:0xf
  v_add_f32_dpp v188, v180, v68 row_half_mirror row_mask:0xf bank_mask:0xf
  v_sub_f32_dpp v180, v180, v68 row_half_mirror row_mask:0xf bank_mask:0xf
  v_add_f32_dpp v185, v86, v177 row_half_mirror row_mask:0xf bank_mask:0xf
  v_sub_f32_dpp v86, v86, v177 row_half_mirror row_mask:0xf bank_mask:0xf
  v_add_f32_dpp v189, v181, v69 row_half_mirror row_mask:0xf bank_mask:0xf
  v_sub_f32_dpp v181, v181, v69 row_half_mirror row_mask:0xf bank_mask:0xf
  v_add_f32_dpp v186, v85, v178 row_half_mirror row_mask:0xf bank_mask:0xf
  v_sub_f32_dpp v85, v85, v178 row_half_mirror row_mask:0xf bank_mask:0xf
  v_add_f32_dpp v190, v182, v70 row_half_mirror row_mask:0xf bank_mask:0xf
  v_sub_f32_dpp v182, v182, v70 row_half_mirror row_mask:0xf bank_mask:0xf
  v_add_f32_dpp v187, v84, v179 row_half_mirror row_mask:0xf bank_mask:0xf
  v_sub_f32_dpp v84, v84, v179 row_half_mirror row_mask:0xf bank_mask:0xf
  v_add_f32_dpp v191, v183, v71 row_half_mirror row_mask:0xf bank_mask:0xf
  v_sub_f32_dpp v183, v183, v71 row_half_mirror row_mask:0xf bank_mask:0xf
  v_cvt_pk_bf16_f32 v68, v184, v188
  v_cvt_pk_bf16_f32 v69, v185, v189
  v_cvt_pk_bf16_f32 v70, v186, v190
  v_cvt_pk_bf16_f32 v71, v187, v191
  ds_write_b128 v10, v[68:71] offset:33792
  v_cvt_pk_bf16_f32 v176, v87, v180
  v_cvt_pk_bf16_f32 v177, v86, v181
  v_cvt_pk_bf16_f32 v178, v85, v182
  v_cvt_pk_bf16_f32 v179, v84, v183
  ds_write_b128 v10, v[176:179] offset:50176
  s_waitcnt vmcnt(9)
  v_lshlrev_b32 v196, 16, v91
  v_and_b32 v91, s46, v91
  v_lshlrev_b32 v197, 16, v90
  v_and_b32 v90, s46, v90
  v_lshlrev_b32 v198, 16, v89
  v_and_b32 v89, s46, v89
  v_lshlrev_b32 v199, 16, v88
  v_and_b32 v88, s46, v88
  v_lshlrev_b32 v192, 16, v72
  v_and_b32 v72, s46, v72
  v_lshlrev_b32 v193, 16, v73
  v_and_b32 v73, s46, v73
  v_lshlrev_b32 v194, 16, v74
  v_and_b32 v74, s46, v74
  v_lshlrev_b32 v195, 16, v75
  v_and_b32 v75, s46, v75
  v_add_f32_dpp v200, v91, v192 row_half_mirror row_mask:0xf bank_mask:0xf
  v_sub_f32_dpp v91, v91, v192 row_half_mirror row_mask:0xf bank_mask:0xf
  v_add_f32_dpp v204, v196, v72 row_half_mirror row_mask:0xf bank_mask:0xf
  v_sub_f32_dpp v196, v196, v72 row_half_mirror row_mask:0xf bank_mask:0xf
  v_add_f32_dpp v201, v90, v193 row_half_mirror row_mask:0xf bank_mask:0xf
  v_sub_f32_dpp v90, v90, v193 row_half_mirror row_mask:0xf bank_mask:0xf
  v_add_f32_dpp v205, v197, v73 row_half_mirror row_mask:0xf bank_mask:0xf
  v_sub_f32_dpp v197, v197, v73 row_half_mirror row_mask:0xf bank_mask:0xf
  v_add_f32_dpp v202, v89, v194 row_half_mirror row_mask:0xf bank_mask:0xf
  v_sub_f32_dpp v89, v89, v194 row_half_mirror row_mask:0xf bank_mask:0xf
  v_add_f32_dpp v206, v198, v74 row_half_mirror row_mask:0xf bank_mask:0xf
  v_sub_f32_dpp v198, v198, v74 row_half_mirror row_mask:0xf bank_mask:0xf
  v_add_f32_dpp v203, v88, v195 row_half_mirror row_mask:0xf bank_mask:0xf
  v_sub_f32_dpp v88, v88, v195 row_half_mirror row_mask:0xf bank_mask:0xf
  v_add_f32_dpp v207, v199, v75 row_half_mirror row_mask:0xf bank_mask:0xf
  v_sub_f32_dpp v199, v199, v75 row_half_mirror row_mask:0xf bank_mask:0xf
  v_cvt_pk_bf16_f32 v72, v200, v204
  v_cvt_pk_bf16_f32 v73, v201, v205
  v_cvt_pk_bf16_f32 v74, v202, v206
  v_cvt_pk_bf16_f32 v75, v203, v207
  ds_write_b128 v10, v[72:75] offset:34816
  v_cvt_pk_bf16_f32 v192, v91, v196
  v_cvt_pk_bf16_f32 v193, v90, v197
  v_cvt_pk_bf16_f32 v194, v89, v198
  v_cvt_pk_bf16_f32 v195, v88, v199
  ds_write_b128 v10, v[192:195] offset:51200
  s_waitcnt vmcnt(8)
  v_lshlrev_b32 v212, 16, v95
  v_and_b32 v95, s46, v95
  v_lshlrev_b32 v213, 16, v94
  v_and_b32 v94, s46, v94
  v_lshlrev_b32 v214, 16, v93
  v_and_b32 v93, s46, v93
  v_lshlrev_b32 v215, 16, v92
  v_and_b32 v92, s46, v92
  v_lshlrev_b32 v208, 16, v76
  v_and_b32 v76, s46, v76
  v_lshlrev_b32 v209, 16, v77
  v_and_b32 v77, s46, v77
  v_lshlrev_b32 v210, 16, v78
  v_and_b32 v78, s46, v78
  v_lshlrev_b32 v211, 16, v79
  v_and_b32 v79, s46, v79
  v_add_f32_dpp v216, v95, v208 row_half_mirror row_mask:0xf bank_mask:0xf
  v_sub_f32_dpp v95, v95, v208 row_half_mirror row_mask:0xf bank_mask:0xf
  v_add_f32_dpp v220, v212, v76 row_half_mirror row_mask:0xf bank_mask:0xf
  v_sub_f32_dpp v212, v212, v76 row_half_mirror row_mask:0xf bank_mask:0xf
  v_add_f32_dpp v217, v94, v209 row_half_mirror row_mask:0xf bank_mask:0xf
  v_sub_f32_dpp v94, v94, v209 row_half_mirror row_mask:0xf bank_mask:0xf
  v_add_f32_dpp v221, v213, v77 row_half_mirror row_mask:0xf bank_mask:0xf
  v_sub_f32_dpp v213, v213, v77 row_half_mirror row_mask:0xf bank_mask:0xf
  v_add_f32_dpp v218, v93, v210 row_half_mirror row_mask:0xf bank_mask:0xf
  v_sub_f32_dpp v93, v93, v210 row_half_mirror row_mask:0xf bank_mask:0xf
  v_add_f32_dpp v222, v214, v78 row_half_mirror row_mask:0xf bank_mask:0xf
  v_sub_f32_dpp v214, v214, v78 row_half_mirror row_mask:0xf bank_mask:0xf
  v_add_f32_dpp v219, v92, v211 row_half_mirror row_mask:0xf bank_mask:0xf
  v_sub_f32_dpp v92, v92, v211 row_half_mirror row_mask:0xf bank_mask:0xf
  v_add_f32_dpp v223, v215, v79 row_half_mirror row_mask:0xf bank_mask:0xf
  v_sub_f32_dpp v215, v215, v79 row_half_mirror row_mask:0xf bank_mask:0xf
  v_cvt_pk_bf16_f32 v76, v216, v220
  v_cvt_pk_bf16_f32 v77, v217, v221
  v_cvt_pk_bf16_f32 v78, v218, v222
  v_cvt_pk_bf16_f32 v79, v219, v223
  ds_write_b128 v10, v[76:79] offset:35840
  v_cvt_pk_bf16_f32 v208, v95, v212
  v_cvt_pk_bf16_f32 v209, v94, v213
  v_cvt_pk_bf16_f32 v210, v93, v214
  v_cvt_pk_bf16_f32 v211, v92, v215
  ds_write_b128 v10, v[208:211] offset:52224
  s_waitcnt lgkmcnt(0)
  s_barrier
  buffer_load_dword v240, v241, s[56:59], 0 offen sc1
  s_waitcnt vmcnt(4)
  buffer_load_dwordx4 v[128:131], v6, s[20:23], s53 offen offset:384
  buffer_load_dwordx4 v[132:135], v7, s[20:23], s53 offen offset:384
  buffer_load_dwordx4 v[136:139], v8, s[20:23], s53 offen offset:384
  buffer_load_dwordx4 v[140:143], v9, s[20:23], s53 offen offset:384
  v_lshlrev_b32 v164, 16, v115
  v_and_b32 v115, s46, v115
  v_lshlrev_b32 v165, 16, v114
  v_and_b32 v114, s46, v114
  v_lshlrev_b32 v166, 16, v113
  v_and_b32 v113, s46, v113
  v_lshlrev_b32 v167, 16, v112
  v_and_b32 v112, s46, v112
  v_lshlrev_b32 v160, 16, v96
  v_and_b32 v96, s46, v96
  v_lshlrev_b32 v161, 16, v97
  v_and_b32 v97, s46, v97
  v_lshlrev_b32 v162, 16, v98
  v_and_b32 v98, s46, v98
  v_lshlrev_b32 v163, 16, v99
  v_and_b32 v99, s46, v99
  v_add_f32_dpp v168, v115, v160 row_half_mirror row_mask:0xf bank_mask:0xf
  v_sub_f32_dpp v115, v115, v160 row_half_mirror row_mask:0xf bank_mask:0xf
  v_add_f32_dpp v172, v164, v96 row_half_mirror row_mask:0xf bank_mask:0xf
  v_sub_f32_dpp v164, v164, v96 row_half_mirror row_mask:0xf bank_mask:0xf
  v_add_f32_dpp v169, v114, v161 row_half_mirror row_mask:0xf bank_mask:0xf
  v_sub_f32_dpp v114, v114, v161 row_half_mirror row_mask:0xf bank_mask:0xf
  v_add_f32_dpp v173, v165, v97 row_half_mirror row_mask:0xf bank_mask:0xf
  v_sub_f32_dpp v165, v165, v97 row_half_mirror row_mask:0xf bank_mask:0xf
  v_add_f32_dpp v170, v113, v162 row_half_mirror row_mask:0xf bank_mask:0xf
  v_sub_f32_dpp v113, v113, v162 row_half_mirror row_mask:0xf bank_mask:0xf
  v_add_f32_dpp v174, v166, v98 row_half_mirror row_mask:0xf bank_mask:0xf
  v_sub_f32_dpp v166, v166, v98 row_half_mirror row_mask:0xf bank_mask:0xf
  v_add_f32_dpp v171, v112, v163 row_half_mirror row_mask:0xf bank_mask:0xf
  v_sub_f32_dpp v112, v112, v163 row_half_mirror row_mask:0xf bank_mask:0xf
  v_add_f32_dpp v175, v167, v99 row_half_mirror row_mask:0xf bank_mask:0xf
  v_sub_f32_dpp v167, v167, v99 row_half_mirror row_mask:0xf bank_mask:0xf
  v_cvt_pk_bf16_f32 v96, v168, v172
  v_cvt_pk_bf16_f32 v97, v169, v173
  v_cvt_pk_bf16_f32 v98, v170, v174
  v_cvt_pk_bf16_f32 v99, v171, v175
  ds_write_b128 v11, v[96:99] offset:0
  v_cvt_pk_bf16_f32 v160, v115, v164
  v_cvt_pk_bf16_f32 v161, v114, v165
  v_cvt_pk_bf16_f32 v162, v113, v166
  v_cvt_pk_bf16_f32 v163, v112, v167
  ds_write_b128 v11, v[160:163] offset:16384
  s_waitcnt vmcnt(7)
  v_lshlrev_b32 v180, 16, v119
  v_and_b32 v119, s46, v119
  v_lshlrev_b32 v181, 16, v118
  v_and_b32 v118, s46, v118
  v_lshlrev_b32 v182, 16, v117
  v_and_b32 v117, s46, v117
  v_lshlrev_b32 v183, 16, v116
  v_and_b32 v116, s46, v116
  v_lshlrev_b32 v176, 16, v100
  v_and_b32 v100, s46, v100
  v_lshlrev_b32 v177, 16, v101
  v_and_b32 v101, s46, v101
  v_lshlrev_b32 v178, 16, v102
  v_and_b32 v102, s46, v102
  v_lshlrev_b32 v179, 16, v103
  v_and_b32 v103, s46, v103
  v_add_f32_dpp v184, v119, v176 row_half_mirror row_mask:0xf bank_mask:0xf
  v_sub_f32_dpp v119, v119, v176 row_half_mirror row_mask:0xf bank_mask:0xf
  v_add_f32_dpp v188, v180, v100 row_half_mirror row_mask:0xf bank_mask:0xf
  v_sub_f32_dpp v180, v180, v100 row_half_mirror row_mask:0xf bank_mask:0xf
  v_add_f32_dpp v185, v118, v177 row_half_mirror row_mask:0xf bank_mask:0xf
  v_sub_f32_dpp v118, v118, v177 row_half_mirror row_mask:0xf bank_mask:0xf
  v_add_f32_dpp v189, v181, v101 row_half_mirror row_mask:0xf bank_mask:0xf
  v_sub_f32_dpp v181, v181, v101 row_half_mirror row_mask:0xf bank_mask:0xf
  v_add_f32_dpp v186, v117, v178 row_half_mirror row_mask:0xf bank_mask:0xf
  v_sub_f32_dpp v117, v117, v178 row_half_mirror row_mask:0xf bank_mask:0xf
  v_add_f32_dpp v190, v182, v102 row_half_mirror row_mask:0xf bank_mask:0xf
  v_sub_f32_dpp v182, v182, v102 row_half_mirror row_mask:0xf bank_mask:0xf
  v_add_f32_dpp v187, v116, v179 row_half_mirror row_mask:0xf bank_mask:0xf
  v_sub_f32_dpp v116, v116, v179 row_half_mirror row_mask:0xf bank_mask:0xf
  v_add_f32_dpp v191, v183, v103 row_half_mirror row_mask:0xf bank_mask:0xf
  v_sub_f32_dpp v183, v183, v103 row_half_mirror row_mask:0xf bank_mask:0xf
  v_cvt_pk_bf16_f32 v100, v184, v188
  v_cvt_pk_bf16_f32 v101, v185, v189
  v_cvt_pk_bf16_f32 v102, v186, v190
  v_cvt_pk_bf16_f32 v103, v187, v191
  ds_write_b128 v11, v[100:103] offset:1024
  v_cvt_pk_bf16_f32 v176, v119, v180
  v_cvt_pk_bf16_f32 v177, v118, v181
  v_cvt_pk_bf16_f32 v178, v117, v182
  v_cvt_pk_bf16_f32 v179, v116, v183
  ds_write_b128 v11, v[176:179] offset:17408
  s_waitcnt vmcnt(6)
  v_lshlrev_b32 v196, 16, v123
  v_and_b32 v123, s46, v123
  v_lshlrev_b32 v197, 16, v122
  v_and_b32 v122, s46, v122
  v_lshlrev_b32 v198, 16, v121
  v_and_b32 v121, s46, v121
  v_lshlrev_b32 v199, 16, v120
  v_and_b32 v120, s46, v120
  v_lshlrev_b32 v192, 16, v104
  v_and_b32 v104, s46, v104
  v_lshlrev_b32 v193, 16, v105
  v_and_b32 v105, s46, v105
  v_lshlrev_b32 v194, 16, v106
  v_and_b32 v106, s46, v106
  v_lshlrev_b32 v195, 16, v107
  v_and_b32 v107, s46, v107
  v_add_f32_dpp v200, v123, v192 row_half_mirror row_mask:0xf bank_mask:0xf
  v_sub_f32_dpp v123, v123, v192 row_half_mirror row_mask:0xf bank_mask:0xf
  v_add_f32_dpp v204, v196, v104 row_half_mirror row_mask:0xf bank_mask:0xf
  v_sub_f32_dpp v196, v196, v104 row_half_mirror row_mask:0xf bank_mask:0xf
  v_add_f32_dpp v201, v122, v193 row_half_mirror row_mask:0xf bank_mask:0xf
  v_sub_f32_dpp v122, v122, v193 row_half_mirror row_mask:0xf bank_mask:0xf
  v_add_f32_dpp v205, v197, v105 row_half_mirror row_mask:0xf bank_mask:0xf
  v_sub_f32_dpp v197, v197, v105 row_half_mirror row_mask:0xf bank_mask:0xf
  v_add_f32_dpp v202, v121, v194 row_half_mirror row_mask:0xf bank_mask:0xf
  v_sub_f32_dpp v121, v121, v194 row_half_mirror row_mask:0xf bank_mask:0xf
  v_add_f32_dpp v206, v198, v106 row_half_mirror row_mask:0xf bank_mask:0xf
  v_sub_f32_dpp v198, v198, v106 row_half_mirror row_mask:0xf bank_mask:0xf
  v_add_f32_dpp v203, v120, v195 row_half_mirror row_mask:0xf bank_mask:0xf
  v_sub_f32_dpp v120, v120, v195 row_half_mirror row_mask:0xf bank_mask:0xf
  v_add_f32_dpp v207, v199, v107 row_half_mirror row_mask:0xf bank_mask:0xf
  v_sub_f32_dpp v199, v199, v107 row_half_mirror row_mask:0xf bank_mask:0xf
  v_cvt_pk_bf16_f32 v104, v200, v204
  v_cvt_pk_bf16_f32 v105, v201, v205
  v_cvt_pk_bf16_f32 v106, v202, v206
  v_cvt_pk_bf16_f32 v107, v203, v207
  ds_write_b128 v11, v[104:107] offset:2048
  v_cvt_pk_bf16_f32 v192, v123, v196
  v_cvt_pk_bf16_f32 v193, v122, v197
  v_cvt_pk_bf16_f32 v194, v121, v198
  v_cvt_pk_bf16_f32 v195, v120, v199
  ds_write_b128 v11, v[192:195] offset:18432
  s_waitcnt vmcnt(5)
  v_lshlrev_b32 v212, 16, v127
  v_and_b32 v127, s46, v127
  v_lshlrev_b32 v213, 16, v126
  v_and_b32 v126, s46, v126
  v_lshlrev_b32 v214, 16, v125
  v_and_b32 v125, s46, v125
  v_lshlrev_b32 v215, 16, v124
  v_and_b32 v124, s46, v124
  v_lshlrev_b32 v208, 16, v108
  v_and_b32 v108, s46, v108
  v_lshlrev_b32 v209, 16, v109
  v_and_b32 v109, s46, v109
  v_lshlrev_b32 v210, 16, v110
  v_and_b32 v110, s46, v110
  v_lshlrev_b32 v211, 16, v111
  v_and_b32 v111, s46, v111
  v_add_f32_dpp v216, v127, v208 row_half_mirror row_mask:0xf bank_mask:0xf
  v_sub_f32_dpp v127, v127, v208 row_half_mirror row_mask:0xf bank_mask:0xf
  v_add_f32_dpp v220, v212, v108 row_half_mirror row_mask:0xf bank_mask:0xf
  v_sub_f32_dpp v212, v212, v108 row_half_mirror row_mask:0xf bank_mask:0xf
  v_add_f32_dpp v217, v126, v209 row_half_mirror row_mask:0xf bank_mask:0xf
  v_sub_f32_dpp v126, v126, v209 row_half_mirror row_mask:0xf bank_mask:0xf
  v_add_f32_dpp v221, v213, v109 row_half_mirror row_mask:0xf bank_mask:0xf
  v_sub_f32_dpp v213, v213, v109 row_half_mirror row_mask:0xf bank_mask:0xf
  v_add_f32_dpp v218, v125, v210 row_half_mirror row_mask:0xf bank_mask:0xf
  v_sub_f32_dpp v125, v125, v210 row_half_mirror row_mask:0xf bank_mask:0xf
  v_add_f32_dpp v222, v214, v110 row_half_mirror row_mask:0xf bank_mask:0xf
  v_sub_f32_dpp v214, v214, v110 row_half_mirror row_mask:0xf bank_mask:0xf
  v_add_f32_dpp v219, v124, v211 row_half_mirror row_mask:0xf bank_mask:0xf
  v_sub_f32_dpp v124, v124, v211 row_half_mirror row_mask:0xf bank_mask:0xf
  v_add_f32_dpp v223, v215, v111 row_half_mirror row_mask:0xf bank_mask:0xf
  v_sub_f32_dpp v215, v215, v111 row_half_mirror row_mask:0xf bank_mask:0xf
  v_cvt_pk_bf16_f32 v108, v216, v220
  v_cvt_pk_bf16_f32 v109, v217, v221
  v_cvt_pk_bf16_f32 v110, v218, v222
  v_cvt_pk_bf16_f32 v111, v219, v223
  ds_write_b128 v11, v[108:111] offset:3072
  v_cvt_pk_bf16_f32 v208, v127, v212
  v_cvt_pk_bf16_f32 v209, v126, v213
  v_cvt_pk_bf16_f32 v210, v125, v214
  v_cvt_pk_bf16_f32 v211, v124, v215
  ds_write_b128 v11, v[208:211] offset:19456
  s_waitcnt vmcnt(4)
  s_mov_b32 s3, 0
  s_branch pl2_chk
pl2:
  buffer_load_dword v240, v241, s[56:59], 0 offen sc1
  s_waitcnt vmcnt(0)
pl2_chk:
  v_cmp_eq_u32 vcc, 0, v240
  s_add_u32 s3, s3, 1
  s_cbranch_vccz pl2_ok
  s_sleep 8
  s_cmp_lt_u32 s3, 200000
  s_cbranch_scc1 pl2
pl2_ok:
  s_bitcmp1_b32 s17, 0
  s_cselect_b32 s28, s38, s36
  s_cselect_b32 s29, s39, s37
  s_mov_b32 s30, 921600
  s_mov_b32 s31, 0x20000
  s_waitcnt lgkmcnt(0)
  s_barrier
  s_waitcnt vmcnt(3)
  v_lshlrev_b32 v160, 16, v128
  v_and_b32 v128, s46, v128
  v_lshlrev_b32 v161, 16, v129
  v_and_b32 v129, s46, v129
  v_lshlrev_b32 v162, 16, v130
  v_and_b32 v130, s46, v130
  v_lshlrev_b32 v163, 16, v131
  v_and_b32 v131, s46, v131
  s_nop 1
  v_add_f32_dpp v168, v131, v160 row_half_mirror row_mask:0xf bank_mask:0x5
  v_add_f32_dpp v172, v163, v128 row_half_mirror row_mask:0xf bank_mask:0x5
  v_add_f32_dpp v169, v130, v161 row_half_mirror row_mask:0xf bank_mask:0x5
  v_add_f32_dpp v173, v162, v129 row_half_mirror row_mask:0xf bank_mask:0x5
  v_add_f32_dpp v170, v129, v162 row_half_mirror row_mask:0xf bank_mask:0x5
  v_add_f32_dpp v174, v161, v130 row_half_mirror row_mask:0xf bank_mask:0x5
  v_add_f32_dpp v171, v128, v163 row_half_mirror row_mask:0xf bank_mask:0x5
  v_add_f32_dpp v175, v160, v131 row_half_mirror row_mask:0xf bank_mask:0x5
  v_subrev_f32_dpp v168, v131, v160 row_half_mirror row_mask:0xf bank_mask:0xa
  v_subrev_f32_dpp v172, v163, v128 row_half_mirror row_mask:0xf bank_mask:0xa
  v_subrev_f32_dpp v169, v130, v161 row_half_mirror row_mask:0xf bank_mask:0xa
  v_subrev_f32_dpp v173, v162, v129 row_half_mirror row_mask:0xf bank_mask:0xa
  v_subrev_f32_dpp v170, v129, v162 row_half_mirror row_mask:0xf bank_mask:0xa
  v_subrev_f32_dpp v174, v161, v130 row_half_mirror row_mask:0xf bank_mask:0xa
  v_subrev_f32_dpp v171, v128, v163 row_half_mirror row_mask:0xf bank_mask:0xa
  v_subrev_f32_dpp v175, v160, v131 row_half_mirror row_mask:0xf bank_mask:0xa
  v_cvt_pk_bf16_f32 v164, v168, v172
  v_cvt_pk_bf16_f32 v165, v169, v173
  v_cvt_pk_bf16_f32 v166, v170, v174
  v_cvt_pk_bf16_f32 v167, v171, v175
  ds_write_b128 v11, v[164:167] offset:32768
  s_waitcnt vmcnt(2)
  v_lshlrev_b32 v176, 16, v132
  v_and_b32 v132, s46, v132
  v_lshlrev_b32 v177, 16, v133
  v_and_b32 v133, s46, v133
  v_lshlrev_b32 v178, 16, v134
  v_and_b32 v134, s46, v134
  v_lshlrev_b32 v179, 16, v135
  v_and_b32 v135, s46, v135
  s_nop 1
  v_add_f32_dpp v184, v135, v176 row_half_mirror row_mask:0xf bank_mask:0xa
  v_add_f32_dpp v188, v179, v132 row_half_mirror row_mask:0xf bank_mask:0xa
  v_add_f32_dpp v185, v134, v177 row_half_mirror row_mask:0xf bank_mask:0xa
  v_add_f32_dpp v189, v178, v133 row_half_mirror row_mask:0xf bank_mask:0xa
  v_add_f32_dpp v186, v133, v178 row_half_mirror row_mask:0xf bank_mask:0xa
  v_add_f32_dpp v190, v177, v134 row_half_mirror row_mask:0xf bank_mask:0xa
  v_add_f32_dpp v187, v132, v179 row_half_mirror row_mask:0xf bank_mask:0xa
  v_add_f32_dpp v191, v176, v135 row_half_mirror row_mask:0xf bank_mask:0xa
  v_subrev_f32_dpp v184, v135, v176 row_half_mirror row_mask:0xf bank_mask:0x5
  v_subrev_f32_dpp v188, v179, v132 row_half_mirror row_mask:0xf bank_mask:0x5
  v_subrev_f32_dpp v185, v134, v177 row_half_mirror row_mask:0xf bank_mask:0x5
  v_subrev_f32_dpp v189, v178, v133 row_half_mirror row_mask:0xf bank_mask:0x5
  v_subrev_f32_dpp v186, v133, v178 row_half_mirror row_mask:0xf bank_mask:0x5
  v_subrev_f32_dpp v190, v177, v134 row_half_mirror row_mask:0xf bank_mask:0x5
  v_subrev_f32_dpp v187, v132, v179 row_half_mirror row_mask:0xf bank_mask:0x5
  v_subrev_f32_dpp v191, v176, v135 row_half_mirror row_mask:0xf bank_mask:0x5
  v_cvt_pk_bf16_f32 v180, v184, v188
  v_cvt_pk_bf16_f32 v181, v185, v189
  v_cvt_pk_bf16_f32 v182, v186, v190
  v_cvt_pk_bf16_f32 v183, v187, v191
  ds_write_b128 v11, v[180:183] offset:33792
  s_waitcnt vmcnt(1)
  v_lshlrev_b32 v192, 16, v136
  v_and_b32 v136, s46, v136
  v_lshlrev_b32 v193, 16, v137
  v_and_b32 v137, s46, v137
  v_lshlrev_b32 v194, 16, v138
  v_and_b32 v138, s46, v138
  v_lshlrev_b32 v195, 16, v139
  v_and_b32 v139, s46, v139
  s_nop 1
  v_add_f32_dpp v200, v139, v192 row_half_mirror row_mask:0xf bank_mask:0x5
  v_add_f32_dpp v204, v195, v136 row_half_mirror row_mask:0xf bank_mask:0x5
  v_add_f32_dpp v201, v138, v193 row_half_mirror row_mask:0xf bank_mask:0x5
  v_add_f32_dpp v205, v194, v137 row_half_mirror row_mask:0xf bank_mask:0x5
  v_add_f32_dpp v202, v137, v194 row_half_mirror row_mask:0xf bank_mask:0x5
  v_add_f32_dpp v206, v193, v138 row_half_mirror row_mask:0xf bank_mask:0x5
  v_add_f32_dpp v203, v136, v195 row_half_mirror row_mask:0xf bank_mask:0x5
  v_add_f32_dpp v207, v192, v139 row_half_mirror row_mask:0xf bank_mask:0x5
  v_subrev_f32_dpp v200, v139, v192 row_half_mirror row_mask:0xf bank_mask:0xa
  v_subrev_f32_dpp v204, v195, v136 row_half_mirror row_mask:0xf bank_mask:0xa
  v_subrev_f32_dpp v201, v138, v193 row_half_mirror row_mask:0xf bank_mask:0xa
  v_subrev_f32_dpp v205, v194, v137 row_half_mirror row_mask:0xf bank_mask:0xa
  v_subrev_f32_dpp v202, v137, v194 row_half_mirror row_mask:0xf bank_mask:0xa
  v_subrev_f32_dpp v206, v193, v138 row_half_mirror row_mask:0xf bank_mask:0xa
  v_subrev_f32_dpp v203, v136, v195 row_half_mirror row_mask:0xf bank_mask:0xa
  v_subrev_f32_dpp v207, v192, v139 row_half_mirror row_mask:0xf bank_mask:0xa
  v_cvt_pk_bf16_f32 v196, v200, v204
  v_cvt_pk_bf16_f32 v197, v201, v205
  v_cvt_pk_bf16_f32 v198, v202, v206
  v_cvt_pk_bf16_f32 v199, v203, v207
  ds_write_b128 v11, v[196:199] offset:34816
  buffer_load_dwordx4 v[12:15], v242, s[24:27], s52 offen sc1
  s_waitcnt vmcnt(1)
  v_lshlrev_b32 v208, 16, v140
  v_and_b32 v140, s46, v140
  v_lshlrev_b32 v209, 16, v141
  v_and_b32 v141, s46, v141
  v_lshlrev_b32 v210, 16, v142
  v_and_b32 v142, s46, v142
  v_lshlrev_b32 v211, 16, v143
  v_and_b32 v143, s46, v143
  s_nop 1
  v_add_f32_dpp v216, v143, v208 row_half_mirror row_mask:0xf bank_mask:0xa
  v_add_f32_dpp v220, v211, v140 row_half_mirror row_mask:0xf bank_mask:0xa
  v_add_f32_dpp v217, v142, v209 row_half_mirror row_mask:0xf bank_mask:0xa
  v_add_f32_dpp v221, v210, v141 row_half_mirror row_mask:0xf bank_mask:0xa
  v_add_f32_dpp v218, v141, v210 row_half_mirror row_mask:0xf bank_mask:0xa
  v_add_f32_dpp v222, v209, v142 row_half_mirror row_mask:0xf bank_mask:0xa
  v_add_f32_dpp v219, v140, v211 row_half_mirror row_mask:0xf bank_mask:0xa
  v_add_f32_dpp v223, v208, v143 row_half_mirror row_mask:0xf bank_mask:0xa
  v_subrev_f32_dpp v216, v143, v208 row_half_mirror row_mask:0xf bank_mask:0x5
  v_subrev_f32_dpp v220, v211, v140 row_half_mirror row_mask:0xf bank_mask:0x5
  v_subrev_f32_dpp v217, v142, v209 row_half_mirror row_mask:0xf bank_mask:0x5
  v_subrev_f32_dpp v221, v210, v141 row_half_mirror row_mask:0xf bank_mask:0x5
  v_subrev_f32_dpp v218, v141, v210 row_half_mirror row_mask:0xf bank_mask:0x5
  v_subrev_f32_dpp v222, v209, v142 row_half_mirror row_mask:0xf bank_mask:0x5
  v_subrev_f32_dpp v219, v140, v211 row_half_mirror row_mask:0xf bank_mask:0x5
  v_subrev_f32_dpp v223, v208, v143 row_half_mirror row_mask:0xf bank_mask:0x5
  v_cvt_pk_bf16_f32 v212, v216, v220
  v_cvt_pk_bf16_f32 v213, v217, v221
  v_cvt_pk_bf16_f32 v214, v218, v222
  v_cvt_pk_bf16_f32 v215, v219, v223
  ds_write_b128 v11, v[212:215] offset:35840
  s_waitcnt lgkmcnt(0)
  s_barrier
  s_add_u32 m0, s54, 0
  s_nop 0
  buffer_load_dwordx4 v224, s[28:31], 0 offen lds
  s_add_u32 m0, s54, 1088
  s_nop 0
  buffer_load_dwordx4 v225, s[28:31], 0 offen lds
  s_add_u32 m0, s54, 2176
  s_nop 0
  buffer_load_dwordx4 v226, s[28:31], 0 offen lds
  s_add_u32 m0, s54, 3264
  s_nop 0
  buffer_load_dwordx4 v227, s[28:31], 0 offen lds
  s_mov_b32 s3, 0
  s_waitcnt vmcnt(4)
  s_branch fa_rc
fa_rl:
  buffer_load_dwordx4 v[12:15], v242, s[24:27], s52 offen sc1
  s_waitcnt vmcnt(0)
fa_rc:
  v_cmp_eq_u32 vcc, 0, v15
  s_add_u32 s3, s3, 1
  s_cbranch_vccz fa_rk
  s_cmp_lt_u32 s3, 200000
  s_cbranch_scc1 fa_rl
fa_rk:
  ds_write_b32 v4, v15
  v_and_b32 v13, s46, v13
  ds_write_b32 v4, v13 offset:512
  s_add_u32 m0, s54, 4352
  s_nop 0
  buffer_load_dwordx4 v228, s[28:31], 0 offen lds
  s_add_u32 m0, s54, 5440
  s_nop 0
  buffer_load_dwordx4 v229, s[28:31], 0 offen lds
  s_add_u32 m0, s54, 6528
  s_nop 0
  buffer_load_dwordx4 v230, s[28:31], 0 offen lds
  s_add_u32 m0, s54, 7616
  s_nop 0
  buffer_load_dwordx4 v231, s[28:31], 0 offen lds
  s_waitcnt lgkmcnt(0)
  s_barrier
  s_add_u32 m0, s54, 8704
  s_nop 0
  buffer_load_dwordx4 v232, s[28:31], 0 offen lds
  s_add_u32 m0, s54, 9792
  s_nop 0
  buffer_load_dwordx4 v233, s[28:31], 0 offen lds
  s_add_u32 m0, s54, 10880
  s_nop 0
  buffer_load_dwordx4 v234, s[28:31], 0 offen lds
  s_add_u32 m0, s54, 11968
  s_nop 0
  buffer_load_dwordx4 v235, s[28:31], 0 offen lds
  s_add_u32 m0, s54, 13056
  s_nop 0
  buffer_load_dwordx4 v236, s[28:31], 0 offen lds
  s_add_u32 m0, s54, 14144
  s_nop 0
  buffer_load_dwordx4 v237, s[28:31], 0 offen lds
  s_add_u32 m0, s54, 15232
  s_nop 0
  buffer_load_dwordx4 v238, s[28:31], 0 offen lds
  s_add_u32 m0, s54, 16320
  s_nop 0
  buffer_load_dwordx4 v239, s[28:31], 0 offen lds
  s_mov_b64 exec, 0
  s_cmp_eq_u32 s17, 0
  s_cbranch_scc1 dry0
  s_cmp_eq_u32 s17, 1
  s_cbranch_scc1 dry1
  s_cmp_eq_u32 s17, 2
  s_cbranch_scc1 dry2
  s_branch dry3
dry_ret:
  s_nop 7
  s_nop 7
  s_mov_b64 exec, -1
  s_waitcnt vmcnt(0)
amid_main:
  v_mov_b32 v252, 1
  v_mov_b32 v253, 0
  s_barrier
  v_lshlrev_b32 v246, 4, v254
  v_add_u32 v246, 139264, v246
  v_lshlrev_b32 v247, 3, v254
  v_add_u32 v247, 139264, v247
  v_mov_b64 v[64:65], 0
  v_mov_b64 v[66:67], 0
  v_mov_b64 v[68:69], 0
  v_mov_b64 v[70:71], 0
  v_mov_b64 v[72:73], 0
  v_mov_b64 v[74:75], 0
  v_mov_b64 v[76:77], 0
  v_mov_b64 v[78:79], 0
  v_mov_b64 v[80:81], 0
  v_mov_b64 v[82:83], 0
  v_mov_b64 v[84:85], 0
  v_mov_b64 v[86:87], 0
  v_mov_b64 v[88:89], 0
  v_mov_b64 v[90:91], 0
  v_mov_b64 v[92:93], 0
  v_mov_b64 v[94:95], 0
  v_mov_b64 v[96:97], 0
  v_mov_b64 v[98:99], 0
  v_mov_b64 v[100:101], 0
  v_mov_b64 v[102:103], 0
  v_mov_b64 v[104:105], 0
  v_mov_b64 v[106:107], 0
  v_mov_b64 v[108:109], 0
  v_mov_b64 v[110:111], 0
  v_mov_b64 v[112:113], 0
  v_mov_b64 v[114:115], 0
  v_mov_b64 v[116:117], 0
  v_mov_b64 v[118:119], 0
  v_mov_b64 v[120:121], 0
  v_mov_b64 v[122:123], 0
  v_mov_b64 v[124:125], 0
  v_mov_b64 v[126:127], 0
  ds_read_b128 v[160:163], v246 offset:0
  ds_read_b64 v[164:165], v247 offset:1024
  ds_read_b128 v[166:169], v246 offset:1536
  ds_read_b64 v[170:171], v247 offset:2560
  ds_read_b128 v[172:175], v246 offset:3072
  ds_read_b64 v[176:177], v247 offset:4096
  ds_read_b128 v[178:181], v246 offset:4608
  ds_read_b64 v[182:183], v247 offset:5632
  ds_read_b128 v[184:187], v246 offset:6144
  ds_read_b64 v[188:189], v247 offset:7168
  ds_read_b128 v[190:193], v246 offset:7680
  ds_read_b64 v[194:195], v247 offset:8704
  ds_read_b128 v[196:199], v246 offset:9216
  ds_read_b64 v[200:201], v247 offset:10240
  ds_read_b128 v[202:205], v246 offset:10752
  ds_read_b64 v[206:207], v247 offset:11776
  v_mul_u32_u24 v248, 1088, v245
  v_lshl_add_u32 v248, v244, 1, v248
  s_and_b32 s20, s14, 7
  s_and_b32 s21, s44, 7
  s_lshl4_add_u32 s20, s17, s20
  s_lshl4_add_u32 s21, s17, s21
  s_lshl1_add_u32 s20, s20, 2048
  s_lshl1_add_u32 s21, s21, 36864
  v_add_u32 v249, s21, v248
  v_add_u32 v248, s20, v248
  s_cmp_eq_u32 s18, 7
  s_cselect_b32 s20, 1, 0
  s_cmp_eq_u32 s15, 0
  s_cselect_b32 s20, s20, 0
  s_cmp_lg_u32 s20, 0
  s_cbranch_scc1 f_end
  v_lshlrev_b32 v251, 13, v245
  v_lshl_add_u32 v251, v244, 4, v251
  s_lshl_b32 s19, s14, 17
  s_lshl_b32 s20, s15, 11
  s_add_u32 s19, s19, s20
  s_lshl_b32 s20, s17, 8
  s_add_u32 s19, s19, s20
  s_add_u32 s19, s19, 8388608
  s_lshl_b32 s21, s15, 10
  s_add_u32 s21, s21, 19922944
  v_lshlrev_b32 v253, 11, v244
  v_lshl_add_u32 v253, v245, 2, v253
  v_lshlrev_b32 v240, 17, v245
  v_lshl_add_u32 v240, v244, 2, v240
  v_add_u32 v241, 32768, v240
  v_add_u32 v242, 65536, v240
  v_add_u32 v243, 98304, v240
  s_lshl_b32 s22, s14, 11
  s_lshl_b32 s20, s18, 6
  s_add_u32 s22, s22, s20
  s_add_u32 s22, s22, 12582912
  s_cmp_eq_u32 s14, 0
  s_cselect_b32 s42, 0, 1.0
  s_mov_b32 s43, s42
  s_cmp_lg_u32 s17, 0
  s_cbranch_scc1 amid_np
  s_mov_b32 s3, 0
pl3:
  buffer_load_dword v255, v253, s[24:27], s21 offen sc1
  s_waitcnt vmcnt(0)
  v_cmp_eq_u32 vcc, 0, v255
  s_add_u32 s3, s3, 1
  s_cbranch_vccz pl3_ok
  s_sleep 2
  s_cmp_lt_u32 s3, 200000
  s_cbranch_scc1 pl3
pl3_ok:
amid_np:
  s_waitcnt vmcnt(0) lgkmcnt(0)
  s_barrier
  s_add_u32 s20, s19, 4096
  buffer_load_dwordx4 v[128:131], v251, s[24:27], s19 offen sc1
  buffer_load_dwordx4 v[144:147], v251, s[24:27], s20 offen sc1
  s_add_u32 s19, s19, 32768
  s_add_u32 s20, s20, 32768
  buffer_load_dwordx4 v[132:135], v251, s[24:27], s19 offen sc1
  buffer_load_dwordx4 v[148:151], v251, s[24:27], s20 offen sc1
  s_add_u32 s19, s19, 32768
  s_add_u32 s20, s20, 32768
  buffer_load_dwordx4 v[136:139], v251, s[24:27], s19 offen sc1
  buffer_load_dwordx4 v[152:155], v251, s[24:27], s20 offen sc1
  s_add_u32 s19, s19, 32768
  s_add_u32 s20, s20, 32768
  buffer_load_dwordx4 v[140:143], v251, s[24:27], s19 offen sc1
  buffer_load_dwordx4 v[156:159], v251, s[24:27], s20 offen sc1
  ds_read_u16_d16_hi v64, v248 offset:0
  ds_read_u16_d16_hi v65, v248 offset:256
  ds_read_u16_d16_hi v66, v248 offset:512
  ds_read_u16_d16_hi v67, v248 offset:768
  ds_read_u16_d16_hi v80, v248 offset:17408
  ds_read_u16_d16_hi v81, v248 offset:17664
  ds_read_u16_d16_hi v82, v248 offset:17920
  ds_read_u16_d16_hi v83, v248 offset:18176
  ds_read_u16_d16_hi v96, v249 offset:0
  ds_read_u16_d16_hi v97, v249 offset:256
  ds_read_u16_d16_hi v98, v249 offset:512
  ds_read_u16_d16_hi v99, v249 offset:768
  ds_read_u16_d16_hi v112, v249 offset:17408
  ds_read_u16_d16_hi v113, v249 offset:17664
  ds_read_u16_d16_hi v114, v249 offset:17920
  ds_read_u16_d16_hi v115, v249 offset:18176
  ds_read_u16_d16_hi v68, v248 offset:4352
  ds_read_u16_d16_hi v69, v248 offset:4608
  ds_read_u16_d16_hi v70, v248 offset:4864
  ds_read_u16_d16_hi v71, v248 offset:5120
  ds_read_u16_d16_hi v84, v248 offset:21760
  ds_read_u16_d16_hi v85, v248 offset:22016
  ds_read_u16_d16_hi v86, v248 offset:22272
  ds_read_u16_d16_hi v87, v248 offset:22528
  ds_read_u16_d16_hi v100, v249 offset:4352
  ds_read_u16_d16_hi v101, v249 offset:4608
  ds_read_u16_d16_hi v102, v249 offset:4864
  ds_read_u16_d16_hi v103, v249 offset:5120
  ds_read_u16_d16_hi v116, v249 offset:21760
  ds_read_u16_d16_hi v117, v249 offset:22016
  ds_read_u16_d16_hi v118, v249 offset:22272
  ds_read_u16_d16_hi v119, v249 offset:22528
  ds_read_u16_d16_hi v72, v248 offset:8704
  ds_read_u16_d16_hi v73, v248 offset:8960
  ds_read_u16_d16_hi v74, v248 offset:9216
  ds_read_u16_d16_hi v75, v248 offset:9472
  ds_read_u16_d16_hi v88, v248 offset:26112
  ds_read_u16_d16_hi v89, v248 offset:26368
  ds_read_u16_d16_hi v90, v248 offset:26624
  ds_read_u16_d16_hi v91, v248 offset:26880
  ds_read_u16_d16_hi v104, v249 offset:8704
  ds_read_u16_d16_hi v105, v249 offset:8960
  ds_read_u16_d16_hi v106, v249 offset:9216
  ds_read_u16_d16_hi v107, v249 offset:9472
  ds_read_u16_d16_hi v120, v249 offset:26112
  ds_read_u16_d16_hi v121, v249 offset:26368
  ds_read_u16_d16_hi v122, v249 offset:26624
  ds_read_u16_d16_hi v123, v249 offset:26880
  ds_read_u16_d16_hi v76, v248 offset:13056
  ds_read_u16_d16_hi v77, v248 offset:13312
  ds_read_u16_d16_hi v78, v248 offset:13568
  ds_read_u16_d16_hi v79, v248 offset:13824
  ds_read_u16_d16_hi v92, v248 offset:30464
  ds_read_u16_d16_hi v93, v248 offset:30720
  ds_read_u16_d16_hi v94, v248 offset:30976
  ds_read_u16_d16_hi v95, v248 offset:31232
  ds_read_u16_d16_hi v108, v249 offset:13056
  ds_read_u16_d16_hi v109, v249 offset:13312
  ds_read_u16_d16_hi v110, v249 offset:13568
  ds_read_u16_d16_hi v111, v249 offset:13824
  ds_read_u16_d16_hi v124, v249 offset:30464
  ds_read_u16_d16_hi v125, v249 offset:30720
  ds_read_u16_d16_hi v126, v249 offset:30976
  ds_read_u16_d16_hi v127, v249 offset:31232
dry0:
  s_waitcnt vmcnt(6)
  v_swap_b32 v129, v144
  v_swap_b32 v131, v146
  s_nop 1
  v_mfma_f32_16x16x32_bf16 v[0:3], v[162:165], v[128:131], 0
  v_mfma_f32_16x16x32_bf16 v[4:7], v[160:163], v[128:131], 0
  v_mfma_f32_16x16x32_bf16 v[32:35], v[186:189], v[144:147], 0
  v_mfma_f32_16x16x32_bf16 v[36:39], v[184:187], v[144:147], 0
  s_waitcnt vmcnt(4)
  v_swap_b32 v133, v148
  v_swap_b32 v135, v150
  s_nop 1
  v_mfma_f32_16x16x32_bf16 v[8:11], v[168:171], v[132:135], 0
  v_mfma_f32_16x16x32_bf16 v[12:15], v[166:169], v[132:135], 0
  v_mfma_f32_16x16x32_bf16 v[40:43], v[192:195], v[148:151], 0
  v_mfma_f32_16x16x32_bf16 v[44:47], v[190:193], v[148:151], 0
  s_waitcnt vmcnt(2)
  v_swap_b32 v137, v152
  v_swap_b32 v139, v154
  s_nop 1
  v_mfma_f32_16x16x32_bf16 v[16:19], v[174:177], v[136:139], 0
  v_mfma_f32_16x16x32_bf16 v[20:23], v[172:175], v[136:139], 0
  v_mfma_f32_16x16x32_bf16 v[48:51], v[198:201], v[152:155], 0
  v_mfma_f32_16x16x32_bf16 v[52:55], v[196:199], v[152:155], 0
  s_waitcnt vmcnt(0)
  v_swap_b32 v141, v156
  v_swap_b32 v143, v158
  s_nop 1
  v_mfma_f32_16x16x32_bf16 v[24:27], v[180:183], v[140:143], 0
  v_mfma_f32_16x16x32_bf16 v[28:31], v[178:181], v[140:143], 0
  v_mfma_f32_16x16x32_bf16 v[56:59], v[204:207], v[156:159], 0
  v_mfma_f32_16x16x32_bf16 v[60:63], v[202:205], v[156:159], 0
  s_nop 3
  ds_read_b128 v[160:163], v246 offset:12288
  ds_read_b64 v[164:165], v247 offset:13312
  ds_read_b128 v[166:169], v246 offset:13824
  ds_read_b64 v[170:171], v247 offset:14848
  ds_read_b128 v[172:175], v246 offset:15360
  ds_read_b64 v[176:177], v247 offset:16384
  ds_read_b128 v[178:181], v246 offset:16896
  ds_read_b64 v[182:183], v247 offset:17920
  ds_read_b128 v[184:187], v246 offset:18432
  ds_read_b64 v[188:189], v247 offset:19456
  ds_read_b128 v[190:193], v246 offset:19968
  ds_read_b64 v[194:195], v247 offset:20992
  ds_read_b128 v[196:199], v246 offset:21504
  ds_read_b64 v[200:201], v247 offset:22528
  ds_read_b128 v[202:205], v246 offset:23040
  ds_read_b64 v[206:207], v247 offset:24064
  v_pk_add_f32 v[128:129], v[0:1], v[16:17]
  v_pk_add_f32 v[130:131], v[2:3], v[18:19]
  v_pk_add_f32 v[136:137], v[0:1], v[16:17] neg_lo:[0,1] neg_hi:[0,1]
  v_pk_add_f32 v[138:139], v[2:3], v[18:19] neg_lo:[0,1] neg_hi:[0,1]
  v_pk_add_f32 v[144:145], v[8:9], v[24:25]
  v_pk_add_f32 v[146:147], v[10:11], v[26:27]
  v_pk_add_f32 v[152:153], v[8:9], v[24:25] neg_lo:[0,1] neg_hi:[0,1]
  v_pk_add_f32 v[154:155], v[10:11], v[26:27] neg_lo:[0,1] neg_hi:[0,1]
  v_pk_add_f32 v[132:133], v[4:5], v[20:21]
  v_pk_add_f32 v[134:135], v[6:7], v[22:23]
  v_pk_add_f32 v[140:141], v[4:5], v[20:21] neg_lo:[0,1] neg_hi:[0,1]
  v_pk_add_f32 v[142:143], v[6:7], v[22:23] neg_lo:[0,1] neg_hi:[0,1]
  v_pk_add_f32 v[148:149], v[12:13], v[28:29]
  v_pk_add_f32 v[150:151], v[14:15], v[30:31]
  v_pk_add_f32 v[156:157], v[12:13], v[28:29] neg_lo:[0,1] neg_hi:[0,1]
  v_pk_add_f32 v[158:159], v[14:15], v[30:31] neg_lo:[0,1] neg_hi:[0,1]
  v_pk_add_f32 v[0:1], v[128:129], v[144:145]
  v_pk_add_f32 v[2:3], v[130:131], v[146:147]
  v_pk_add_f32 v[16:17], v[128:129], v[144:145] neg_lo:[0,1] neg_hi:[0,1]
  v_pk_add_f32 v[18:19], v[130:131], v[146:147] neg_lo:[0,1] neg_hi:[0,1]
  v_pk_add_f32 v[4:5], v[132:133], v[148:149]
  v_pk_add_f32 v[6:7], v[134:135], v[150:151]
  v_pk_add_f32 v[20:21], v[132:133], v[148:149] neg_lo:[0,1] neg_hi:[0,1]
  v_pk_add_f32 v[22:23], v[134:135], v[150:151] neg_lo:[0,1] neg_hi:[0,1]
  v_pk_add_f32 v[8:9], v[136:137], v[156:157]
  v_pk_add_f32 v[10:11], v[138:139], v[158:159]
  v_pk_add_f32 v[12:13], v[140:141], v[152:153] neg_lo:[0,1] neg_hi:[0,1]
  v_pk_add_f32 v[14:15], v[142:143], v[154:155] neg_lo:[0,1] neg_hi:[0,1]
  v_pk_add_f32 v[24:25], v[136:137], v[156:157] neg_lo:[0,1] neg_hi:[0,1]
  v_pk_add_f32 v[26:27], v[138:139], v[158:159] neg_lo:[0,1] neg_hi:[0,1]
  v_pk_add_f32 v[28:29], v[140:141], v[152:153]
  v_pk_add_f32 v[30:31], v[142:143], v[154:155]
  v_pk_add_f32 v[128:129], v[32:33], v[48:49]
  v_pk_add_f32 v[130:131], v[34:35], v[50:51]
  v_pk_add_f32 v[136:137], v[32:33], v[48:49] neg_lo:[0,1] neg_hi:[0,1]
  v_pk_add_f32 v[138:139], v[34:35], v[50:51] neg_lo:[0,1] neg_hi:[0,1]
  v_pk_add_f32 v[144:145], v[40:41], v[56:57]
  v_pk_add_f32 v[146:147], v[42:43], v[58:59]
  v_pk_add_f32 v[152:153], v[40:41], v[56:57] neg_lo:[0,1] neg_hi:[0,1]
  v_pk_add_f32 v[154:155], v[42:43], v[58:59] neg_lo:[0,1] neg_hi:[0,1]
  v_pk_add_f32 v[132:133], v[36:37], v[52:53]
  v_pk_add_f32 v[134:135], v[38:39], v[54:55]
  v_pk_add_f32 v[140:141], v[36:37], v[52:53] neg_lo:[0,1] neg_hi:[0,1]
  v_pk_add_f32 v[142:143], v[38:39], v[54:55] neg_lo:[0,1] neg_hi:[0,1]
  v_pk_add_f32 v[148:149], v[44:45], v[60:61]
  v_pk_add_f32 v[150:151], v[46:47], v[62:63]
  v_pk_add_f32 v[156:157], v[44:45], v[60:61] neg_lo:[0,1] neg_hi:[0,1]
  v_pk_add_f32 v[158:159], v[46:47], v[62:63] neg_lo:[0,1] neg_hi:[0,1]
  v_pk_add_f32 v[32:33], v[128:129], v[144:145]
  v_pk_add_f32 v[34:35], v[130:131], v[146:147]
  v_pk_add_f32 v[48:49], v[128:129], v[144:145] neg_lo:[0,1] neg_hi:[0,1]
  v_pk_add_f32 v[50:51], v[130:131], v[146:147] neg_lo:[0,1] neg_hi:[0,1]
  v_pk_add_f32 v[36:37], v[132:133], v[148:149]
  v_pk_add_f32 v[38:39], v[134:135], v[150:151]
  v_pk_add_f32 v[52:53], v[132:133], v[148:149] neg_lo:[0,1] neg_hi:[0,1]
  v_pk_add_f32 v[54:55], v[134:135], v[150:151] neg_lo:[0,1] neg_hi:[0,1]
  v_pk_add_f32 v[40:41], v[136:137], v[156:157]
  v_pk_add_f32 v[42:43], v[138:139], v[158:159]
  v_pk_add_f32 v[44:45], v[140:141], v[152:153] neg_lo:[0,1] neg_hi:[0,1]
  v_pk_add_f32 v[46:47], v[142:143], v[154:155] neg_lo:[0,1] neg_hi:[0,1]
  v_pk_add_f32 v[56:57], v[136:137], v[156:157] neg_lo:[0,1] neg_hi:[0,1]
  v_pk_add_f32 v[58:59], v[138:139], v[158:159] neg_lo:[0,1] neg_hi:[0,1]
  v_pk_add_f32 v[60:61], v[140:141], v[152:153]
  v_pk_add_f32 v[62:63], v[142:143], v[154:155]
  s_cbranch_execz dry_ret
dry1:
  s_waitcnt lgkmcnt(15)
  s_waitcnt lgkmcnt(0)
  v_pk_mul_f32 v[128:129], v[0:1], v[64:65]
  v_pk_mul_f32 v[130:131], v[0:1], v[80:81]
  v_pk_mul_f32 v[132:133], v[32:33], v[96:97]
  v_pk_mul_f32 v[134:135], v[32:33], v[112:113]
  v_pk_fma_f32 v[128:129], v[4:5], v[80:81], v[128:129] neg_lo:[0,1,0] neg_hi:[0,1,0]
  v_pk_fma_f32 v[130:131], v[4:5], v[64:65], v[130:131]
  v_pk_fma_f32 v[132:133], v[36:37], v[112:113], v[132:133] neg_lo:[0,1,0] neg_hi:[0,1,0]
  v_pk_fma_f32 v[134:135], v[36:37], v[96:97], v[134:135]
  v_pk_fma_f32 v[0:1], v[132:133], s[42:43], v[128:129]
  v_pk_fma_f32 v[32:33], v[128:129], s[42:43], v[132:133] neg_lo:[0,0,1] neg_hi:[0,0,1]
  v_pk_fma_f32 v[4:5], v[134:135], s[42:43], v[130:131]
  v_pk_fma_f32 v[36:37], v[130:131], s[42:43], v[134:135] neg_lo:[0,0,1] neg_hi:[0,0,1]
  v_pk_mul_f32 v[136:137], v[2:3], v[66:67]
  v_pk_mul_f32 v[138:139], v[2:3], v[82:83]
  v_pk_mul_f32 v[140:141], v[34:35], v[98:99]
  v_pk_mul_f32 v[142:143], v[34:35], v[114:115]
  v_pk_fma_f32 v[136:137], v[6:7], v[82:83], v[136:137] neg_lo:[0,1,0] neg_hi:[0,1,0]
  v_pk_fma_f32 v[138:139], v[6:7], v[66:67], v[138:139]
  v_pk_fma_f32 v[140:141], v[38:39], v[114:115], v[140:141] neg_lo:[0,1,0] neg_hi:[0,1,0]
  v_pk_fma_f32 v[142:143], v[38:39], v[98:99], v[142:143]
  v_pk_fma_f32 v[2:3], v[140:141], s[42:43], v[136:137]
  v_pk_fma_f32 v[34:35], v[136:137], s[42:43], v[140:141] neg_lo:[0,0,1] neg_hi:[0,0,1]
  v_pk_fma_f32 v[6:7], v[142:143], s[42:43], v[138:139]
  v_pk_fma_f32 v[38:39], v[138:139], s[42:43], v[142:143] neg_lo:[0,0,1] neg_hi:[0,0,1]
  v_pk_mul_f32 v[144:145], v[8:9], v[68:69]
  v_pk_mul_f32 v[146:147], v[8:9], v[84:85]
  v_pk_mul_f32 v[148:149], v[40:41], v[100:101]
  v_pk_mul_f32 v[150:151], v[40:41], v[116:117]
  v_pk_fma_f32 v[144:145], v[12:13], v[84:85], v[144:145] neg_lo:[0,1,0] neg_hi:[0,1,0]
  v_pk_fma_f32 v[146:147], v[12:13], v[68:69], v[146:147]
  v_pk_fma_f32 v[148:149], v[44:45], v[116:117], v[148:149] neg_lo:[0,1,0] neg_hi:[0,1,0]
  v_pk_fma_f32 v[150:151], v[44:45], v[100:101], v[150:151]
  v_pk_fma_f32 v[8:9], v[148:149], s[42:43], v[144:145]
  v_pk_fma_f32 v[40:41], v[144:145], s[42:43], v[148:149] neg_lo:[0,0,1] neg_hi:[0,0,1]
  v_pk_fma_f32 v[12:13], v[150:151], s[42:43], v[146:147]
  v_pk_fma_f32 v[44:45], v[146:147], s[42:43], v[150:151] neg_lo:[0,0,1] neg_hi:[0,0,1]
  v_pk_mul_f32 v[152:153], v[10:11], v[70:71]
  v_pk_mul_f32 v[154:155], v[10:11], v[86:87]
  v_pk_mul_f32 v[156:157], v[42:43], v[102:103]
  v_pk_mul_f32 v[158:159], v[42:43], v[118:119]
  v_pk_fma_f32 v[152:153], v[14:15], v[86:87], v[152:153] neg_lo:[0,1,0] neg_hi:[0,1,0]
  v_pk_fma_f32 v[154:155], v[14:15], v[70:71], v[154:155]
  v_pk_fma_f32 v[156:157], v[46:47], v[118:119], v[156:157] neg_lo:[0,1,0] neg_hi:[0,1,0]
  v_pk_fma_f32 v[158:159], v[46:47], v[102:103], v[158:159]
  v_pk_fma_f32 v[10:11], v[156:157], s[42:43], v[152:153]
  v_pk_fma_f32 v[42:43], v[152:153], s[42:43], v[156:157] neg_lo:[0,0,1] neg_hi:[0,0,1]
  v_pk_fma_f32 v[14:15], v[158:159], s[42:43], v[154:155]
  v_pk_fma_f32 v[46:47], v[154:155], s[42:43], v[158:159] neg_lo:[0,0,1] neg_hi:[0,0,1]
  v_pk_mul_f32 v[128:129], v[16:17], v[72:73]
  v_pk_mul_f32 v[130:131], v[16:17], v[88:89]
  v_pk_mul_f32 v[132:133], v[48:49], v[104:105]
  v_pk_mul_f32 v[134:135], v[48:49], v[120:121]
  v_pk_fma_f32 v[128:129], v[20:21], v[88:89], v[128:129] neg_lo:[0,1,0] neg_hi:[0,1,0]
  v_pk_fma_f32 v[130:131], v[20:21], v[72:73], v[130:131]
  v_pk_fma_f32 v[132:133], v[52:53], v[120:121], v[132:133] neg_lo:[0,1,0] neg_hi:[0,1,0]
  v_pk_fma_f32 v[134:135], v[52:53], v[104:105], v[134:135]
  v_pk_fma_f32 v[16:17], v[132:133], s[42:43], v[128:129]
  v_pk_fma_f32 v[48:49], v[128:129], s[42:43], v[132:133] neg_lo:[0,0,1] neg_hi:[0,0,1]
  v_pk_fma_f32 v[20:21], v[134:135], s[42:43], v[130:131]
  v_pk_fma_f32 v[52:53], v[130:131], s[42:43], v[134:135] neg_lo:[0,0,1] neg_hi:[0,0,1]
  v_pk_mul_f32 v[136:137], v[18:19], v[74:75]
  v_pk_mul_f32 v[138:139], v[18:19], v[90:91]
  v_pk_mul_f32 v[140:141], v[50:51], v[106:107]
  v_pk_mul_f32 v[142:143], v[50:51], v[122:123]
  v_pk_fma_f32 v[136:137], v[22:23], v[90:91], v[136:137] neg_lo:[0,1,0] neg_hi:[0,1,0]
  v_pk_fma_f32 v[138:139], v[22:23], v[74:75], v[138:139]
  v_pk_fma_f32 v[140:141], v[54:55], v[122:123], v[140:141] neg_lo:[0,1,0] neg_hi:[0,1,0]
  v_pk_fma_f32 v[142:143], v[54:55], v[106:107], v[142:143]
  v_pk_fma_f32 v[18:19], v[140:141], s[42:43], v[136:137]
  v_pk_fma_f32 v[50:51], v[136:137], s[42:43], v[140:141] neg_lo:[0,0,1] neg_hi:[0,0,1]
  v_pk_fma_f32 v[22:23], v[142:143], s[42:43], v[138:139]
  v_pk_fma_f32 v[54:55], v[138:139], s[42:43], v[142:143] neg_lo:[0,0,1] neg_hi:[0,0,1]
  v_pk_mul_f32 v[144:145], v[24:25], v[76:77]
  v_pk_mul_f32 v[146:147], v[24:25], v[92:93]
  v_pk_mul_f32 v[148:149], v[56:57], v[108:109]
  v_pk_mul_f32 v[150:151], v[56:57], v[124:125]
  v_pk_fma_f32 v[144:145], v[28:29], v[92:93], v[144:145] neg_lo:[0,1,0] neg_hi:[0,1,0]
  v_pk_fma_f32 v[146:147], v[28:29], v[76:77], v[146:147]
  v_pk_fma_f32 v[148:149], v[60:61], v[124:125], v[148:149] neg_lo:[0,1,0] neg_hi:[0,1,0]
  v_pk_fma_f32 v[150:151], v[60:61], v[108:109], v[150:151]
  v_pk_fma_f32 v[24:25], v[148:149], s[42:43], v[144:145]
  v_pk_fma_f32 v[56:57], v[144:145], s[42:43], v[148:149] neg_lo:[0,0,1] neg_hi:[0,0,1]
  v_pk_fma_f32 v[28:29], v[150:151], s[42:43], v[146:147]
  v_pk_fma_f32 v[60:61], v[146:147], s[42:43], v[150:151] neg_lo:[0,0,1] neg_hi:[0,0,1]
  v_pk_mul_f32 v[152:153], v[26:27], v[78:79]
  v_pk_mul_f32 v[154:155], v[26:27], v[94:95]
  v_pk_mul_f32 v[156:157], v[58:59], v[110:111]
  v_pk_mul_f32 v[158:159], v[58:59], v[126:127]
  v_pk_fma_f32 v[152:153], v[30:31], v[94:95], v[152:153] neg_lo:[0,1,0] neg_hi:[0,1,0]
  v_pk_fma_f32 v[154:155], v[30:31], v[78:79], v[154:155]
  v_pk_fma_f32 v[156:157], v[62:63], v[126:127], v[156:157] neg_lo:[0,1,0] neg_hi:[0,1,0]
  v_pk_fma_f32 v[158:159], v[62:63], v[110:111], v[158:159]
  v_pk_fma_f32 v[26:27], v[156:157], s[42:43], v[152:153]
  v_pk_fma_f32 v[58:59], v[152:153], s[42:43], v[156:157] neg_lo:[0,0,1] neg_hi:[0,0,1]
  v_pk_fma_f32 v[30:31], v[158:159], s[42:43], v[154:155]
  v_pk_fma_f32 v[62:63], v[154:155], s[42:43], v[158:159] neg_lo:[0,0,1] neg_hi:[0,0,1]
  s_waitcnt lgkmcnt(0)
  s_cbranch_execz dry_ret
dry2:
  v_pk_add_f32 v[128:129], v[0:1], v[16:17]
  v_pk_add_f32 v[130:131], v[2:3], v[18:19]
  v_pk_add_f32 v[136:137], v[0:1], v[16:17] neg_lo:[0,1] neg_hi:[0,1]
  v_pk_add_f32 v[138:139], v[2:3], v[18:19] neg_lo:[0,1] neg_hi:[0,1]
  v_pk_add_f32 v[144:145], v[8:9], v[24:25]
  v_pk_add_f32 v[146:147], v[10:11], v[26:27]
  v_pk_add_f32 v[152:153], v[8:9], v[24:25] neg_lo:[0,1] neg_hi:[0,1]
  v_pk_add_f32 v[154:155], v[10:11], v[26:27] neg_lo:[0,1] neg_hi:[0,1]
  v_pk_add_f32 v[132:133], v[4:5], v[20:21]
  v_pk_add_f32 v[134:135], v[6:7], v[22:23]
  v_pk_add_f32 v[140:141], v[4:5], v[20:21] neg_lo:[0,1] neg_hi:[0,1]
  v_pk_add_f32 v[142:143], v[6:7], v[22:23] neg_lo:[0,1] neg_hi:[0,1]
  v_pk_add_f32 v[148:149], v[12:13], v[28:29]
  v_pk_add_f32 v[150:151], v[14:15], v[30:31]
  v_pk_add_f32 v[156:157], v[12:13], v[28:29] neg_lo:[0,1] neg_hi:[0,1]
  v_pk_add_f32 v[158:159], v[14:15], v[30:31] neg_lo:[0,1] neg_hi:[0,1]
  v_pk_add_f32 v[0:1], v[128:129], v[144:145]
  v_pk_add_f32 v[2:3], v[130:131], v[146:147]
  v_pk_add_f32 v[16:17], v[128:129], v[144:145] neg_lo:[0,1] neg_hi:[0,1]
  v_pk_add_f32 v[18:19], v[130:131], v[146:147] neg_lo:[0,1] neg_hi:[0,1]
  v_pk_add_f32 v[4:5], v[132:133], v[148:149]
  v_pk_add_f32 v[6:7], v[134:135], v[150:151]
  v_pk_add_f32 v[20:21], v[132:133], v[148:149] neg_lo:[0,1] neg_hi:[0,1]
  v_pk_add_f32 v[22:23], v[134:135], v[150:151] neg_lo:[0,1] neg_hi:[0,1]
  v_pk_add_f32 v[24:25], v[136:137], v[156:157]
  v_pk_add_f32 v[26:27], v[138:139], v[158:159]
  v_pk_add_f32 v[28:29], v[140:141], v[152:153] neg_lo:[0,1] neg_hi:[0,1]
  v_pk_add_f32 v[30:31], v[142:143], v[154:155] neg_lo:[0,1] neg_hi:[0,1]
  v_pk_add_f32 v[8:9], v[136:137], v[156:157] neg_lo:[0,1] neg_hi:[0,1]
  v_pk_add_f32 v[10:11], v[138:139], v[158:159] neg_lo:[0,1] neg_hi:[0,1]
  v_pk_add_f32 v[12:13], v[140:141], v[152:153]
  v_pk_add_f32 v[14:15], v[142:143], v[154:155]
  v_cvt_pk_bf16_f32 v64, v0, v1
  v_cvt_pk_bf16_f32 v65, v2, v3
  v_cvt_pk_bf16_f32 v66, -v4, -v5
  v_cvt_pk_bf16_f32 v67, -v6, -v7
  v_cvt_pk_bf16_f32 v68, v8, v9
  v_cvt_pk_bf16_f32 v69, v10, v11
  v_cvt_pk_bf16_f32 v70, -v12, -v13
  v_cvt_pk_bf16_f32 v71, -v14, -v15
  v_cvt_pk_bf16_f32 v72, v16, v17
  v_cvt_pk_bf16_f32 v73, v18, v19
  v_cvt_pk_bf16_f32 v74, -v20, -v21
  v_cvt_pk_bf16_f32 v75, -v22, -v23
  v_cvt_pk_bf16_f32 v76, v24, v25
  v_cvt_pk_bf16_f32 v77, v26, v27
  v_cvt_pk_bf16_f32 v78, -v28, -v29
  v_cvt_pk_bf16_f32 v79, -v30, -v31
  v_mfma_f32_16x16x32_bf16 v[0:3], v[162:165], v[64:67], 0
  v_mfma_f32_16x16x32_bf16 v[4:7], v[160:163], v[64:67], 0
  v_mfma_f32_16x16x32_bf16 v[8:11], v[168:171], v[68:71], 0
  v_mfma_f32_16x16x32_bf16 v[12:15], v[166:169], v[68:71], 0
  v_mfma_f32_16x16x32_bf16 v[16:19], v[174:177], v[72:75], 0
  v_mfma_f32_16x16x32_bf16 v[20:23], v[172:175], v[72:75], 0
  v_mfma_f32_16x16x32_bf16 v[24:27], v[180:183], v[76:79], 0
  v_mfma_f32_16x16x32_bf16 v[28:31], v[178:181], v[76:79], 0
  v_pk_add_f32 v[128:129], v[32:33], v[48:49]
  v_pk_add_f32 v[130:131], v[34:35], v[50:51]
  v_pk_add_f32 v[136:137], v[32:33], v[48:49] neg_lo:[0,1] neg_hi:[0,1]
  v_pk_add_f32 v[138:139], v[34:35], v[50:51] neg_lo:[0,1] neg_hi:[0,1]
  v_pk_add_f32 v[144:145], v[40:41], v[56:57]
  v_pk_add_f32 v[146:147], v[42:43], v[58:59]
  v_pk_add_f32 v[152:153], v[40:41], v[56:57] neg_lo:[0,1] neg_hi:[0,1]
  v_pk_add_f32 v[154:155], v[42:43], v[58:59] neg_lo:[0,1] neg_hi:[0,1]
  v_pk_add_f32 v[132:133], v[36:37], v[52:53]
  v_pk_add_f32 v[134:135], v[38:39], v[54:55]
  v_pk_add_f32 v[140:141], v[36:37], v[52:53] neg_lo:[0,1] neg_hi:[0,1]
  v_pk_add_f32 v[142:143], v[38:39], v[54:55] neg_lo:[0,1] neg_hi:[0,1]
  v_pk_add_f32 v[148:149], v[44:45], v[60:61]
  v_pk_add_f32 v[150:151], v[46:47], v[62:63]
  v_pk_add_f32 v[156:157], v[44:45], v[60:61] neg_lo:[0,1] neg_hi:[0,1]
  v_pk_add_f32 v[158:159], v[46:47], v[62:63] neg_lo:[0,1] neg_hi:[0,1]
  v_pk_add_f32 v[32:33], v[128:129], v[144:145]
  v_pk_add_f32 v[34:35], v[130:131], v[146:147]
  v_pk_add_f32 v[48:49], v[128:129], v[144:145] neg_lo:[0,1] neg_hi:[0,1]
  v_pk_add_f32 v[50:51], v[130:131], v[146:147] neg_lo:[0,1] neg_hi:[0,1]
  v_pk_add_f32 v[36:37], v[132:133], v[148:149]
  v_pk_add_f32 v[38:39], v[134:135], v[150:151]
  v_pk_add_f32 v[52:53], v[132:133], v[148:149] neg_lo:[0,1] neg_hi:[0,1]
  v_pk_add_f32 v[54:55], v[134:135], v[150:151] neg_lo:[0,1] neg_hi:[0,1]
  v_pk_add_f32 v[56:57], v[136:137], v[156:157]
  v_pk_add_f32 v[58:59], v[138:139], v[158:159]
  v_pk_add_f32 v[60:61], v[140:141], v[152:153] neg_lo:[0,1] neg_hi:[0,1]
  v_pk_add_f32 v[62:63], v[142:143], v[154:155] neg_lo:[0,1] neg_hi:[0,1]
  v_pk_add_f32 v[40:41], v[136:137], v[156:157] neg_lo:[0,1] neg_hi:[0,1]
  v_pk_add_f32 v[42:43], v[138:139], v[158:159] neg_lo:[0,1] neg_hi:[0,1]
  v_pk_add_f32 v[44:45], v[140:141], v[152:153]
  v_pk_add_f32 v[46:47], v[142:143], v[154:155]
  s_cbranch_execz dry_ret
dry3:
  s_add_u32 s20, s22, 0
  v_cvt_pk_bf16_f32 v96, v0, v4
  v_cvt_pk_bf16_f32 v97, v1, v5
  v_cvt_pk_bf16_f32 v98, v2, v6
  v_cvt_pk_bf16_f32 v99, v3, v7
  s_cbranch_execz dry_s00
  buffer_store_dword v96, v240, s[24:27], s20 offen sc1
  buffer_store_dword v97, v241, s[24:27], s20 offen sc1
  buffer_store_dword v98, v242, s[24:27], s20 offen sc1
  buffer_store_dword v99, v243, s[24:27], s20 offen sc1
dry_s00:
  s_add_u32 s20, s20, 524288
  v_cvt_pk_bf16_f32 v100, v8, v12
  v_cvt_pk_bf16_f32 v101, v9, v13
  v_cvt_pk_bf16_f32 v102, v10, v14
  v_cvt_pk_bf16_f32 v103, v11, v15
  s_cbranch_execz dry_s01
  buffer_store_dword v100, v240, s[24:27], s20 offen sc1
  buffer_store_dword v101, v241, s[24:27], s20 offen sc1
  buffer_store_dword v102, v242, s[24:27], s20 offen sc1
  buffer_store_dword v103, v243, s[24:27], s20 offen sc1
dry_s01:
  s_add_u32 s20, s20, 524288
  v_cvt_pk_bf16_f32 v104, v16, v20
  v_cvt_pk_bf16_f32 v105, v17, v21
  v_cvt_pk_bf16_f32 v106, v18, v22
  v_cvt_pk_bf16_f32 v107, v19, v23
  s_cbranch_execz dry_s02
  buffer_store_dword v104, v240, s[24:27], s20 offen sc1
  buffer_store_dword v105, v241, s[24:27], s20 offen sc1
  buffer_store_dword v106, v242, s[24:27], s20 offen sc1
  buffer_store_dword v107, v243, s[24:27], s20 offen sc1
dry_s02:
  s_add_u32 s20, s20, 524288
  v_cvt_pk_bf16_f32 v108, v24, v28
  v_cvt_pk_bf16_f32 v109, v25, v29
  v_cvt_pk_bf16_f32 v110, v26, v30
  v_cvt_pk_bf16_f32 v111, v27, v31
  s_cbranch_execz dry_s03
  buffer_store_dword v108, v240, s[24:27], s20 offen sc1
  buffer_store_dword v109, v241, s[24:27], s20 offen sc1
  buffer_store_dword v110, v242, s[24:27], s20 offen sc1
  buffer_store_dword v111, v243, s[24:27], s20 offen sc1
dry_s03:
  v_cvt_pk_bf16_f32 v80, v32, v33
  v_cvt_pk_bf16_f32 v81, v34, v35
  v_cvt_pk_bf16_f32 v82, -v36, -v37
  v_cvt_pk_bf16_f32 v83, -v38, -v39
  v_cvt_pk_bf16_f32 v84, v40, v41
  v_cvt_pk_bf16_f32 v85, v42, v43
  v_cvt_pk_bf16_f32 v86, -v44, -v45
  v_cvt_pk_bf16_f32 v87, -v46, -v47
  v_cvt_pk_bf16_f32 v88, v48, v49
  v_cvt_pk_bf16_f32 v89, v50, v51
  v_cvt_pk_bf16_f32 v90, -v52, -v53
  v_cvt_pk_bf16_f32 v91, -v54, -v55
  v_cvt_pk_bf16_f32 v92, v56, v57
  v_cvt_pk_bf16_f32 v93, v58, v59
  v_cvt_pk_bf16_f32 v94, -v60, -v61
  v_cvt_pk_bf16_f32 v95, -v62, -v63
  v_mfma_f32_16x16x32_bf16 v[32:35], v[186:189], v[80:83], 0
  v_mfma_f32_16x16x32_bf16 v[36:39], v[184:187], v[80:83], 0
  v_mfma_f32_16x16x32_bf16 v[40:43], v[192:195], v[84:87], 0
  v_mfma_f32_16x16x32_bf16 v[44:47], v[190:193], v[84:87], 0
  v_mfma_f32_16x16x32_bf16 v[48:51], v[198:201], v[88:91], 0
  v_mfma_f32_16x16x32_bf16 v[52:55], v[196:199], v[88:91], 0
  v_mfma_f32_16x16x32_bf16 v[56:59], v[204:207], v[92:95], 0
  v_mfma_f32_16x16x32_bf16 v[60:63], v[202:205], v[92:95], 0
  s_add_u32 s20, s22, 1024
  s_nop 0
  v_cvt_pk_bf16_f32 v112, v32, v36
  v_cvt_pk_bf16_f32 v113, v33, v37
  v_cvt_pk_bf16_f32 v114, v34, v38
  v_cvt_pk_bf16_f32 v115, v35, v39
  s_cbranch_execz dry_s10
  buffer_store_dword v112, v240, s[24:27], s20 offen sc1
  buffer_store_dword v113, v241, s[24:27], s20 offen sc1
  buffer_store_dword v114, v242, s[24:27], s20 offen sc1
  buffer_store_dword v115, v243, s[24:27], s20 offen sc1
dry_s10:
  s_add_u32 s20, s20, 524288
  v_cvt_pk_bf16_f32 v116, v40, v44
  v_cvt_pk_bf16_f32 v117, v41, v45
  v_cvt_pk_bf16_f32 v118, v42, v46
  v_cvt_pk_bf16_f32 v119, v43, v47
  s_cbranch_execz dry_s11
  buffer_store_dword v116, v240, s[24:27], s20 offen sc1
  buffer_store_dword v117, v241, s[24:27], s20 offen sc1
  buffer_store_dword v118, v242, s[24:27], s20 offen sc1
  buffer_store_dword v119, v243, s[24:27], s20 offen sc1
dry_s11:
  s_add_u32 s20, s20, 524288
  v_cvt_pk_bf16_f32 v120, v48, v52
  v_cvt_pk_bf16_f32 v121, v49, v53
  v_cvt_pk_bf16_f32 v122, v50, v54
  v_cvt_pk_bf16_f32 v123, v51, v55
  s_cbranch_execz dry_s12
  buffer_store_dword v120, v240, s[24:27], s20 offen sc1
  buffer_store_dword v121, v241, s[24:27], s20 offen sc1
  buffer_store_dword v122, v242, s[24:27], s20 offen sc1
  buffer_store_dword v123, v243, s[24:27], s20 offen sc1
dry_s12:
  s_add_u32 s20, s20, 524288
  v_cvt_pk_bf16_f32 v124, v56, v60
  v_cvt_pk_bf16_f32 v125, v57, v61
  v_cvt_pk_bf16_f32 v126, v58, v62
  v_cvt_pk_bf16_f32 v127, v59, v63
  s_cbranch_execz dry_s13
  buffer_store_dword v124, v240, s[24:27], s20 offen sc1
  buffer_store_dword v125, v241, s[24:27], s20 offen sc1
  buffer_store_dword v126, v242, s[24:27], s20 offen sc1
  buffer_store_dword v127, v243, s[24:27], s20 offen sc1
dry_s13:
  s_cbranch_execz dry_ret
  v_mov_b32 v253, 0
  s_waitcnt vmcnt(0)
  s_barrier
  s_cmp_lg_u32 s17, 4
  s_cbranch_scc1 amid_end
  s_mov_b64 exec, 1
  buffer_store_dword v252, v253, s[24:27], s61 offen sc1
  s_mov_b64 exec, -1
amid_end:
  s_endpgm
f_comp:
  s_mov_b64 s[6:7], s[58:59]
  s_lshl2_add_u32 s14, s18, s14
  s_and_b32 s40, s17, 3
  s_cmp_eq_u32 s16, 0
  s_cbranch_scc1 f_compA
  s_movk_i32 s58, 256
  s_mov_b32 s59, 0x20000
  v_min_u32 v242, 53, v254
  v_lshlrev_b32 v242, 2, v242
  s_lshl1_add_u32 s23, s14, s15
  s_lshl3_add_u32 s60, s23, s16
  s_lshl_b32 s60, s60, 7
  s_add_u32 s60, s60, 19922944
  v_and_b32 v252, 31, v254
  v_bfe_u32 v253, v254, 1, 3
  v_lshrrev_b32 v237, 5, v254
  v_xor_b32 v253, v253, v237
  v_lshlrev_b32 v253, 4, v253
  v_lshl_add_u32 v236, v252, 7, v253
  v_add_u32 v236, 98304, v236
  v_lshlrev_b32 v216, 4, v252
  v_add_u32 v216, 4096, v216
  s_lshl_b32 s20, s40, 10
  s_add_u32 s20, s20, 0
  v_lshl_add_u32 v217, v254, 4, s20
  v_mov_b64 v[208:209], 0
  v_lshlrev_b32 v240, 12, v237
  s_lshl_b32 s20, s40, 8
  v_add_u32 v240, s20, v240
  v_bfe_u32 v252, v254, 2, 2
  v_lshl_add_u32 v240, v252, 6, v240
  v_bfe_u32 v252, v254, 4, 1
  v_lshl_add_u32 v240, v252, 5, v240
  v_and_b32 v252, 3, v254
  v_lshl_add_u32 v240, v252, 3, v240
  v_add_u32 v243, 65536, v240
  v_xor_b32 v237, 32, v236
  v_xor_b32 v238, 64, v236
  v_xor_b32 v239, 96, v236
  s_mul_i32 s37, s15, 7
  s_add_u32 s37, s37, s16
  s_sub_u32 s37, s37, 1
  s_lshl2_add_u32 s22, s37, s40
  s_lshl_b32 s28, s22, 11
  s_mul_i32 s48, s14, 458752
  s_add_u32 s28, s28, s48
  s_lshl_b32 s22, s22, 12
  s_add_u32 s22, s22, 20025344
  s_lshr_b32 s3, s12, 1
  s_lshl1_add_u32 s43, s51, s18
  s_lshl_b32 s21, s3, 10
  s_lshl2_add_u32 s21, s18, s21
  s_add_u32 s21, s21, s22
  s_cmp_lt_u32 s43, 14
  s_cselect_b32 s43, s18, 7
  s_and_b32 s44, s40, 1
  s_lshr_b32 s45, s40, 1
  v_lshrrev_b32 v252, 5, v254
  v_lshlrev_b32 v244, 9, v252
  v_bfe_u32 v252, v254, 2, 2
  v_lshl_add_u32 v244, v252, 6, v244
  v_bfe_u32 v252, v254, 4, 1
  v_lshl_add_u32 v244, v252, 5, v244
  v_and_b32 v252, 1, v254
  v_lshl_add_u32 v244, v252, 4, v244
  v_bfe_u32 v252, v254, 1, 1
  v_lshl_add_u32 v244, v252, 3, v244
  s_mul_i32 s46, s45, 8448
  v_add_u32 v244, s46, v244
  v_xor_b32 v247, 256, v244
  v_add_u32 v245, 65536, v244
  v_add_u32 v246, 131072, v244
  v_add_u32 v248, 65536, v247
  v_add_u32 v249, 131072, v247
  v_lshlrev_b32 v250, 4, v254
  s_load_dwordx4 s[52:55], s[0:1], 8
  s_lshl2_add_u32 s62, s13, s40
  s_sub_u32 s62, s62, 16
  v_lshrrev_b32 v16, 5, v254
  s_lshl_b32 s49, s12, 1
  v_add_u32 v16, s49, v16
  v_sub_u32 v17, 0, v16
  v_cmp_eq_u32 vcc, 0, v16
  s_nop 1
  v_cndmask_b32 v17, v17, 16, vcc
  v_and_b32 v252, 16, v254
  v_cmp_eq_u32 vcc, 0, v252
  s_nop 1
  v_cndmask_b32 v16, v17, v16, vcc
  s_lshr_b32 s49, s62, 1
  s_lshl_b32 s49, s49, 6
  v_add_u32 v16, s49, v16
  v_and_b32 v252, 8, v254
  v_lshl_add_u32 v16, v252, 2, v16
  v_and_b32 v16, 2047, v16
  v_mul_u32_u24 v16, 450, v16
  v_and_b32 v252, 7, v254
  v_lshlrev_b32 v252, 7, v252
  v_min_u32 v252, 446, v252
  v_add_u32 v16, v16, v252
  v_and_b32 v16, -4, v16
  s_waitcnt lgkmcnt(0)
  s_bitcmp1_b32 s62, 0
  s_cselect_b64 s[52:53], s[54:55], s[52:53]
  s_mov_b32 s54, 921600
  s_mov_b32 s55, 0x20000
  s_cmp_ge_u32 s62, 64
  s_cbranch_scc1 wt_no
  buffer_load_dword v255, v16, s[52:55], 0 offen
  s_mov_b32 s61, 0
wt_no:
  s_mov_b32 s20, 0x3f803f80
  v_mov_b64 v[8:9], 0
  s_lshl3_add_u32 s63, s15, s16
  s_lshl4_add_u32 s63, s14, s63
  s_lshl2_add_u32 s63, s63, s40
  s_lshl_b32 s63, s63, 5
  s_add_u32 s63, s63, 19992576
  v_lshrrev_b32 v180, 5, v254
  v_lshlrev_b32 v180, 4, v180
  s_waitcnt vmcnt(1)
  s_cmp_lt_u32 s61, 54
  s_cbranch_scc1 sm_nw
  s_waitcnt vmcnt(0)
sm_nw:
  v_dot2c_f32_bf16 v8, s20, v0
  v_dot2c_f32_bf16 v9, v0, v0
  v_dot2c_f32_bf16 v8, s20, v1
  v_dot2c_f32_bf16 v9, v1, v1
  v_dot2c_f32_bf16 v8, s20, v2
  v_dot2c_f32_bf16 v9, v2, v2
  v_dot2c_f32_bf16 v8, s20, v3
  v_dot2c_f32_bf16 v9, v3, v3
  v_dot2c_f32_bf16 v8, s20, v4
  v_dot2c_f32_bf16 v9, v4, v4
  v_dot2c_f32_bf16 v8, s20, v5
  v_dot2c_f32_bf16 v9, v5, v5
  v_dot2c_f32_bf16 v8, s20, v6
  v_dot2c_f32_bf16 v9, v6, v6
  s_nop 1
  v_add_f32_dpp v8, v8, v8 quad_perm:[1,0,3,2] row_mask:0xf bank_mask:0xf
  v_add_f32_dpp v9, v9, v9 quad_perm:[1,0,3,2] row_mask:0xf bank_mask:0xf
  s_nop 0
  v_add_f32_dpp v8, v8, v8 quad_perm:[2,3,0,1] row_mask:0xf bank_mask:0xf
  v_add_f32_dpp v9, v9, v9 quad_perm:[2,3,0,1] row_mask:0xf bank_mask:0xf
  s_nop 0
  v_add_f32_dpp v8, v8, v8 row_half_mirror row_mask:0xf bank_mask:0xf
  v_add_f32_dpp v9, v9, v9 row_half_mirror row_mask:0xf bank_mask:0xf
  s_nop 0
  v_add_f32_dpp v8, v8, v8 row_mirror row_mask:0xf bank_mask:0xf
  v_add_f32_dpp v9, v9, v9 row_mirror row_mask:0xf bank_mask:0xf
  s_nop 0
  v_add_f32_dpp v8, v8, v8 row_bcast:15 row_mask:0xa bank_mask:0xf
  v_add_f32_dpp v9, v9, v9 row_bcast:15 row_mask:0xa bank_mask:0xf
  v_mul_f32 v8, 0x3b124925, v8
  v_mul_f32 v9, 0x3b124925, v9
  v_fma_f32 v9, -v8, v8, v9
  v_max_f32 v9, 0, v9
  v_cvt_pk_bf16_f32 v9, v8, v9
  v_lshlrev_b32 v10, 16, v9
  v_and_b32 v9, 0xffff0000, v9
  v_add_f32 v9, 0x3727c5ac, v9
  v_cvt_pk_bf16_f32 v9, 0, v9
  v_sqrt_f32 v9, v9
  v_sub_f32 v8, v8, v10
  v_cvt_pk_bf16_f32 v9, 0, v9
  v_rcp_f32 v12, v9
  v_mul_f32 v8, 0x43600000, v8
  v_cvt_pk_bf16_f32 v176, -v10, -v10
  v_cvt_pk_bf16_f32 v177, -v10, v8
  v_mul_f32 v178, v12, v12
  v_mul_f32 v179, 0x36124925, v12
  v_or_b32 v179, 1, v179
  s_setprio 2
  s_barrier
  ds_read_b64_tr_b16 v[144:145], v240 offset:0
  ds_read_b64_tr_b16 v[146:147], v240 offset:2048
  ds_read_b128 v[128:131], v236 offset:0
  ds_read_b64_tr_b16 v[148:149], v240 offset:1024
  ds_read_b64_tr_b16 v[150:151], v240 offset:3072
  ds_read_b128 v[132:135], v236 offset:4096
  ds_read_b128 v[136:139], v236 offset:8192
  ds_read_b128 v[140:143], v236 offset:12288
  s_waitcnt lgkmcnt(5)
  v_mfma_f32_32x32x16_bf16 v[0:15], v[144:147], v[128:131], 0
  s_waitcnt lgkmcnt(3)
  v_mfma_f32_32x32x16_bf16 v[16:31], v[148:151], v[128:131], 0
  ds_read_b64_tr_b16 v[168:169], v240 offset:8192
  ds_read_b64_tr_b16 v[170:171], v240 offset:10240
  s_cmp_lg_u32 s43, 0
  s_cbranch_scc1 fb_c1
  v_dot2c_f32_bf16 v208, s20, v144
  v_dot2c_f32_bf16 v209, s20, v148
  v_dot2c_f32_bf16 v208, s20, v145
  v_dot2c_f32_bf16 v209, s20, v149
  v_dot2c_f32_bf16 v208, s20, v146
  v_dot2c_f32_bf16 v209, s20, v150
  v_dot2c_f32_bf16 v208, s20, v147
  v_dot2c_f32_bf16 v209, s20, v151
fb_c1:
  s_waitcnt lgkmcnt(4)
  v_mfma_f32_32x32x16_bf16 v[32:47], v[144:147], v[132:135], 0
  ds_read_b128 v[152:155], v237 offset:0
  v_mfma_f32_32x32x16_bf16 v[48:63], v[148:151], v[132:135], 0
  ds_read_b64_tr_b16 v[172:173], v240 offset:9216
  ds_read_b64_tr_b16 v[174:175], v240 offset:11264
  s_waitcnt lgkmcnt(6)
  v_mfma_f32_32x32x16_bf16 v[64:79], v[144:147], v[136:139], 0
  ds_read_b128 v[156:159], v237 offset:4096
  v_mfma_f32_32x32x16_bf16 v[80:95], v[148:151], v[136:139], 0
  ds_read_b128 v[160:163], v237 offset:8192
  s_waitcnt lgkmcnt(7)
  v_mfma_f32_32x32x16_bf16 v[96:111], v[144:147], v[140:143], 0
  ds_read_b128 v[164:167], v237 offset:12288
  v_mfma_f32_32x32x16_bf16 v[112:127], v[148:151], v[140:143], 0
  s_waitcnt lgkmcnt(5)
  v_mfma_f32_32x32x16_bf16 v[0:15], v[168:171], v[152:155], v[0:15]
  s_waitcnt lgkmcnt(3)
  v_mfma_f32_32x32x16_bf16 v[16:31], v[172:175], v[152:155], v[16:31]
  s_barrier
  ds_read_b64_tr_b16 v[144:145], v240 offset:16384
  ds_read_b64_tr_b16 v[146:147], v240 offset:18432
  s_cmp_lg_u32 s43, 0
  s_cbranch_scc1 fb_c2
  v_dot2c_f32_bf16 v208, s20, v168
  v_dot2c_f32_bf16 v209, s20, v172
  v_dot2c_f32_bf16 v208, s20, v169
  v_dot2c_f32_bf16 v209, s20, v173
  v_dot2c_f32_bf16 v208, s20, v170
  v_dot2c_f32_bf16 v209, s20, v174
  v_dot2c_f32_bf16 v208, s20, v171
  v_dot2c_f32_bf16 v209, s20, v175
fb_c2:
  s_waitcnt lgkmcnt(4)
  v_mfma_f32_32x32x16_bf16 v[32:47], v[168:171], v[156:159], v[32:47]
  ds_read_b128 v[128:131], v238 offset:0
  v_mfma_f32_32x32x16_bf16 v[48:63], v[172:175], v[156:159], v[48:63]
  ds_read_b64_tr_b16 v[148:149], v240 offset:17408
  ds_read_b64_tr_b16 v[150:151], v240 offset:19456
  s_waitcnt lgkmcnt(6)
  v_mfma_f32_32x32x16_bf16 v[64:79], v[168:171], v[160:163], v[64:79]
  ds_read_b128 v[132:135], v238 offset:4096
  v_mfma_f32_32x32x16_bf16 v[80:95], v[172:175], v[160:163], v[80:95]
  ds_read_b128 v[136:139], v238 offset:8192
  s_waitcnt lgkmcnt(7)
  v_mfma_f32_32x32x16_bf16 v[96:111], v[168:171], v[164:167], v[96:111]
  ds_read_b128 v[140:143], v238 offset:12288
  v_mfma_f32_32x32x16_bf16 v[112:127], v[172:175], v[164:167], v[112:127]
  s_waitcnt lgkmcnt(5)
  v_mfma_f32_32x32x16_bf16 v[0:15], v[144:147], v[128:131], v[0:15]
  s_waitcnt lgkmcnt(3)
  v_mfma_f32_32x32x16_bf16 v[16:31], v[148:151], v[128:131], v[16:31]
  ds_read_b64_tr_b16 v[168:169], v240 offset:24576
  ds_read_b64_tr_b16 v[170:171], v240 offset:26624
  s_cmp_lg_u32 s43, 1
  s_cbranch_scc1 fb_c3
  v_dot2c_f32_bf16 v208, s20, v144
  v_dot2c_f32_bf16 v209, s20, v148
  v_dot2c_f32_bf16 v208, s20, v145
  v_dot2c_f32_bf16 v209, s20, v149
  v_dot2c_f32_bf16 v208, s20, v146
  v_dot2c_f32_bf16 v209, s20, v150
  v_dot2c_f32_bf16 v208, s20, v147
  v_dot2c_f32_bf16 v209, s20, v151
fb_c3:
  s_waitcnt lgkmcnt(4)
  v_mfma_f32_32x32x16_bf16 v[32:47], v[144:147], v[132:135], v[32:47]
  ds_read_b128 v[152:155], v239 offset:0
  v_mfma_f32_32x32x16_bf16 v[48:63], v[148:151], v[132:135], v[48:63]
  ds_read_b64_tr_b16 v[172:173], v240 offset:25600
  ds_read_b64_tr_b16 v[174:175], v240 offset:27648
  s_waitcnt lgkmcnt(6)
  v_mfma_f32_32x32x16_bf16 v[64:79], v[144:147], v[136:139], v[64:79]
  ds_read_b128 v[156:159], v239 offset:4096
  v_mfma_f32_32x32x16_bf16 v[80:95], v[148:151], v[136:139], v[80:95]
  ds_read_b128 v[160:163], v239 offset:8192
  s_waitcnt lgkmcnt(7)
  v_mfma_f32_32x32x16_bf16 v[96:111], v[144:147], v[140:143], v[96:111]
  ds_read_b128 v[164:167], v239 offset:12288
  v_mfma_f32_32x32x16_bf16 v[112:127], v[148:151], v[140:143], v[112:127]
  s_waitcnt lgkmcnt(5)
  v_mfma_f32_32x32x16_bf16 v[0:15], v[168:171], v[152:155], v[0:15]
  s_waitcnt lgkmcnt(3)
  v_mfma_f32_32x32x16_bf16 v[16:31], v[172:175], v[152:155], v[16:31]
  s_barrier
  ds_read_b64_tr_b16 v[144:145], v240 offset:32768
  ds_read_b64_tr_b16 v[146:147], v240 offset:34816
  s_cmp_lg_u32 s43, 1
  s_cbranch_scc1 fb_c4
  v_dot2c_f32_bf16 v208, s20, v168
  v_dot2c_f32_bf16 v209, s20, v172
  v_dot2c_f32_bf16 v208, s20, v169
  v_dot2c_f32_bf16 v209, s20, v173
  v_dot2c_f32_bf16 v208, s20, v170
  v_dot2c_f32_bf16 v209, s20, v174
  v_dot2c_f32_bf16 v208, s20, v171
  v_dot2c_f32_bf16 v209, s20, v175
fb_c4:
  s_waitcnt lgkmcnt(4)
  v_mfma_f32_32x32x16_bf16 v[32:47], v[168:171], v[156:159], v[32:47]
  ds_read_b128 v[128:131], v236 offset:16384
  v_mfma_f32_32x32x16_bf16 v[48:63], v[172:175], v[156:159], v[48:63]
  ds_read_b64_tr_b16 v[148:149], v240 offset:33792
  ds_read_b64_tr_b16 v[150:151], v240 offset:35840
  s_waitcnt lgkmcnt(6)
  v_mfma_f32_32x32x16_bf16 v[64:79], v[168:171], v[160:163], v[64:79]
  ds_read_b128 v[132:135], v236 offset:20480
  v_mfma_f32_32x32x16_bf16 v[80:95], v[172:175], v[160:163], v[80:95]
  ds_read_b128 v[136:139], v236 offset:24576
  s_waitcnt lgkmcnt(7)
  v_mfma_f32_32x32x16_bf16 v[96:111], v[168:171], v[164:167], v[96:111]
  ds_read_b128 v[140:143], v236 offset:28672
  v_mfma_f32_32x32x16_bf16 v[112:127], v[172:175], v[164:167], v[112:127]
  s_waitcnt lgkmcnt(5)
  v_mfma_f32_32x32x16_bf16 v[0:15], v[144:147], v[128:131], v[0:15]
  s_waitcnt lgkmcnt(3)
  v_mfma_f32_32x32x16_bf16 v[16:31], v[148:151], v[128:131], v[16:31]
  ds_read_b64_tr_b16 v[168:169], v240 offset:40960
  ds_read_b64_tr_b16 v[170:171], v240 offset:43008
  s_cmp_lg_u32 s43, 2
  s_cbranch_scc1 fb_c5
  v_dot2c_f32_bf16 v208, s20, v144
  v_dot2c_f32_bf16 v209, s20, v148
  v_dot2c_f32_bf16 v208, s20, v145
  v_dot2c_f32_bf16 v209, s20, v149
  v_dot2c_f32_bf16 v208, s20, v146
  v_dot2c_f32_bf16 v209, s20, v150
  v_dot2c_f32_bf16 v208, s20, v147
  v_dot2c_f32_bf16 v209, s20, v151
fb_c5:
  s_waitcnt lgkmcnt(4)
  v_mfma_f32_32x32x16_bf16 v[32:47], v[144:147], v[132:135], v[32:47]
  ds_read_b128 v[152:155], v237 offset:16384
  v_mfma_f32_32x32x16_bf16 v[48:63], v[148:151], v[132:135], v[48:63]
  ds_read_b64_tr_b16 v[172:173], v240 offset:41984
  ds_read_b64_tr_b16 v[174:175], v240 offset:44032
  s_waitcnt lgkmcnt(6)
  v_mfma_f32_32x32x16_bf16 v[64:79], v[144:147], v[136:139], v[64:79]
  ds_read_b128 v[156:159], v237 offset:20480
  v_mfma_f32_32x32x16_bf16 v[80:95], v[148:151], v[136:139], v[80:95]
  ds_read_b128 v[160:163], v237 offset:24576
  s_waitcnt lgkmcnt(7)
  v_mfma_f32_32x32x16_bf16 v[96:111], v[144:147], v[140:143], v[96:111]
  ds_read_b128 v[164:167], v237 offset:28672
  v_mfma_f32_32x32x16_bf16 v[112:127], v[148:151], v[140:143], v[112:127]
  s_waitcnt lgkmcnt(5)
  v_mfma_f32_32x32x16_bf16 v[0:15], v[168:171], v[152:155], v[0:15]
  s_cmp_lg_u32 s40, 0
  s_cbranch_scc1 fb_c6
  buffer_load_dword v241, v242, s[56:59], 0 offen sc1
fb_c6:
  s_waitcnt lgkmcnt(3)
  v_mfma_f32_32x32x16_bf16 v[16:31], v[172:175], v[152:155], v[16:31]
  s_barrier
  ds_read_b64_tr_b16 v[144:145], v240 offset:49152
  ds_read_b64_tr_b16 v[146:147], v240 offset:51200
  s_cmp_lg_u32 s43, 2
  s_cbranch_scc1 fb_c7
  v_dot2c_f32_bf16 v208, s20, v168
  v_dot2c_f32_bf16 v209, s20, v172
  v_dot2c_f32_bf16 v208, s20, v169
  v_dot2c_f32_bf16 v209, s20, v173
  v_dot2c_f32_bf16 v208, s20, v170
  v_dot2c_f32_bf16 v209, s20, v174
  v_dot2c_f32_bf16 v208, s20, v171
  v_dot2c_f32_bf16 v209, s20, v175
fb_c7:
  s_waitcnt lgkmcnt(4)
  v_mfma_f32_32x32x16_bf16 v[32:47], v[168:171], v[156:159], v[32:47]
  ds_read_b128 v[128:131], v238 offset:16384
  v_mfma_f32_32x32x16_bf16 v[48:63], v[172:175], v[156:159], v[48:63]
  ds_read_b64_tr_b16 v[148:149], v240 offset:50176
  ds_read_b64_tr_b16 v[150:151], v240 offset:52224
  s_waitcnt lgkmcnt(6)
  v_mfma_f32_32x32x16_bf16 v[64:79], v[168:171], v[160:163], v[64:79]
  ds_read_b128 v[132:135], v238 offset:20480
  v_mfma_f32_32x32x16_bf16 v[80:95], v[172:175], v[160:163], v[80:95]
  ds_read_b128 v[136:139], v238 offset:24576
  s_waitcnt lgkmcnt(7)
  v_mfma_f32_32x32x16_bf16 v[96:111], v[168:171], v[164:167], v[96:111]
  ds_read_b128 v[140:143], v238 offset:28672
  v_mfma_f32_32x32x16_bf16 v[112:127], v[172:175], v[164:167], v[112:127]
  s_waitcnt lgkmcnt(5)
  v_mfma_f32_32x32x16_bf16 v[0:15], v[144:147], v[128:131], v[0:15]
  s_waitcnt lgkmcnt(3)
  v_mfma_f32_32x32x16_bf16 v[16:31], v[148:151], v[128:131], v[16:31]
  ds_read_b64_tr_b16 v[168:169], v240 offset:57344
  ds_read_b64_tr_b16 v[170:171], v240 offset:59392
  s_cmp_lg_u32 s43, 3
  s_cbranch_scc1 fb_c8
  v_dot2c_f32_bf16 v208, s20, v144
  v_dot2c_f32_bf16 v209, s20, v148
  v_dot2c_f32_bf16 v208, s20, v145
  v_dot2c_f32_bf16 v209, s20, v149
  v_dot2c_f32_bf16 v208, s20, v146
  v_dot2c_f32_bf16 v209, s20, v150
  v_dot2c_f32_bf16 v208, s20, v147
  v_dot2c_f32_bf16 v209, s20, v151
fb_c8:
  s_waitcnt lgkmcnt(4)
  v_mfma_f32_32x32x16_bf16 v[32:47], v[144:147], v[132:135], v[32:47]
  ds_read_b128 v[152:155], v239 offset:16384
  v_mfma_f32_32x32x16_bf16 v[48:63], v[148:151], v[132:135], v[48:63]
  ds_read_b64_tr_b16 v[172:173], v240 offset:58368
  ds_read_b64_tr_b16 v[174:175], v240 offset:60416
  s_waitcnt lgkmcnt(6)
  v_mfma_f32_32x32x16_bf16 v[64:79], v[144:147], v[136:139], v[64:79]
  ds_read_b128 v[156:159], v239 offset:20480
  v_mfma_f32_32x32x16_bf16 v[80:95], v[148:151], v[136:139], v[80:95]
  ds_read_b128 v[160:163], v239 offset:24576
  s_waitcnt lgkmcnt(7)
  v_mfma_f32_32x32x16_bf16 v[96:111], v[144:147], v[140:143], v[96:111]
  ds_read_b128 v[164:167], v239 offset:28672
  v_mfma_f32_32x32x16_bf16 v[112:127], v[148:151], v[140:143], v[112:127]
  s_waitcnt lgkmcnt(5)
  v_mfma_f32_32x32x16_bf16 v[0:15], v[168:171], v[152:155], v[0:15]
  s_waitcnt lgkmcnt(3)
  v_mfma_f32_32x32x16_bf16 v[16:31], v[172:175], v[152:155], v[16:31]
  s_barrier
  ds_read_b64_tr_b16 v[144:145], v243 offset:0
  ds_read_b64_tr_b16 v[146:147], v243 offset:2048
  s_cmp_lg_u32 s43, 3
  s_cbranch_scc1 fb_c9
  v_dot2c_f32_bf16 v208, s20, v168
  v_dot2c_f32_bf16 v209, s20, v172
  v_dot2c_f32_bf16 v208, s20, v169
  v_dot2c_f32_bf16 v209, s20, v173
  v_dot2c_f32_bf16 v208, s20, v170
  v_dot2c_f32_bf16 v209, s20, v174
  v_dot2c_f32_bf16 v208, s20, v171
  v_dot2c_f32_bf16 v209, s20, v175
fb_c9:
  s_waitcnt lgkmcnt(4)
  v_mfma_f32_32x32x16_bf16 v[32:47], v[168:171], v[156:159], v[32:47]
  ds_read_b128 v[128:131], v236 offset:32768
  v_mfma_f32_32x32x16_bf16 v[48:63], v[172:175], v[156:159], v[48:63]
  ds_read_b64_tr_b16 v[148:149], v243 offset:1024
  ds_read_b64_tr_b16 v[150:151], v243 offset:3072
  s_waitcnt lgkmcnt(6)
  v_mfma_f32_32x32x16_bf16 v[64:79], v[168:171], v[160:163], v[64:79]
  ds_read_b128 v[132:135], v236 offset:36864
  v_mfma_f32_32x32x16_bf16 v[80:95], v[172:175], v[160:163], v[80:95]
  ds_read_b128 v[136:139], v236 offset:40960
  s_waitcnt lgkmcnt(7)
  v_mfma_f32_32x32x16_bf16 v[96:111], v[168:171], v[164:167], v[96:111]
  ds_read_b128 v[140:143], v236 offset:45056
  v_mfma_f32_32x32x16_bf16 v[112:127], v[172:175], v[164:167], v[112:127]
  s_waitcnt lgkmcnt(5)
  v_mfma_f32_32x32x16_bf16 v[0:15], v[144:147], v[128:131], v[0:15]
  s_waitcnt lgkmcnt(3)
  v_mfma_f32_32x32x16_bf16 v[16:31], v[148:151], v[128:131], v[16:31]
  ds_read_b64_tr_b16 v[168:169], v243 offset:8192
  ds_read_b64_tr_b16 v[170:171], v243 offset:10240
  v_permlane32_swap_b32 v208, v209
  s_waitcnt lgkmcnt(4)
  v_mfma_f32_32x32x16_bf16 v[32:47], v[144:147], v[132:135], v[32:47]
  ds_read_b128 v[152:155], v237 offset:32768
  v_add_f32 v208, v208, v209
  v_mfma_f32_32x32x16_bf16 v[48:63], v[148:151], v[132:135], v[48:63]
  ds_read_b64_tr_b16 v[172:173], v243 offset:9216
  ds_read_b64_tr_b16 v[174:175], v243 offset:11264
  v_or_b32 v208, 1, v208
  s_waitcnt lgkmcnt(6)
  v_mfma_f32_32x32x16_bf16 v[64:79], v[144:147], v[136:139], v[64:79]
  ds_read_b128 v[156:159], v237 offset:36864
  v_mfma_f32_32x32x16_bf16 v[80:95], v[148:151], v[136:139], v[80:95]
  ds_read_b128 v[160:163], v237 offset:40960
  s_waitcnt lgkmcnt(7)
  v_mfma_f32_32x32x16_bf16 v[96:111], v[144:147], v[140:143], v[96:111]
  ds_read_b128 v[164:167], v237 offset:45056
  v_mfma_f32_32x32x16_bf16 v[112:127], v[148:151], v[140:143], v[112:127]
  s_waitcnt lgkmcnt(5)
  v_mfma_f32_32x32x16_bf16 v[0:15], v[168:171], v[152:155], v[0:15]
  s_cmp_lg_u32 s40, 0
  s_cbranch_scc1 fb_c10
  s_waitcnt vmcnt(0)
  s_mov_b32 s3, 0
  s_branch pl4_chk
pl4:
  buffer_load_dword v241, v242, s[56:59], 0 offen sc1
  s_waitcnt vmcnt(0)
pl4_chk:
  v_cmp_eq_u32 vcc, 0, v241
  s_add_u32 s3, s3, 1
  s_cbranch_vccz pl4_ok
  s_sleep 8
  s_cmp_lt_u32 s3, 200000
  s_cbranch_scc1 pl4
pl4_ok:
fb_c10:
  s_waitcnt lgkmcnt(3)
  v_mfma_f32_32x32x16_bf16 v[16:31], v[172:175], v[152:155], v[16:31]
  s_barrier
  ds_read_b64_tr_b16 v[144:145], v243 offset:16384
  ds_read_b64_tr_b16 v[146:147], v243 offset:18432
  s_waitcnt lgkmcnt(4)
  v_mfma_f32_32x32x16_bf16 v[32:47], v[168:171], v[156:159], v[32:47]
  ds_read_b128 v[128:131], v238 offset:32768
  s_mov_b32 exec_lo, 0x10000
  s_mov_b32 exec_hi, 0x10000
  buffer_store_dwordx4 v[176:179], v180, s[24:27], s63 offen sc1
  s_mov_b64 exec, -1
  v_mfma_f32_32x32x16_bf16 v[48:63], v[172:175], v[156:159], v[48:63]
  ds_read_b64_tr_b16 v[148:149], v243 offset:17408
  ds_read_b64_tr_b16 v[150:151], v243 offset:19456
  s_waitcnt lgkmcnt(6)
  v_mfma_f32_32x32x16_bf16 v[64:79], v[168:171], v[160:163], v[64:79]
  ds_read_b128 v[132:135], v238 offset:36864
  v_mfma_f32_32x32x16_bf16 v[80:95], v[172:175], v[160:163], v[80:95]
  ds_read_b128 v[136:139], v238 offset:40960
  s_waitcnt lgkmcnt(7)
  v_mfma_f32_32x32x16_bf16 v[96:111], v[168:171], v[164:167], v[96:111]
  ds_read_b128 v[140:143], v238 offset:45056
  v_mfma_f32_32x32x16_bf16 v[112:127], v[172:175], v[164:167], v[112:127]
  s_waitcnt lgkmcnt(5)
  v_mfma_f32_32x32x16_bf16 v[0:15], v[144:147], v[128:131], v[0:15]
  s_waitcnt lgkmcnt(3)
  v_mfma_f32_32x32x16_bf16 v[16:31], v[148:151], v[128:131], v[16:31]
  ds_read_b64_tr_b16 v[168:169], v243 offset:24576
  ds_read_b64_tr_b16 v[170:171], v243 offset:26624
  s_waitcnt lgkmcnt(4)
  v_mfma_f32_32x32x16_bf16 v[32:47], v[144:147], v[132:135], v[32:47]
  ds_read_b128 v[152:155], v239 offset:32768
  v_mfma_f32_32x32x16_bf16 v[48:63], v[148:151], v[132:135], v[48:63]
  ds_read_b64_tr_b16 v[172:173], v243 offset:25600
  ds_read_b64_tr_b16 v[174:175], v243 offset:27648
  s_waitcnt lgkmcnt(6)
  v_mfma_f32_32x32x16_bf16 v[64:79], v[144:147], v[136:139], v[64:79]
  ds_read_b128 v[156:159], v239 offset:36864
  buffer_store_dword v208, v250, s[24:27], s21 offen sc1
  v_mfma_f32_32x32x16_bf16 v[80:95], v[148:151], v[136:139], v[80:95]
  ds_read_b128 v[160:163], v239 offset:40960
  s_waitcnt lgkmcnt(7)
  v_mfma_f32_32x32x16_bf16 v[96:111], v[144:147], v[140:143], v[96:111]
  ds_read_b128 v[164:167], v239 offset:45056
  v_mfma_f32_32x32x16_bf16 v[112:127], v[148:151], v[140:143], v[112:127]
  s_waitcnt lgkmcnt(5)
  v_mfma_f32_32x32x16_bf16 v[0:15], v[168:171], v[152:155], v[0:15]
  s_waitcnt lgkmcnt(3)
  v_mfma_f32_32x32x16_bf16 v[16:31], v[172:175], v[152:155], v[16:31]
  s_barrier
  ds_read_b64_tr_b16 v[144:145], v240 offset:0
  ds_read_b64_tr_b16 v[146:147], v240 offset:2048
  s_waitcnt lgkmcnt(4)
  v_mfma_f32_32x32x16_bf16 v[32:47], v[168:171], v[156:159], v[32:47]
  ds_read_b128 v[128:131], v236 offset:49152
  v_mfma_f32_32x32x16_bf16 v[48:63], v[172:175], v[156:159], v[48:63]
  ds_read_b64_tr_b16 v[148:149], v240 offset:1024
  ds_read_b64_tr_b16 v[150:151], v240 offset:3072
  s_waitcnt lgkmcnt(6)
  v_mfma_f32_32x32x16_bf16 v[64:79], v[168:171], v[160:163], v[64:79]
  ds_read_b128 v[132:135], v236 offset:53248
  v_mfma_f32_32x32x16_bf16 v[80:95], v[172:175], v[160:163], v[80:95]
  ds_read_b128 v[136:139], v236 offset:57344
  s_waitcnt lgkmcnt(7)
  v_mfma_f32_32x32x16_bf16 v[96:111], v[168:171], v[164:167], v[96:111]
  ds_read_b128 v[140:143], v236 offset:61440
  v_mfma_f32_32x32x16_bf16 v[112:127], v[172:175], v[164:167], v[112:127]
  s_waitcnt lgkmcnt(5)
  v_mfma_f32_32x32x16_bf16 v[0:15], v[144:147], v[128:131], v[0:15]
  s_waitcnt lgkmcnt(3)
  v_mfma_f32_32x32x16_bf16 v[16:31], v[148:151], v[128:131], v[16:31]
  ds_read_b64_tr_b16 v[168:169], v240 offset:8192
  ds_read_b64_tr_b16 v[170:171], v240 offset:10240
  s_waitcnt lgkmcnt(4)
  v_mfma_f32_32x32x16_bf16 v[32:47], v[144:147], v[132:135], v[32:47]
  ds_read_b128 v[152:155], v237 offset:49152
  v_mfma_f32_32x32x16_bf16 v[48:63], v[148:151], v[132:135], v[48:63]
  ds_read_b64_tr_b16 v[172:173], v240 offset:9216
  ds_read_b64_tr_b16 v[174:175], v240 offset:11264
  s_waitcnt lgkmcnt(6)
  v_mfma_f32_32x32x16_bf16 v[64:79], v[144:147], v[136:139], v[64:79]
  ds_read_b128 v[156:159], v237 offset:53248
  v_mfma_f32_32x32x16_bf16 v[80:95], v[148:151], v[136:139], v[80:95]
  ds_read_b128 v[160:163], v237 offset:57344
  s_waitcnt lgkmcnt(7)
  v_mfma_f32_32x32x16_bf16 v[96:111], v[144:147], v[140:143], v[96:111]
  ds_read_b128 v[164:167], v237 offset:61440
  v_mfma_f32_32x32x16_bf16 v[112:127], v[148:151], v[140:143], v[112:127]
  s_waitcnt lgkmcnt(5)
  v_mfma_f32_32x32x16_bf16 v[0:15], v[168:171], v[152:155], v[0:15]
  s_waitcnt lgkmcnt(3)
  v_mfma_f32_32x32x16_bf16 v[16:31], v[172:175], v[152:155], v[16:31]
  s_barrier
  ds_read_b64_tr_b16 v[144:145], v240 offset:16384
  ds_read_b64_tr_b16 v[146:147], v240 offset:18432
  s_waitcnt lgkmcnt(4)
  v_mfma_f32_32x32x16_bf16 v[32:47], v[168:171], v[156:159], v[32:47]
  ds_read_b128 v[128:131], v238 offset:49152
  v_mfma_f32_32x32x16_bf16 v[48:63], v[172:175], v[156:159], v[48:63]
  ds_read_b64_tr_b16 v[148:149], v240 offset:17408
  ds_read_b64_tr_b16 v[150:151], v240 offset:19456
  s_waitcnt lgkmcnt(6)
  v_mfma_f32_32x32x16_bf16 v[64:79], v[168:171], v[160:163], v[64:79]
  ds_read_b128 v[132:135], v238 offset:53248
  v_mfma_f32_32x32x16_bf16 v[80:95], v[172:175], v[160:163], v[80:95]
  ds_read_b128 v[136:139], v238 offset:57344
  s_waitcnt lgkmcnt(7)
  v_mfma_f32_32x32x16_bf16 v[96:111], v[168:171], v[164:167], v[96:111]
  ds_read_b128 v[140:143], v238 offset:61440
  v_mfma_f32_32x32x16_bf16 v[112:127], v[172:175], v[164:167], v[112:127]
  s_waitcnt lgkmcnt(5)
  v_mfma_f32_32x32x16_bf16 v[0:15], v[144:147], v[128:131], v[0:15]
  s_waitcnt lgkmcnt(3)
  v_mfma_f32_32x32x16_bf16 v[16:31], v[148:151], v[128:131], v[16:31]
  ds_read_b64_tr_b16 v[168:169], v240 offset:24576
  ds_read_b64_tr_b16 v[170:171], v240 offset:26624
  s_waitcnt lgkmcnt(4)
  v_mfma_f32_32x32x16_bf16 v[32:47], v[144:147], v[132:135], v[32:47]
  ds_read_b128 v[152:155], v239 offset:49152
  v_mfma_f32_32x32x16_bf16 v[48:63], v[148:151], v[132:135], v[48:63]
  ds_read_b64_tr_b16 v[172:173], v240 offset:25600
  ds_read_b64_tr_b16 v[174:175], v240 offset:27648
  s_waitcnt lgkmcnt(6)
  v_mfma_f32_32x32x16_bf16 v[64:79], v[144:147], v[136:139], v[64:79]
  ds_read_b128 v[156:159], v239 offset:53248
  v_mfma_f32_32x32x16_bf16 v[80:95], v[148:151], v[136:139], v[80:95]
  ds_read_b128 v[160:163], v239 offset:57344
  s_waitcnt lgkmcnt(7)
  v_mfma_f32_32x32x16_bf16 v[96:111], v[144:147], v[140:143], v[96:111]
  ds_read_b128 v[164:167], v239 offset:61440
  v_mfma_f32_32x32x16_bf16 v[112:127], v[148:151], v[140:143], v[112:127]
  s_waitcnt lgkmcnt(5)
  v_mfma_f32_32x32x16_bf16 v[0:15], v[168:171], v[152:155], v[0:15]
  s_waitcnt lgkmcnt(3)
  v_mfma_f32_32x32x16_bf16 v[16:31], v[172:175], v[152:155], v[16:31]
  s_barrier
  ds_read_b64_tr_b16 v[144:145], v240 offset:32768
  ds_read_b64_tr_b16 v[146:147], v240 offset:34816
  s_waitcnt lgkmcnt(4)
  v_mfma_f32_32x32x16_bf16 v[32:47], v[168:171], v[156:159], v[32:47]
  ds_read_b128 v[128:131], v236 offset:0
  v_mfma_f32_32x32x16_bf16 v[48:63], v[172:175], v[156:159], v[48:63]
  ds_read_b64_tr_b16 v[148:149], v240 offset:33792
  ds_read_b64_tr_b16 v[150:151], v240 offset:35840
  s_waitcnt lgkmcnt(6)
  v_mfma_f32_32x32x16_bf16 v[64:79], v[168:171], v[160:163], v[64:79]
  ds_read_b128 v[132:135], v236 offset:4096
  v_mfma_f32_32x32x16_bf16 v[80:95], v[172:175], v[160:163], v[80:95]
  ds_read_b128 v[136:139], v236 offset:8192
  s_waitcnt lgkmcnt(7)
  v_mfma_f32_32x32x16_bf16 v[96:111], v[168:171], v[164:167], v[96:111]
  ds_read_b128 v[140:143], v236 offset:12288
  v_mfma_f32_32x32x16_bf16 v[112:127], v[172:175], v[164:167], v[112:127]
  s_waitcnt lgkmcnt(5)
  v_mfma_f32_32x32x16_bf16 v[0:15], v[144:147], v[128:131], v[0:15]
  s_waitcnt lgkmcnt(3)
  v_mfma_f32_32x32x16_bf16 v[16:31], v[148:151], v[128:131], v[16:31]
  ds_read_b64_tr_b16 v[168:169], v240 offset:40960
  ds_read_b64_tr_b16 v[170:171], v240 offset:43008
  s_waitcnt lgkmcnt(4)
  v_mfma_f32_32x32x16_bf16 v[32:47], v[144:147], v[132:135], v[32:47]
  ds_read_b128 v[152:155], v237 offset:0
  v_mfma_f32_32x32x16_bf16 v[48:63], v[148:151], v[132:135], v[48:63]
  ds_read_b64_tr_b16 v[172:173], v240 offset:41984
  ds_read_b64_tr_b16 v[174:175], v240 offset:44032
  s_waitcnt lgkmcnt(6)
  v_mfma_f32_32x32x16_bf16 v[64:79], v[144:147], v[136:139], v[64:79]
  ds_read_b128 v[156:159], v237 offset:4096
  v_mfma_f32_32x32x16_bf16 v[80:95], v[148:151], v[136:139], v[80:95]
  ds_read_b128 v[160:163], v237 offset:8192
  s_waitcnt lgkmcnt(7)
  v_mfma_f32_32x32x16_bf16 v[96:111], v[144:147], v[140:143], v[96:111]
  ds_read_b128 v[164:167], v237 offset:12288
  v_mfma_f32_32x32x16_bf16 v[112:127], v[148:151], v[140:143], v[112:127]
  s_waitcnt lgkmcnt(5)
  v_mfma_f32_32x32x16_bf16 v[0:15], v[168:171], v[152:155], v[0:15]
  s_waitcnt lgkmcnt(3)
  v_mfma_f32_32x32x16_bf16 v[16:31], v[172:175], v[152:155], v[16:31]
  s_barrier
  ds_read_b64_tr_b16 v[144:145], v240 offset:49152
  ds_read_b64_tr_b16 v[146:147], v240 offset:51200
  s_waitcnt lgkmcnt(4)
  v_mfma_f32_32x32x16_bf16 v[32:47], v[168:171], v[156:159], v[32:47]
  ds_read_b128 v[128:131], v238 offset:0
  v_mfma_f32_32x32x16_bf16 v[48:63], v[172:175], v[156:159], v[48:63]
  ds_read_b64_tr_b16 v[148:149], v240 offset:50176
  ds_read_b64_tr_b16 v[150:151], v240 offset:52224
  s_waitcnt lgkmcnt(6)
  v_mfma_f32_32x32x16_bf16 v[64:79], v[168:171], v[160:163], v[64:79]
  ds_read_b128 v[132:135], v238 offset:4096
  v_mfma_f32_32x32x16_bf16 v[80:95], v[172:175], v[160:163], v[80:95]
  ds_read_b128 v[136:139], v238 offset:8192
  s_waitcnt lgkmcnt(7)
  v_mfma_f32_32x32x16_bf16 v[96:111], v[168:171], v[164:167], v[96:111]
  ds_read_b128 v[140:143], v238 offset:12288
  v_mfma_f32_32x32x16_bf16 v[112:127], v[172:175], v[164:167], v[112:127]
  s_waitcnt lgkmcnt(5)
  v_mfma_f32_32x32x16_bf16 v[0:15], v[144:147], v[128:131], v[0:15]
  s_waitcnt lgkmcnt(3)
  v_mfma_f32_32x32x16_bf16 v[16:31], v[148:151], v[128:131], v[16:31]
  ds_read_b64_tr_b16 v[168:169], v240 offset:57344
  ds_read_b64_tr_b16 v[170:171], v240 offset:59392
  s_waitcnt lgkmcnt(4)
  v_mfma_f32_32x32x16_bf16 v[32:47], v[144:147], v[132:135], v[32:47]
  ds_read_b128 v[152:155], v239 offset:0
  v_mfma_f32_32x32x16_bf16 v[48:63], v[148:151], v[132:135], v[48:63]
  ds_read_b64_tr_b16 v[172:173], v240 offset:58368
  ds_read_b64_tr_b16 v[174:175], v240 offset:60416
  s_waitcnt lgkmcnt(6)
  v_mfma_f32_32x32x16_bf16 v[64:79], v[144:147], v[136:139], v[64:79]
  ds_read_b128 v[156:159], v239 offset:4096
  v_mfma_f32_32x32x16_bf16 v[80:95], v[148:151], v[136:139], v[80:95]
  ds_read_b128 v[160:163], v239 offset:8192
  s_waitcnt lgkmcnt(7)
  v_mfma_f32_32x32x16_bf16 v[96:111], v[144:147], v[140:143], v[96:111]
  ds_read_b128 v[164:167], v239 offset:12288
  v_mfma_f32_32x32x16_bf16 v[112:127], v[148:151], v[140:143], v[112:127]
  s_waitcnt lgkmcnt(5)
  v_mfma_f32_32x32x16_bf16 v[0:15], v[168:171], v[152:155], v[0:15]
  s_waitcnt lgkmcnt(3)
  v_mfma_f32_32x32x16_bf16 v[16:31], v[172:175], v[152:155], v[16:31]
  s_barrier
  ds_read_b64_tr_b16 v[144:145], v243 offset:0
  ds_read_b64_tr_b16 v[146:147], v243 offset:2048
  s_waitcnt lgkmcnt(4)
  v_mfma_f32_32x32x16_bf16 v[32:47], v[168:171], v[156:159], v[32:47]
  ds_read_b128 v[128:131], v236 offset:16384
  v_mfma_f32_32x32x16_bf16 v[48:63], v[172:175], v[156:159], v[48:63]
  ds_read_b64_tr_b16 v[148:149], v243 offset:1024
  ds_read_b64_tr_b16 v[150:151], v243 offset:3072
  s_waitcnt lgkmcnt(6)
  v_mfma_f32_32x32x16_bf16 v[64:79], v[168:171], v[160:163], v[64:79]
  ds_read_b128 v[132:135], v236 offset:20480
  v_mfma_f32_32x32x16_bf16 v[80:95], v[172:175], v[160:163], v[80:95]
  ds_read_b128 v[136:139], v236 offset:24576
  s_waitcnt lgkmcnt(7)
  v_mfma_f32_32x32x16_bf16 v[96:111], v[168:171], v[164:167], v[96:111]
  ds_read_b128 v[140:143], v236 offset:28672
  v_mfma_f32_32x32x16_bf16 v[112:127], v[172:175], v[164:167], v[112:127]
  s_waitcnt lgkmcnt(5)
  v_mfma_f32_32x32x16_bf16 v[0:15], v[144:147], v[128:131], v[0:15]
  s_waitcnt lgkmcnt(3)
  v_mfma_f32_32x32x16_bf16 v[16:31], v[148:151], v[128:131], v[16:31]
  ds_read_b64_tr_b16 v[168:169], v243 offset:8192
  ds_read_b64_tr_b16 v[170:171], v243 offset:10240
  s_waitcnt lgkmcnt(4)
  v_mfma_f32_32x32x16_bf16 v[32:47], v[144:147], v[132:135], v[32:47]
  ds_read_b128 v[152:155], v237 offset:16384
  v_mfma_f32_32x32x16_bf16 v[48:63], v[148:151], v[132:135], v[48:63]
  ds_read_b64_tr_b16 v[172:173], v243 offset:9216
  ds_read_b64_tr_b16 v[174:175], v243 offset:11264
  s_waitcnt lgkmcnt(6)
  v_mfma_f32_32x32x16_bf16 v[64:79], v[144:147], v[136:139], v[64:79]
  ds_read_b128 v[156:159], v237 offset:20480
  v_mfma_f32_32x32x16_bf16 v[80:95], v[148:151], v[136:139], v[80:95]
  ds_read_b128 v[160:163], v237 offset:24576
  s_waitcnt lgkmcnt(7)
  v_mfma_f32_32x32x16_bf16 v[96:111], v[144:147], v[140:143], v[96:111]
  ds_read_b128 v[164:167], v237 offset:28672
  v_mfma_f32_32x32x16_bf16 v[112:127], v[148:151], v[140:143], v[112:127]
  s_waitcnt lgkmcnt(5)
  v_mfma_f32_32x32x16_bf16 v[0:15], v[168:171], v[152:155], v[0:15]
  s_waitcnt lgkmcnt(3)
  v_mfma_f32_32x32x16_bf16 v[16:31], v[172:175], v[152:155], v[16:31]
  s_barrier
  ds_read_b64_tr_b16 v[144:145], v243 offset:16384
  ds_read_b64_tr_b16 v[146:147], v243 offset:18432
  s_waitcnt lgkmcnt(4)
  v_mfma_f32_32x32x16_bf16 v[32:47], v[168:171], v[156:159], v[32:47]
  ds_read_b128 v[128:131], v238 offset:16384
  v_mfma_f32_32x32x16_bf16 v[48:63], v[172:175], v[156:159], v[48:63]
  ds_read_b64_tr_b16 v[148:149], v243 offset:17408
  ds_read_b64_tr_b16 v[150:151], v243 offset:19456
  s_waitcnt lgkmcnt(6)
  v_mfma_f32_32x32x16_bf16 v[64:79], v[168:171], v[160:163], v[64:79]
  ds_read_b128 v[132:135], v238 offset:20480
  v_mfma_f32_32x32x16_bf16 v[80:95], v[172:175], v[160:163], v[80:95]
  ds_read_b128 v[136:139], v238 offset:24576
  s_waitcnt lgkmcnt(7)
  v_mfma_f32_32x32x16_bf16 v[96:111], v[168:171], v[164:167], v[96:111]
  ds_read_b128 v[140:143], v238 offset:28672
  v_mfma_f32_32x32x16_bf16 v[112:127], v[172:175], v[164:167], v[112:127]
  s_waitcnt lgkmcnt(5)
  v_mfma_f32_32x32x16_bf16 v[0:15], v[144:147], v[128:131], v[0:15]
  s_waitcnt lgkmcnt(3)
  v_mfma_f32_32x32x16_bf16 v[16:31], v[148:151], v[128:131], v[16:31]
  ds_read_b64_tr_b16 v[168:169], v243 offset:24576
  ds_read_b64_tr_b16 v[170:171], v243 offset:26624
  s_waitcnt lgkmcnt(4)
  v_mfma_f32_32x32x16_bf16 v[32:47], v[144:147], v[132:135], v[32:47]
  ds_read_b128 v[152:155], v239 offset:16384
  v_mfma_f32_32x32x16_bf16 v[48:63], v[148:151], v[132:135], v[48:63]
  ds_read_b64_tr_b16 v[172:173], v243 offset:25600
  ds_read_b64_tr_b16 v[174:175], v243 offset:27648
  s_waitcnt lgkmcnt(6)
  v_mfma_f32_32x32x16_bf16 v[64:79], v[144:147], v[136:139], v[64:79]
  ds_read_b128 v[156:159], v239 offset:20480
  v_mfma_f32_32x32x16_bf16 v[80:95], v[148:151], v[136:139], v[80:95]
  ds_read_b128 v[160:163], v239 offset:24576
  s_waitcnt lgkmcnt(7)
  v_mfma_f32_32x32x16_bf16 v[96:111], v[144:147], v[140:143], v[96:111]
  ds_read_b128 v[164:167], v239 offset:28672
  v_mfma_f32_32x32x16_bf16 v[112:127], v[148:151], v[140:143], v[112:127]
  s_waitcnt lgkmcnt(5)
  v_mfma_f32_32x32x16_bf16 v[0:15], v[168:171], v[152:155], v[0:15]
  s_waitcnt lgkmcnt(3)
  v_mfma_f32_32x32x16_bf16 v[16:31], v[172:175], v[152:155], v[16:31]
  s_barrier
  ds_read_b64_tr_b16 v[144:145], v240 offset:0
  ds_read_b64_tr_b16 v[146:147], v240 offset:2048
  s_waitcnt lgkmcnt(4)
  v_mfma_f32_32x32x16_bf16 v[32:47], v[168:171], v[156:159], v[32:47]
  ds_read_b128 v[128:131], v236 offset:32768
  v_mfma_f32_32x32x16_bf16 v[48:63], v[172:175], v[156:159], v[48:63]
  ds_read_b64_tr_b16 v[148:149], v240 offset:1024
  ds_read_b64_tr_b16 v[150:151], v240 offset:3072
  s_waitcnt lgkmcnt(6)
  v_mfma_f32_32x32x16_bf16 v[64:79], v[168:171], v[160:163], v[64:79]
  ds_read_b128 v[132:135], v236 offset:36864
  v_mfma_f32_32x32x16_bf16 v[80:95], v[172:175], v[160:163], v[80:95]
  ds_read_b128 v[136:139], v236 offset:40960
  s_waitcnt lgkmcnt(7)
  v_mfma_f32_32x32x16_bf16 v[96:111], v[168:171], v[164:167], v[96:111]
  ds_read_b128 v[140:143], v236 offset:45056
  v_mfma_f32_32x32x16_bf16 v[112:127], v[172:175], v[164:167], v[112:127]
  s_waitcnt lgkmcnt(5)
  v_mfma_f32_32x32x16_bf16 v[0:15], v[144:147], v[128:131], v[0:15]
  s_waitcnt lgkmcnt(3)
  v_mfma_f32_32x32x16_bf16 v[16:31], v[148:151], v[128:131], v[16:31]
  ds_read_b64_tr_b16 v[168:169], v240 offset:8192
  ds_read_b64_tr_b16 v[170:171], v240 offset:10240
  s_waitcnt lgkmcnt(4)
  v_mfma_f32_32x32x16_bf16 v[32:47], v[144:147], v[132:135], v[32:47]
  ds_read_b128 v[152:155], v237 offset:32768
  v_mfma_f32_32x32x16_bf16 v[48:63], v[148:151], v[132:135], v[48:63]
  ds_read_b64_tr_b16 v[172:173], v240 offset:9216
  ds_read_b64_tr_b16 v[174:175], v240 offset:11264
  s_waitcnt lgkmcnt(6)
  v_mfma_f32_32x32x16_bf16 v[64:79], v[144:147], v[136:139], v[64:79]
  ds_read_b128 v[156:159], v237 offset:36864
  v_mfma_f32_32x32x16_bf16 v[80:95], v[148:151], v[136:139], v[80:95]
  ds_read_b128 v[160:163], v237 offset:40960
  s_waitcnt lgkmcnt(7)
  v_mfma_f32_32x32x16_bf16 v[96:111], v[144:147], v[140:143], v[96:111]
  ds_read_b128 v[164:167], v237 offset:45056
  v_mfma_f32_32x32x16_bf16 v[112:127], v[148:151], v[140:143], v[112:127]
  s_waitcnt lgkmcnt(5)
  v_mfma_f32_32x32x16_bf16 v[0:15], v[168:171], v[152:155], v[0:15]
  s_waitcnt lgkmcnt(3)
  v_mfma_f32_32x32x16_bf16 v[16:31], v[172:175], v[152:155], v[16:31]
  s_barrier
  ds_read_b64_tr_b16 v[144:145], v240 offset:16384
  ds_read_b64_tr_b16 v[146:147], v240 offset:18432
  s_waitcnt lgkmcnt(4)
  v_mfma_f32_32x32x16_bf16 v[32:47], v[168:171], v[156:159], v[32:47]
  ds_read_b128 v[128:131], v238 offset:32768
  v_mfma_f32_32x32x16_bf16 v[48:63], v[172:175], v[156:159], v[48:63]
  ds_read_b64_tr_b16 v[148:149], v240 offset:17408
  ds_read_b64_tr_b16 v[150:151], v240 offset:19456
  s_waitcnt lgkmcnt(6)
  v_mfma_f32_32x32x16_bf16 v[64:79], v[168:171], v[160:163], v[64:79]
  ds_read_b128 v[132:135], v238 offset:36864
  v_mfma_f32_32x32x16_bf16 v[80:95], v[172:175], v[160:163], v[80:95]
  ds_read_b128 v[136:139], v238 offset:40960
  s_waitcnt lgkmcnt(7)
  v_mfma_f32_32x32x16_bf16 v[96:111], v[168:171], v[164:167], v[96:111]
  ds_read_b128 v[140:143], v238 offset:45056
  v_mfma_f32_32x32x16_bf16 v[112:127], v[172:175], v[164:167], v[112:127]
  s_waitcnt lgkmcnt(5)
  v_mfma_f32_32x32x16_bf16 v[0:15], v[144:147], v[128:131], v[0:15]
  s_waitcnt lgkmcnt(3)
  v_mfma_f32_32x32x16_bf16 v[16:31], v[148:151], v[128:131], v[16:31]
  ds_read_b64_tr_b16 v[168:169], v240 offset:24576
  ds_read_b64_tr_b16 v[170:171], v240 offset:26624
  s_waitcnt lgkmcnt(4)
  v_mfma_f32_32x32x16_bf16 v[32:47], v[144:147], v[132:135], v[32:47]
  ds_read_b128 v[152:155], v239 offset:32768
  v_mfma_f32_32x32x16_bf16 v[48:63], v[148:151], v[132:135], v[48:63]
  ds_read_b64_tr_b16 v[172:173], v240 offset:25600
  ds_read_b64_tr_b16 v[174:175], v240 offset:27648
  s_waitcnt lgkmcnt(6)
  v_mfma_f32_32x32x16_bf16 v[64:79], v[144:147], v[136:139], v[64:79]
  ds_read_b128 v[156:159], v239 offset:36864
  v_mfma_f32_32x32x16_bf16 v[80:95], v[148:151], v[136:139], v[80:95]
  ds_read_b128 v[160:163], v239 offset:40960
  s_waitcnt lgkmcnt(7)
  v_mfma_f32_32x32x16_bf16 v[96:111], v[144:147], v[140:143], v[96:111]
  ds_read_b128 v[164:167], v239 offset:45056
  v_mfma_f32_32x32x16_bf16 v[112:127], v[148:151], v[140:143], v[112:127]
  s_waitcnt lgkmcnt(5)
  v_mfma_f32_32x32x16_bf16 v[0:15], v[168:171], v[152:155], v[0:15]
  s_waitcnt lgkmcnt(3)
  v_mfma_f32_32x32x16_bf16 v[16:31], v[172:175], v[152:155], v[16:31]
  s_barrier
  ds_read_b128 v[192:195], v217
  ds_read_b128 v[176:179], v216 offset:0
  s_waitcnt lgkmcnt(4)
  v_mfma_f32_32x32x16_bf16 v[32:47], v[168:171], v[156:159], v[32:47]
  ds_read_b128 v[180:183], v216 offset:512
  v_mfma_f32_32x32x16_bf16 v[48:63], v[172:175], v[156:159], v[48:63]
  ds_read_b128 v[184:187], v216 offset:1024
  ds_read_b128 v[188:191], v216 offset:1536
  s_waitcnt lgkmcnt(6)
  v_mfma_f32_32x32x16_bf16 v[64:79], v[168:171], v[160:163], v[64:79]
  v_mfma_f32_32x32x16_bf16 v[80:95], v[172:175], v[160:163], v[80:95]
  s_waitcnt lgkmcnt(5)
  v_mfma_f32_32x32x16_bf16 v[96:111], v[168:171], v[164:167], v[96:111]
  v_mfma_f32_32x32x16_bf16 v[112:127], v[172:175], v[164:167], v[112:127]
  s_waitcnt lgkmcnt(0)
  v_mfma_f32_32x32x8_bf16 v[0:15], v[192:193], v[176:177], v[0:15]
  v_mfma_f32_32x32x8_bf16 v[16:31], v[194:195], v[176:177], v[16:31]
  v_mfma_f32_32x32x8_bf16 v[32:47], v[192:193], v[180:181], v[32:47]
  v_mfma_f32_32x32x8_bf16 v[48:63], v[194:195], v[180:181], v[48:63]
  s_nop 0
  v_mfma_f32_32x32x8_bf16 v[64:79], v[192:193], v[184:185], v[64:79]
  v_mfma_f32_32x32x8_bf16 v[80:95], v[194:195], v[184:185], v[80:95]
  s_nop 0
  v_mfma_f32_32x32x8_bf16 v[96:111], v[192:193], v[188:189], v[96:111]
  v_mfma_f32_32x32x8_bf16 v[112:127], v[194:195], v[188:189], v[112:127]
  s_nop 2
  v_pk_mul_f32 v[0:1], v[0:1], v[178:179] op_sel_hi:[1,0]
  v_pk_mul_f32 v[2:3], v[2:3], v[178:179] op_sel_hi:[1,0]
  v_pk_mul_f32 v[4:5], v[4:5], v[178:179] op_sel_hi:[1,0]
  v_pk_mul_f32 v[6:7], v[6:7], v[178:179] op_sel_hi:[1,0]
  v_pk_mul_f32 v[8:9], v[8:9], v[178:179] op_sel_hi:[1,0]
  v_pk_mul_f32 v[10:11], v[10:11], v[178:179] op_sel_hi:[1,0]
  v_pk_mul_f32 v[12:13], v[12:13], v[178:179] op_sel_hi:[1,0]
  v_pk_mul_f32 v[14:15], v[14:15], v[178:179] op_sel_hi:[1,0]
  v_pk_mul_f32 v[0:1], v[0:1], v[16:17]
  v_pk_mul_f32 v[2:3], v[2:3], v[18:19]
  v_pk_mul_f32 v[4:5], v[4:5], v[20:21]
  v_pk_mul_f32 v[6:7], v[6:7], v[22:23]
  v_cvt_pk_bf16_f32 v16, v0, v1
  v_cvt_pk_bf16_f32 v17, v2, v3
  v_cvt_pk_bf16_f32 v18, v4, v5
  v_cvt_pk_bf16_f32 v19, v6, v7
  buffer_store_dwordx4 v[16:19], v250, s[24:27], s28 offen offset:0 sc1
  v_pk_mul_f32 v[8:9], v[8:9], v[24:25]
  v_pk_mul_f32 v[10:11], v[10:11], v[26:27]
  v_pk_mul_f32 v[12:13], v[12:13], v[28:29]
  v_pk_mul_f32 v[14:15], v[14:15], v[30:31]
  v_cvt_pk_bf16_f32 v24, v8, v9
  v_cvt_pk_bf16_f32 v25, v10, v11
  v_cvt_pk_bf16_f32 v26, v12, v13
  v_cvt_pk_bf16_f32 v27, v14, v15
  buffer_store_dwordx4 v[24:27], v250, s[24:27], s28 offen offset:1024 sc1
  s_add_u32 s28, s28, 114688
  v_pk_mul_f32 v[32:33], v[32:33], v[182:183] op_sel_hi:[1,0]
  v_pk_mul_f32 v[34:35], v[34:35], v[182:183] op_sel_hi:[1,0]
  v_pk_mul_f32 v[36:37], v[36:37], v[182:183] op_sel_hi:[1,0]
  v_pk_mul_f32 v[38:39], v[38:39], v[182:183] op_sel_hi:[1,0]
  v_pk_mul_f32 v[40:41], v[40:41], v[182:183] op_sel_hi:[1,0]
  v_pk_mul_f32 v[42:43], v[42:43], v[182:183] op_sel_hi:[1,0]
  v_pk_mul_f32 v[44:45], v[44:45], v[182:183] op_sel_hi:[1,0]
  v_pk_mul_f32 v[46:47], v[46:47], v[182:183] op_sel_hi:[1,0]
  v_pk_mul_f32 v[32:33], v[32:33], v[48:49]
  v_pk_mul_f32 v[34:35], v[34:35], v[50:51]
  v_pk_mul_f32 v[36:37], v[36:37], v[52:53]
  v_pk_mul_f32 v[38:39], v[38:39], v[54:55]
  v_cvt_pk_bf16_f32 v48, v32, v33
  v_cvt_pk_bf16_f32 v49, v34, v35
  v_cvt_pk_bf16_f32 v50, v36, v37
  v_cvt_pk_bf16_f32 v51, v38, v39
  buffer_store_dwordx4 v[48:51], v250, s[24:27], s28 offen offset:0 sc1
  v_pk_mul_f32 v[40:41], v[40:41], v[56:57]
  v_pk_mul_f32 v[42:43], v[42:43], v[58:59]
  v_pk_mul_f32 v[44:45], v[44:45], v[60:61]
  v_pk_mul_f32 v[46:47], v[46:47], v[62:63]
  v_cvt_pk_bf16_f32 v56, v40, v41
  v_cvt_pk_bf16_f32 v57, v42, v43
  v_cvt_pk_bf16_f32 v58, v44, v45
  v_cvt_pk_bf16_f32 v59, v46, v47
  buffer_store_dwordx4 v[56:59], v250, s[24:27], s28 offen offset:1024 sc1
  s_add_u32 s28, s28, 114688
  v_pk_mul_f32 v[64:65], v[64:65], v[186:187] op_sel_hi:[1,0]
  v_pk_mul_f32 v[66:67], v[66:67], v[186:187] op_sel_hi:[1,0]
  v_pk_mul_f32 v[68:69], v[68:69], v[186:187] op_sel_hi:[1,0]
  v_pk_mul_f32 v[70:71], v[70:71], v[186:187] op_sel_hi:[1,0]
  v_pk_mul_f32 v[72:73], v[72:73], v[186:187] op_sel_hi:[1,0]
  v_pk_mul_f32 v[74:75], v[74:75], v[186:187] op_sel_hi:[1,0]
  v_pk_mul_f32 v[76:77], v[76:77], v[186:187] op_sel_hi:[1,0]
  v_pk_mul_f32 v[78:79], v[78:79], v[186:187] op_sel_hi:[1,0]
  v_pk_mul_f32 v[64:65], v[64:65], v[80:81]
  v_pk_mul_f32 v[66:67], v[66:67], v[82:83]
  v_pk_mul_f32 v[68:69], v[68:69], v[84:85]
  v_pk_mul_f32 v[70:71], v[70:71], v[86:87]
  v_cvt_pk_bf16_f32 v80, v64, v65
  v_cvt_pk_bf16_f32 v81, v66, v67
  v_cvt_pk_bf16_f32 v82, v68, v69
  v_cvt_pk_bf16_f32 v83, v70, v71
  buffer_store_dwordx4 v[80:83], v250, s[24:27], s28 offen offset:0 sc1
  v_pk_mul_f32 v[72:73], v[72:73], v[88:89]
  v_pk_mul_f32 v[74:75], v[74:75], v[90:91]
  v_pk_mul_f32 v[76:77], v[76:77], v[92:93]
  v_pk_mul_f32 v[78:79], v[78:79], v[94:95]
  v_cvt_pk_bf16_f32 v88, v72, v73
  v_cvt_pk_bf16_f32 v89, v74, v75
  v_cvt_pk_bf16_f32 v90, v76, v77
  v_cvt_pk_bf16_f32 v91, v78, v79
  buffer_store_dwordx4 v[88:91], v250, s[24:27], s28 offen offset:1024 sc1
  s_add_u32 s28, s28, 114688
  v_pk_mul_f32 v[96:97], v[96:97], v[190:191] op_sel_hi:[1,0]
  v_pk_mul_f32 v[98:99], v[98:99], v[190:191] op_sel_hi:[1,0]
  v_pk_mul_f32 v[100:101], v[100:101], v[190:191] op_sel_hi:[1,0]
  v_pk_mul_f32 v[102:103], v[102:103], v[190:191] op_sel_hi:[1,0]
  v_pk_mul_f32 v[104:105], v[104:105], v[190:191] op_sel_hi:[1,0]
  v_pk_mul_f32 v[106:107], v[106:107], v[190:191] op_sel_hi:[1,0]
  v_pk_mul_f32 v[108:109], v[108:109], v[190:191] op_sel_hi:[1,0]
  v_pk_mul_f32 v[110:111], v[110:111], v[190:191] op_sel_hi:[1,0]
  v_pk_mul_f32 v[96:97], v[96:97], v[112:113]
  v_pk_mul_f32 v[98:99], v[98:99], v[114:115]
  v_pk_mul_f32 v[100:101], v[100:101], v[116:117]
  v_pk_mul_f32 v[102:103], v[102:103], v[118:119]
  v_cvt_pk_bf16_f32 v112, v96, v97
  v_cvt_pk_bf16_f32 v113, v98, v99
  v_cvt_pk_bf16_f32 v114, v100, v101
  v_cvt_pk_bf16_f32 v115, v102, v103
  buffer_store_dwordx4 v[112:115], v250, s[24:27], s28 offen offset:0 sc1
  v_pk_mul_f32 v[104:105], v[104:105], v[120:121]
  v_pk_mul_f32 v[106:107], v[106:107], v[122:123]
  v_pk_mul_f32 v[108:109], v[108:109], v[124:125]
  v_pk_mul_f32 v[110:111], v[110:111], v[126:127]
  v_cvt_pk_bf16_f32 v120, v104, v105
  v_cvt_pk_bf16_f32 v121, v106, v107
  v_cvt_pk_bf16_f32 v122, v108, v109
  v_cvt_pk_bf16_f32 v123, v110, v111
  buffer_store_dwordx4 v[120:123], v250, s[24:27], s28 offen offset:1024 sc1
  ds_read_b64_tr_b16 v[148:149], v244 offset:32768
  ds_read_b64_tr_b16 v[150:151], v244 offset:33792
  ds_read_b64_tr_b16 v[152:153], v247 offset:32768
  ds_read_b64_tr_b16 v[154:155], v247 offset:33792
  ds_read_b64_tr_b16 v[156:157], v244 offset:34816
  ds_read_b64_tr_b16 v[158:159], v244 offset:35840
  ds_read_b64_tr_b16 v[160:161], v247 offset:34816
  ds_read_b64_tr_b16 v[162:163], v247 offset:35840
  ds_read_b64_tr_b16 v[164:165], v244 offset:36864
  ds_read_b64_tr_b16 v[166:167], v244 offset:37888
  ds_read_b64_tr_b16 v[168:169], v247 offset:36864
  ds_read_b64_tr_b16 v[170:171], v247 offset:37888
  ds_read_b64_tr_b16 v[172:173], v244 offset:38912
  ds_read_b64_tr_b16 v[174:175], v244 offset:39936
  ds_read_b64_tr_b16 v[176:177], v247 offset:38912
  ds_read_b64_tr_b16 v[178:179], v247 offset:39936
  ds_read_b64_tr_b16 v[180:181], v246 offset:16384
  ds_read_b64_tr_b16 v[182:183], v246 offset:17408
  ds_read_b64_tr_b16 v[184:185], v249 offset:16384
  ds_read_b64_tr_b16 v[186:187], v249 offset:17408
  ds_read_b64_tr_b16 v[188:189], v246 offset:18432
  ds_read_b64_tr_b16 v[190:191], v246 offset:19456
  ds_read_b64_tr_b16 v[192:193], v249 offset:18432
  ds_read_b64_tr_b16 v[194:195], v249 offset:19456
  ds_read_b64_tr_b16 v[196:197], v246 offset:20480
  ds_read_b64_tr_b16 v[198:199], v246 offset:21504
  ds_read_b64_tr_b16 v[200:201], v249 offset:20480
  ds_read_b64_tr_b16 v[202:203], v249 offset:21504
  ds_read_b64_tr_b16 v[204:205], v246 offset:22528
  ds_read_b64_tr_b16 v[206:207], v246 offset:23552
  ds_read_b64_tr_b16 v[208:209], v249 offset:22528
  ds_read_b64_tr_b16 v[210:211], v249 offset:23552
  v_min_u32 v220, 5, v254
  v_add_u32 v220, s16, v220
  v_subrev_u32 v252, 7, v220
  v_min_u32 v220, v220, v252
  v_lshlrev_b32 v220, 7, v220
  s_lshl1_add_u32 s52, s14, s15
  s_lshl_b32 s52, s52, 10
  s_add_u32 s52, s52, 19923072
  s_xor_b32 s46, s15, 1
  s_lshl1_add_u32 s46, s46, s44
  s_lshl2_add_u32 s49, s14, s46
  s_mul_i32 s48, s49, 114688
  s_mul_i32 s46, s15, 57344
  s_add_u32 s48, s48, s46
  s_lshl_b32 s46, s45, 12
  s_add_u32 s48, s48, s46
  s_add_u32 s47, s48, 57344
  s_lshl_b32 s46, s16, 13
  s_add_u32 s46, s46, s48
  s_sub_u32 s46, s46, 8192
  s_mov_b32 s48, s46
  s_lshl_b32 s50, s18, 2
  s_lshr_b32 s50, 0x6431, s50
  s_and_b32 s50, s50, 15
  s_mul_i32 s50, s50, 8192
  s_lshl_b32 s53, s2, 14
  s_lshl1_add_u32 s54, s44, s45
  s_lshl_b32 s55, s54, 12
  s_add_u32 s53, s53, s55
  s_lshl_b32 s55, s45, 11
  s_add_u32 s53, s53, s55
  s_add_u32 s53, s53, 14680064
  s_xor_b32 s55, s53, 2048
  s_lshl_b32 s56, s2, 7
  s_lshl2_add_u32 s56, s54, s56
  s_add_u32 s56, s56, 19955712
  s_mov_b32 s57, 19988480
  v_and_b32 v224, 31, v254
  v_lshlrev_b32 v224, 7, v224
  v_lshrrev_b32 v252, 3, v254
  s_lshl_b32 s58, s40, 4
  v_add_u32 v252, s58, v252
  v_lshlrev_b32 v221, 10, v252
  v_lshrrev_b32 v252, 4, v254
  v_and_b32 v253, 7, v254
  v_xor_b32 v252, v252, v253
  v_lshlrev_b32 v252, 4, v252
  v_xor_b32 v253, 64, v252
  v_add_u32 v222, v221, v253
  v_add_u32 v222, 7168, v222
  v_add_u32 v221, v221, v252
  s_lshl1_add_u32 s58, s14, s15
  s_lshl_b32 s58, s58, 16
  s_add_u32 s58, s58, 12582912
  s_lshl_b32 s59, s40, 11
  v_lshrrev_b32 v252, 1, v254
  v_lshlrev_b32 v223, 10, v252
  v_and_b32 v252, 1, v254
  v_lshl_add_u32 v223, v252, 4, v223
  s_lshl_b32 s61, s44, 15
  v_add_u32 v223, s61, v223
  v_mov_b32 v252, 1
  v_mov_b32 v253, 0
  s_waitcnt vmcnt(0) lgkmcnt(0)
  s_barrier
  s_cmp_lg_u32 s40, 0
  s_cbranch_scc1 tf_nf
  s_mov_b64 exec, 1
  buffer_store_dword v252, v253, s[24:27], s60 offen sc1
  s_mov_b64 exec, -1
tf_nf:
  ds_write_b32 v253, v253 offset:45056
  s_setprio 3
  buffer_load_dwordx4 v[32:35], v250, s[24:27], s46 offen offset:0 sc1
  buffer_load_dwordx4 v[36:39], v250, s[24:27], s46 offen offset:1024 sc1
  buffer_load_dwordx4 v[40:43], v250, s[24:27], s46 offen offset:2048 sc1
  buffer_load_dwordx4 v[44:47], v250, s[24:27], s46 offen offset:3072 sc1
  s_add_u32 s46, s46, s50
  s_cmp_ge_u32 s46, s47
  s_cselect_b32 s3, 57344, 0
  s_sub_u32 s46, s46, s3
  s_waitcnt vmcnt(3)
  v_mfma_f32_32x32x16_bf16 v[0:15], v[148:151], v[32:35], 0
  v_mfma_f32_32x32x16_bf16 v[16:31], v[152:155], v[32:35], 0
  s_waitcnt vmcnt(2)
  v_mfma_f32_32x32x16_bf16 v[0:15], v[156:159], v[36:39], v[0:15]
  ds_read_b64_tr_b16 v[148:149], v244 offset:49152
  ds_read_b64_tr_b16 v[150:151], v244 offset:50176
  v_mfma_f32_32x32x16_bf16 v[16:31], v[160:163], v[36:39], v[16:31]
  ds_read_b64_tr_b16 v[152:153], v247 offset:49152
  ds_read_b64_tr_b16 v[154:155], v247 offset:50176
  s_waitcnt vmcnt(1)
  v_mfma_f32_32x32x16_bf16 v[0:15], v[164:167], v[40:43], v[0:15]
  ds_read_b64_tr_b16 v[156:157], v244 offset:51200
  ds_read_b64_tr_b16 v[158:159], v244 offset:52224
  v_mfma_f32_32x32x16_bf16 v[16:31], v[168:171], v[40:43], v[16:31]
  ds_read_b64_tr_b16 v[160:161], v247 offset:51200
  ds_read_b64_tr_b16 v[162:163], v247 offset:52224
  s_waitcnt vmcnt(0)
  v_mfma_f32_32x32x16_bf16 v[0:15], v[172:175], v[44:47], v[0:15]
  ds_read_b64_tr_b16 v[164:165], v244 offset:53248
  ds_read_b64_tr_b16 v[166:167], v244 offset:54272
  v_mfma_f32_32x32x16_bf16 v[16:31], v[176:179], v[44:47], v[16:31]
  ds_read_b64_tr_b16 v[168:169], v247 offset:53248
  ds_read_b64_tr_b16 v[170:171], v247 offset:54272
  s_cmp_lg_u32 s40, 1
  s_cbranch_scc1 tg_np
  s_mov_b32 s3, 0
pl5:
  buffer_load_dword v255, v220, s[24:27], s52 offen sc1
  s_waitcnt vmcnt(0)
  v_cmp_eq_u32 vcc, 0, v255
  s_add_u32 s3, s3, 1
  s_cbranch_vccz pl5_ok
  s_sleep 3
  s_cmp_lt_u32 s3, 200000
  s_cbranch_scc1 pl5
pl5_ok:
tg_np:
  s_waitcnt lgkmcnt(0)
  s_barrier
  buffer_load_dwordx4 v[48:51], v250, s[24:27], s46 offen offset:0 sc1
  buffer_load_dwordx4 v[52:55], v250, s[24:27], s46 offen offset:1024 sc1
  buffer_load_dwordx4 v[56:59], v250, s[24:27], s46 offen offset:2048 sc1
  buffer_load_dwordx4 v[60:63], v250, s[24:27], s46 offen offset:3072 sc1
  s_add_u32 s46, s46, 8192
  s_cmp_ge_u32 s46, s47
  s_cselect_b32 s3, 57344, 0
  s_sub_u32 s46, s46, s3
  s_cmp_eq_u32 s46, s48
  s_cselect_b32 s3, 8192, 0
  s_add_u32 s46, s46, s3
  s_cmp_ge_u32 s46, s47
  s_cselect_b32 s3, 57344, 0
  s_sub_u32 s46, s46, s3
  buffer_load_dwordx4 v[64:67], v250, s[24:27], s46 offen offset:0 sc1
  buffer_load_dwordx4 v[68:71], v250, s[24:27], s46 offen offset:1024 sc1
  buffer_load_dwordx4 v[72:75], v250, s[24:27], s46 offen offset:2048 sc1
  buffer_load_dwordx4 v[76:79], v250, s[24:27], s46 offen offset:3072 sc1
  s_add_u32 s46, s46, 8192
  s_cmp_ge_u32 s46, s47
  s_cselect_b32 s3, 57344, 0
  s_sub_u32 s46, s46, s3
  s_cmp_eq_u32 s46, s48
  s_cselect_b32 s3, 8192, 0
  s_add_u32 s46, s46, s3
  s_cmp_ge_u32 s46, s47
  s_cselect_b32 s3, 57344, 0
  s_sub_u32 s46, s46, s3
  buffer_load_dwordx4 v[80:83], v250, s[24:27], s46 offen offset:0 sc1
  buffer_load_dwordx4 v[84:87], v250, s[24:27], s46 offen offset:1024 sc1
  buffer_load_dwordx4 v[88:91], v250, s[24:27], s46 offen offset:2048 sc1
  buffer_load_dwordx4 v[92:95], v250, s[24:27], s46 offen offset:3072 sc1
  s_add_u32 s46, s46, 8192
  s_cmp_ge_u32 s46, s47
  s_cselect_b32 s3, 57344, 0
  s_sub_u32 s46, s46, s3
  s_cmp_eq_u32 s46, s48
  s_cselect_b32 s3, 8192, 0
  s_add_u32 s46, s46, s3
  s_cmp_ge_u32 s46, s47
  s_cselect_b32 s3, 57344, 0
  s_sub_u32 s46, s46, s3
  s_waitcnt vmcnt(11)
  v_mfma_f32_32x32x16_bf16 v[0:15], v[180:183], v[48:51], v[0:15]
  ds_read_b64_tr_b16 v[172:173], v244 offset:55296
  ds_read_b64_tr_b16 v[174:175], v244 offset:56320
  v_mfma_f32_32x32x16_bf16 v[16:31], v[184:187], v[48:51], v[16:31]
  ds_read_b64_tr_b16 v[176:177], v247 offset:55296
  ds_read_b64_tr_b16 v[178:179], v247 offset:56320
  buffer_load_dwordx4 v[96:99], v250, s[24:27], s46 offen offset:0 sc1
  buffer_load_dwordx4 v[100:103], v250, s[24:27], s46 offen offset:1024 sc1
  s_waitcnt vmcnt(12)
  v_mfma_f32_32x32x16_bf16 v[0:15], v[188:191], v[52:55], v[0:15]
  ds_read_b64_tr_b16 v[180:181], v245 offset:0
  ds_read_b64_tr_b16 v[182:183], v245 offset:1024
  v_mfma_f32_32x32x16_bf16 v[16:31], v[192:195], v[52:55], v[16:31]
  ds_read_b64_tr_b16 v[184:185], v248 offset:0
  ds_read_b64_tr_b16 v[186:187], v248 offset:1024
  buffer_load_dwordx4 v[104:107], v250, s[24:27], s46 offen offset:2048 sc1
  buffer_load_dwordx4 v[108:111], v250, s[24:27], s46 offen offset:3072 sc1
  s_add_u32 s46, s46, 8192
  s_cmp_ge_u32 s46, s47
  s_cselect_b32 s3, 57344, 0
  s_sub_u32 s46, s46, s3
  s_cmp_eq_u32 s46, s48
  s_cselect_b32 s3, 8192, 0
  s_add_u32 s46, s46, s3
  s_cmp_ge_u32 s46, s47
  s_cselect_b32 s3, 57344, 0
  s_sub_u32 s46, s46, s3
  s_waitcnt vmcnt(13)
  v_mfma_f32_32x32x16_bf16 v[0:15], v[196:199], v[56:59], v[0:15]
  ds_read_b64_tr_b16 v[188:189], v245 offset:2048
  ds_read_b64_tr_b16 v[190:191], v245 offset:3072
  v_mfma_f32_32x32x16_bf16 v[16:31], v[200:203], v[56:59], v[16:31]
  ds_read_b64_tr_b16 v[192:193], v248 offset:2048
  ds_read_b64_tr_b16 v[194:195], v248 offset:3072
  buffer_load_dwordx4 v[112:115], v250, s[24:27], s46 offen offset:0 sc1
  buffer_load_dwordx4 v[116:119], v250, s[24:27], s46 offen offset:1024 sc1
  s_waitcnt vmcnt(14)
  v_mfma_f32_32x32x16_bf16 v[0:15], v[204:207], v[60:63], v[0:15]
  ds_read_b64_tr_b16 v[196:197], v245 offset:4096
  ds_read_b64_tr_b16 v[198:199], v245 offset:5120
  v_mfma_f32_32x32x16_bf16 v[16:31], v[208:211], v[60:63], v[16:31]
  ds_read_b64_tr_b16 v[200:201], v248 offset:4096
  ds_read_b64_tr_b16 v[202:203], v248 offset:5120
  buffer_load_dwordx4 v[120:123], v250, s[24:27], s46 offen offset:2048 sc1
  buffer_load_dwordx4 v[124:127], v250, s[24:27], s46 offen offset:3072 sc1
  s_add_u32 s46, s46, 8192
  s_cmp_ge_u32 s46, s47
  s_cselect_b32 s3, 57344, 0
  s_sub_u32 s46, s46, s3
  s_cmp_eq_u32 s46, s48
  s_cselect_b32 s3, 8192, 0
  s_add_u32 s46, s46, s3
  s_cmp_ge_u32 s46, s47
  s_cselect_b32 s3, 57344, 0
  s_sub_u32 s46, s46, s3
  s_waitcnt vmcnt(15) lgkmcnt(15)
  v_mfma_f32_32x32x16_bf16 v[0:15], v[148:151], v[64:67], v[0:15]
  ds_read_b64_tr_b16 v[204:205], v245 offset:6144
  ds_read_b64_tr_b16 v[206:207], v245 offset:7168
  v_mfma_f32_32x32x16_bf16 v[16:31], v[152:155], v[64:67], v[16:31]
  ds_read_b64_tr_b16 v[208:209], v248 offset:6144
  ds_read_b64_tr_b16 v[210:211], v248 offset:7168
  buffer_load_dwordx4 v[128:131], v250, s[24:27], s46 offen offset:0 sc1
  buffer_load_dwordx4 v[132:135], v250, s[24:27], s46 offen offset:1024 sc1
  s_waitcnt vmcnt(16) lgkmcnt(15)
  v_mfma_f32_32x32x16_bf16 v[0:15], v[156:159], v[68:71], v[0:15]
  ds_read_b64_tr_b16 v[148:149], v245 offset:32768
  ds_read_b64_tr_b16 v[150:151], v245 offset:33792
  v_mfma_f32_32x32x16_bf16 v[16:31], v[160:163], v[68:71], v[16:31]
  ds_read_b64_tr_b16 v[152:153], v248 offset:32768
  ds_read_b64_tr_b16 v[154:155], v248 offset:33792
  buffer_load_dwordx4 v[136:139], v250, s[24:27], s46 offen offset:2048 sc1
  buffer_load_dwordx4 v[140:143], v250, s[24:27], s46 offen offset:3072 sc1
  s_waitcnt vmcnt(17) lgkmcnt(15)
  v_mfma_f32_32x32x16_bf16 v[0:15], v[164:167], v[72:75], v[0:15]
  ds_read_b64_tr_b16 v[156:157], v245 offset:34816
  ds_read_b64_tr_b16 v[158:159], v245 offset:35840
  v_mfma_f32_32x32x16_bf16 v[16:31], v[168:171], v[72:75], v[16:31]
  ds_read_b64_tr_b16 v[160:161], v248 offset:34816
  ds_read_b64_tr_b16 v[162:163], v248 offset:35840
  s_waitcnt vmcnt(16) lgkmcnt(15)
  v_mfma_f32_32x32x16_bf16 v[0:15], v[172:175], v[76:79], v[0:15]
  ds_read_b64_tr_b16 v[164:165], v245 offset:36864
  ds_read_b64_tr_b16 v[166:167], v245 offset:37888
  v_mfma_f32_32x32x16_bf16 v[16:31], v[176:179], v[76:79], v[16:31]
  ds_read_b64_tr_b16 v[168:169], v248 offset:36864
  ds_read_b64_tr_b16 v[170:171], v248 offset:37888
  s_waitcnt vmcnt(15) lgkmcnt(15)
  v_mfma_f32_32x32x16_bf16 v[0:15], v[180:183], v[80:83], v[0:15]
  ds_read_b64_tr_b16 v[172:173], v245 offset:38912
  ds_read_b64_tr_b16 v[174:175], v245 offset:39936
  v_mfma_f32_32x32x16_bf16 v[16:31], v[184:187], v[80:83], v[16:31]
  ds_read_b64_tr_b16 v[176:177], v248 offset:38912
  ds_read_b64_tr_b16 v[178:179], v248 offset:39936
  s_waitcnt vmcnt(14) lgkmcnt(15)
  v_mfma_f32_32x32x16_bf16 v[0:15], v[188:191], v[84:87], v[0:15]
  ds_read_b64_tr_b16 v[180:181], v245 offset:16384
  ds_read_b64_tr_b16 v[182:183], v245 offset:17408
  v_mfma_f32_32x32x16_bf16 v[16:31], v[192:195], v[84:87], v[16:31]
  ds_read_b64_tr_b16 v[184:185], v248 offset:16384
  ds_read_b64_tr_b16 v[186:187], v248 offset:17408
  s_waitcnt vmcnt(13) lgkmcnt(15)
  v_mfma_f32_32x32x16_bf16 v[0:15], v[196:199], v[88:91], v[0:15]
  ds_read_b64_tr_b16 v[188:189], v245 offset:18432
  ds_read_b64_tr_b16 v[190:191], v245 offset:19456
  v_mfma_f32_32x32x16_bf16 v[16:31], v[200:203], v[88:91], v[16:31]
  ds_read_b64_tr_b16 v[192:193], v248 offset:18432
  ds_read_b64_tr_b16 v[194:195], v248 offset:19456
  s_waitcnt vmcnt(12) lgkmcnt(15)
  v_mfma_f32_32x32x16_bf16 v[0:15], v[204:207], v[92:95], v[0:15]
  ds_read_b64_tr_b16 v[196:197], v245 offset:20480
  ds_read_b64_tr_b16 v[198:199], v245 offset:21504
  v_mfma_f32_32x32x16_bf16 v[16:31], v[208:211], v[92:95], v[16:31]
  ds_read_b64_tr_b16 v[200:201], v248 offset:20480
  ds_read_b64_tr_b16 v[202:203], v248 offset:21504
  s_waitcnt vmcnt(11) lgkmcnt(15)
  v_mfma_f32_32x32x16_bf16 v[0:15], v[148:151], v[96:99], v[0:15]
  ds_read_b64_tr_b16 v[204:205], v245 offset:22528
  ds_read_b64_tr_b16 v[206:207], v245 offset:23552
  v_mfma_f32_32x32x16_bf16 v[16:31], v[152:155], v[96:99], v[16:31]
  ds_read_b64_tr_b16 v[208:209], v248 offset:22528
  ds_read_b64_tr_b16 v[210:211], v248 offset:23552
  s_waitcnt vmcnt(10) lgkmcnt(15)
  v_mfma_f32_32x32x16_bf16 v[0:15], v[156:159], v[100:103], v[0:15]
  ds_read_b64_tr_b16 v[148:149], v245 offset:49152
  ds_read_b64_tr_b16 v[150:151], v245 offset:50176
  v_mfma_f32_32x32x16_bf16 v[16:31], v[160:163], v[100:103], v[16:31]
  ds_read_b64_tr_b16 v[152:153], v248 offset:49152
  ds_read_b64_tr_b16 v[154:155], v248 offset:50176
  s_waitcnt vmcnt(9) lgkmcnt(15)
  v_mfma_f32_32x32x16_bf16 v[0:15], v[164:167], v[104:107], v[0:15]
  ds_read_b64_tr_b16 v[156:157], v245 offset:51200
  ds_read_b64_tr_b16 v[158:159], v245 offset:52224
  v_mfma_f32_32x32x16_bf16 v[16:31], v[168:171], v[104:107], v[16:31]
  ds_read_b64_tr_b16 v[160:161], v248 offset:51200
  ds_read_b64_tr_b16 v[162:163], v248 offset:52224
  s_waitcnt vmcnt(8) lgkmcnt(15)
  v_mfma_f32_32x32x16_bf16 v[0:15], v[172:175], v[108:111], v[0:15]
  ds_read_b64_tr_b16 v[164:165], v245 offset:53248
  ds_read_b64_tr_b16 v[166:167], v245 offset:54272
  v_mfma_f32_32x32x16_bf16 v[16:31], v[176:179], v[108:111], v[16:31]
  ds_read_b64_tr_b16 v[168:169], v248 offset:53248
  ds_read_b64_tr_b16 v[170:171], v248 offset:54272
  s_waitcnt vmcnt(7) lgkmcnt(15)
  v_mfma_f32_32x32x16_bf16 v[0:15], v[180:183], v[112:115], v[0:15]
  ds_read_b64_tr_b16 v[172:173], v245 offset:55296
  ds_read_b64_tr_b16 v[174:175], v245 offset:56320
  v_mfma_f32_32x32x16_bf16 v[16:31], v[184:187], v[112:115], v[16:31]
  ds_read_b64_tr_b16 v[176:177], v248 offset:55296
  ds_read_b64_tr_b16 v[178:179], v248 offset:56320
  s_waitcnt vmcnt(6) lgkmcnt(15)
  v_mfma_f32_32x32x16_bf16 v[0:15], v[188:191], v[116:119], v[0:15]
  v_mfma_f32_32x32x16_bf16 v[16:31], v[192:195], v[116:119], v[16:31]
  s_waitcnt vmcnt(5) lgkmcnt(15)
  v_mfma_f32_32x32x16_bf16 v[0:15], v[196:199], v[120:123], v[0:15]
  v_mfma_f32_32x32x16_bf16 v[16:31], v[200:203], v[120:123], v[16:31]
  s_waitcnt vmcnt(4) lgkmcnt(15)
  v_mfma_f32_32x32x16_bf16 v[0:15], v[204:207], v[124:127], v[0:15]
  v_mfma_f32_32x32x16_bf16 v[16:31], v[208:211], v[124:127], v[16:31]
  s_waitcnt vmcnt(3) lgkmcnt(12)
  v_mfma_f32_32x32x16_bf16 v[0:15], v[148:151], v[128:131], v[0:15]
  v_mfma_f32_32x32x16_bf16 v[16:31], v[152:155], v[128:131], v[16:31]
  s_waitcnt vmcnt(2) lgkmcnt(8)
  v_mfma_f32_32x32x16_bf16 v[0:15], v[156:159], v[132:135], v[0:15]
  v_mfma_f32_32x32x16_bf16 v[16:31], v[160:163], v[132:135], v[16:31]
  s_waitcnt vmcnt(1) lgkmcnt(4)
  v_mfma_f32_32x32x16_bf16 v[0:15], v[164:167], v[136:139], v[0:15]
  v_mfma_f32_32x32x16_bf16 v[16:31], v[168:171], v[136:139], v[16:31]
  s_waitcnt vmcnt(0) lgkmcnt(0)
  v_mfma_f32_32x32x16_bf16 v[0:15], v[172:175], v[140:143], v[0:15]
  v_mfma_f32_32x32x16_bf16 v[16:31], v[176:179], v[140:143], v[16:31]
  s_nop 7
  s_nop 2
  v_cvt_pk_bf16_f32 v148, v0, v1
  v_cvt_pk_bf16_f32 v149, v2, v3
  v_cvt_pk_bf16_f32 v150, v4, v5
  v_cvt_pk_bf16_f32 v151, v6, v7
  buffer_store_dwordx4 v[148:151], v250, s[24:27], s53 offen offset:0 sc1
  v_cvt_pk_bf16_f32 v152, v8, v9
  v_cvt_pk_bf16_f32 v153, v10, v11
  v_cvt_pk_bf16_f32 v154, v12, v13
  v_cvt_pk_bf16_f32 v155, v14, v15
  buffer_store_dwordx4 v[152:155], v250, s[24:27], s53 offen offset:1024 sc1
  v_cvt_pk_bf16_f32 v156, v16, v17
  v_cvt_pk_bf16_f32 v157, v18, v19
  v_cvt_pk_bf16_f32 v158, v20, v21
  v_cvt_pk_bf16_f32 v159, v22, v23
  buffer_store_dwordx4 v[156:159], v250, s[24:27], s55 offen offset:0 sc1
  v_cvt_pk_bf16_f32 v160, v24, v25
  v_cvt_pk_bf16_f32 v161, v26, v27
  v_cvt_pk_bf16_f32 v162, v28, v29
  v_cvt_pk_bf16_f32 v163, v30, v31
  buffer_store_dwordx4 v[160:163], v250, s[24:27], s55 offen offset:1024 sc1
  s_setprio 0
  s_waitcnt vmcnt(0)
  s_mov_b64 exec, 1
  buffer_store_dword v252, v253, s[24:27], s56 offen sc1
  s_mov_b64 exec, -1
  s_cmp_eq_u32 s40, 2
  s_cbranch_scc1 tg_cp
  s_mov_b32 s3, 0
tg_cl:
  s_sleep 1
  ds_read_b32 v255, v253 offset:45056
  s_add_u32 s3, s3, 1
  s_waitcnt lgkmcnt(0)
  v_cmp_eq_u32 vcc, 0, v255
  s_cbranch_vccz tg_ck
  s_cmp_lt_u32 s3, 1600000
  s_cbranch_scc1 tg_cl
  s_branch tg_ck
tg_cp:
  s_mov_b32 s3, 0
pl6:
  buffer_load_dword v255, v224, s[24:27], s57 offen sc1
  s_waitcnt vmcnt(0)
  v_cmp_eq_u32 vcc, 0, v255
  s_add_u32 s3, s3, 1
  s_cbranch_vccz pl6_ok
  s_sleep 3
  s_cmp_lt_u32 s3, 200000
  s_cbranch_scc1 pl6
pl6_ok:
  ds_write_b32 v253, v252 offset:45056
tg_ck:
  s_add_u32 m0, s59, 0
  s_nop 0
  buffer_load_dwordx4 v221, s[24:27], s58 offen sc1 lds
  buffer_load_dwordx4 v222, s[24:27], s58 offen offset:1024 sc1 lds
  s_add_u32 s58, s58, 128
  s_add_u32 m0, s59, 8192
  s_nop 0
  buffer_load_dwordx4 v221, s[24:27], s58 offen sc1 lds
  buffer_load_dwordx4 v222, s[24:27], s58 offen offset:1024 sc1 lds
  s_add_u32 s58, s58, 128
  s_add_u32 m0, s59, 16384
  s_nop 0
  buffer_load_dwordx4 v221, s[24:27], s58 offen sc1 lds
  buffer_load_dwordx4 v222, s[24:27], s58 offen offset:1024 sc1 lds
  s_add_u32 s58, s58, 128
  s_add_u32 m0, s59, 24576
  s_nop 0
  buffer_load_dwordx4 v221, s[24:27], s58 offen sc1 lds
  buffer_load_dwordx4 v222, s[24:27], s58 offen offset:1024 sc1 lds
  s_add_u32 s58, s58, 128
  s_add_u32 m0, s59, 32768
  s_nop 0
  buffer_load_dwordx4 v221, s[24:27], s58 offen sc1 lds
  buffer_load_dwordx4 v222, s[24:27], s58 offen offset:1024 sc1 lds
  s_add_u32 s58, s58, 128
  s_add_u32 m0, s59, 131072
  s_nop 0
  buffer_load_dwordx4 v221, s[24:27], s58 offen sc1 lds
  buffer_load_dwordx4 v222, s[24:27], s58 offen offset:1024 sc1 lds
  s_add_u32 s58, s58, 128
  s_add_u32 m0, s59, 139264
  s_nop 0
  buffer_load_dwordx4 v221, s[24:27], s58 offen sc1 lds
  buffer_load_dwordx4 v222, s[24:27], s58 offen offset:1024 sc1 lds
  s_add_u32 s58, s58, 128
  s_lshl_b32 s60, s44, 10
  s_add_u32 m0, s60, 40960
  s_nop 0
  buffer_load_dwordx4 v223, s[24:27], s58 offen sc1 lds
  s_waitcnt vmcnt(11)
  s_barrier
  s_waitcnt vmcnt(5)
  s_barrier
  s_waitcnt vmcnt(0)
  s_barrier
  s_endpgm
f_compA:
  s_mov_b64 s[28:29], s[30:31]
  s_mov_b32 s30, 229376
  s_mov_b32 s31, 0x20000
  s_lshl2_add_u32 s39, s15, s40
  s_mul_i32 s39, s39, 28672
  v_lshlrev_b32 v249, 4, v254
  buffer_load_dwordx4 v[160:163], v249, s[28:31], s39 offen offset:0
  buffer_load_dwordx4 v[164:167], v249, s[28:31], s39 offen offset:1024
  buffer_load_dwordx4 v[168:171], v249, s[28:31], s39 offen offset:2048
  buffer_load_dwordx4 v[172:175], v249, s[28:31], s39 offen offset:3072
  s_add_u32 s39, s39, 4096
  s_movk_i32 s58, 256
  s_mov_b32 s59, 0x20000
  v_min_u32 v251, 53, v254
  v_lshlrev_b32 v251, 2, v251
  s_lshl1_add_u32 s60, s14, s15
  s_lshl_b32 s60, s60, 10
  s_add_u32 s60, s60, 19922944
  s_lshl_b32 s61, s2, 7
  s_add_u32 s61, s61, 19988480
  s_lshl2_add_u32 s55, s14, s15
  s_lshl2_add_u32 s55, s55, s40
  s_lshl_b32 s55, s55, 9
  s_add_u32 s55, s55, 8388608
  s_or_b32 s62, s15, s40
  v_bfe_u32 v16, v254, 1, 4
  v_sub_u32 v17, 0, v16
  v_cmp_eq_u32 vcc, 0, v16
  s_nop 1
  v_cndmask_b32 v17, v17, 16, vcc
  v_and_b32 v18, 1, v254
  v_cmp_eq_u32 vcc, 0, v18
  s_nop 1
  v_cndmask_b32 v16, v17, v16, vcc
  v_lshrrev_b32 v17, 5, v254
  s_lshl_b32 s20, s40, 3
  v_lshl_add_u32 v17, v17, 2, s20
  v_mul_i32_i24 v17, v17, v16
  v_and_b32 v20, 31, v17
  v_add_u32 v17, v17, v16
  v_and_b32 v21, 31, v17
  v_add_u32 v17, v17, v16
  v_and_b32 v22, 31, v17
  v_add_u32 v17, v17, v16
  v_and_b32 v23, 31, v17
  v_cvt_f32_u32 v20, v20
  v_cvt_f32_u32 v21, v21
  v_cvt_f32_u32 v22, v22
  v_cvt_f32_u32 v23, v23
  v_mul_f32 v20, 0x3d000000, v20
  v_mul_f32 v21, 0x3d000000, v21
  v_mul_f32 v22, 0x3d000000, v22
  v_mul_f32 v23, 0x3d000000, v23
  v_cos_f32 v24, v20
  v_sin_f32 v28, v20
  v_cos_f32 v25, v21
  v_sin_f32 v29, v21
  v_cos_f32 v26, v22
  v_sin_f32 v30, v22
  v_cos_f32 v27, v23
  v_sin_f32 v31, v23
  s_lshr_b32 s20, s40, 1
  s_lshl_b32 s20, s20, 10
  s_and_b32 s21, s40, 1
  s_lshl3_add_u32 s20, s21, s20
  s_add_u32 s20, s20, 114688
  v_add_u32 v18, s20, v249
  v_cvt_pk_bf16_f32 v32, v24, v25
  v_cvt_pk_bf16_f32 v33, v26, v27
  ds_write_b64 v18, v[32:33] offset:0
  v_cvt_pk_bf16_f32 v34, v28, v29
  v_cvt_pk_bf16_f32 v35, v30, v31
  ds_write_b64 v18, v[34:35] offset:2048
  v_cvt_pk_bf16_f32 v36, -v28, -v29
  v_cvt_pk_bf16_f32 v37, -v30, -v31
  ds_write_b64 v18, v[36:37] offset:4096
  s_mov_b32 s20, 0x3f803f80
  v_mov_b64 v[8:9], 0
  s_lshl3_add_u32 s63, s15, s16
  s_lshl4_add_u32 s63, s14, s63
  s_lshl2_add_u32 s63, s63, s40
  s_lshl_b32 s63, s63, 5
  s_add_u32 s63, s63, 19992576
  s_waitcnt vmcnt(4)
  v_dot2c_f32_bf16 v8, s20, v0
  v_dot2c_f32_bf16 v9, v0, v0
  v_dot2c_f32_bf16 v8, s20, v1
  v_dot2c_f32_bf16 v9, v1, v1
  v_dot2c_f32_bf16 v8, s20, v2
  v_dot2c_f32_bf16 v9, v2, v2
  v_dot2c_f32_bf16 v8, s20, v3
  v_dot2c_f32_bf16 v9, v3, v3
  v_dot2c_f32_bf16 v8, s20, v4
  v_dot2c_f32_bf16 v9, v4, v4
  v_dot2c_f32_bf16 v8, s20, v5
  v_dot2c_f32_bf16 v9, v5, v5
  v_dot2c_f32_bf16 v8, s20, v6
  v_dot2c_f32_bf16 v9, v6, v6
  s_nop 1
  v_add_f32_dpp v8, v8, v8 quad_perm:[1,0,3,2] row_mask:0xf bank_mask:0xf
  v_add_f32_dpp v9, v9, v9 quad_perm:[1,0,3,2] row_mask:0xf bank_mask:0xf
  s_nop 0
  v_add_f32_dpp v8, v8, v8 quad_perm:[2,3,0,1] row_mask:0xf bank_mask:0xf
  v_add_f32_dpp v9, v9, v9 quad_perm:[2,3,0,1] row_mask:0xf bank_mask:0xf
  s_nop 0
  v_add_f32_dpp v8, v8, v8 row_half_mirror row_mask:0xf bank_mask:0xf
  v_add_f32_dpp v9, v9, v9 row_half_mirror row_mask:0xf bank_mask:0xf
  s_nop 0
  v_add_f32_dpp v8, v8, v8 row_mirror row_mask:0xf bank_mask:0xf
  v_add_f32_dpp v9, v9, v9 row_mirror row_mask:0xf bank_mask:0xf
  s_nop 0
  v_add_f32_dpp v8, v8, v8 row_bcast:15 row_mask:0xa bank_mask:0xf
  v_add_f32_dpp v9, v9, v9 row_bcast:15 row_mask:0xa bank_mask:0xf
  v_mul_f32 v8, 0x3b124925, v8
  v_mul_f32 v9, 0x3b124925, v9
  v_fma_f32 v9, -v8, v8, v9
  v_max_f32 v9, 0, v9
  v_cvt_pk_bf16_f32 v9, v8, v9
  v_lshlrev_b32 v10, 16, v9
  v_and_b32 v9, 0xffff0000, v9
  v_add_f32 v9, 0x3727c5ac, v9
  v_cvt_pk_bf16_f32 v9, 0, v9
  v_sqrt_f32 v9, v9
  v_sub_f32 v8, v8, v10
  v_cvt_pk_bf16_f32 v9, 0, v9
  v_rcp_f32 v12, v9
  v_mul_f32 v8, 0x43600000, v8
  v_cvt_pk_bf16_f32 v244, -v10, -v10
  v_cvt_pk_bf16_f32 v245, -v10, v8
  v_mul_f32 v246, v12, v12
  v_mul_f32 v247, 0x36124925, v12
  v_or_b32 v247, 1, v247
  buffer_load_dwordx4 v[176:179], v249, s[28:31], s39 offen offset:0
  buffer_load_dwordx4 v[180:183], v249, s[28:31], s39 offen offset:1024
  v_and_b32 v252, 31, v254
  v_bfe_u32 v253, v254, 1, 3
  v_lshrrev_b32 v248, 5, v254
  v_xor_b32 v253, v253, v248
  v_lshlrev_b32 v253, 4, v253
  v_lshl_add_u32 v240, v252, 7, v253
  v_xor_b32 v241, 32, v240
  v_xor_b32 v242, 64, v240
  v_xor_b32 v243, 96, v240
  v_lshlrev_b32 v253, 4, v248
  v_lshlrev_b32 v248, 18, v248
  v_lshl_add_u32 v248, v252, 4, v248
  v_add_u32 v252, 114688, v249
  s_waitcnt lgkmcnt(0)
  s_setprio 2
  s_barrier
  ds_read_b128 v[128:131], v240 offset:0
  ds_read_b128 v[132:135], v240 offset:4096
  ds_read_b128 v[136:139], v240 offset:8192
  ds_read_b128 v[140:143], v240 offset:12288
  ds_read_b128 v[144:147], v240 offset:16384
  s_waitcnt vmcnt(4) lgkmcnt(4)
  v_mfma_f32_32x32x16_bf16 v[0:15], v[128:131], v[160:163], 0
  ds_read_b128 v[148:151], v240 offset:20480
  s_waitcnt lgkmcnt(4)
  v_mfma_f32_32x32x16_bf16 v[32:47], v[132:135], v[160:163], 0
  ds_read_b128 v[152:155], v240 offset:24576
  buffer_load_dwordx4 v[184:187], v249, s[28:31], s39 offen offset:2048
  buffer_load_dwordx4 v[188:191], v249, s[28:31], s39 offen offset:3072
  s_add_u32 s39, s39, 4096
  s_waitcnt lgkmcnt(4)
  v_mfma_f32_32x32x16_bf16 v[64:79], v[136:139], v[160:163], 0
  ds_read_b128 v[156:159], v240 offset:28672
  s_waitcnt lgkmcnt(4)
  v_mfma_f32_32x32x16_bf16 v[96:111], v[140:143], v[160:163], 0
  ds_read_b128 v[128:131], v241 offset:0
  s_waitcnt lgkmcnt(4)
  v_mfma_f32_32x32x16_bf16 v[16:31], v[144:147], v[164:167], 0
  ds_read_b128 v[132:135], v241 offset:4096
  s_waitcnt lgkmcnt(4)
  v_mfma_f32_32x32x16_bf16 v[48:63], v[148:151], v[164:167], 0
  ds_read_b128 v[136:139], v241 offset:8192
  buffer_load_dwordx4 v[192:195], v249, s[28:31], s39 offen offset:0
  buffer_load_dwordx4 v[196:199], v249, s[28:31], s39 offen offset:1024
  s_waitcnt lgkmcnt(4)
  v_mfma_f32_32x32x16_bf16 v[80:95], v[152:155], v[164:167], 0
  ds_read_b128 v[140:143], v241 offset:12288
  s_waitcnt lgkmcnt(4)
  v_mfma_f32_32x32x16_bf16 v[112:127], v[156:159], v[164:167], 0
  ds_read_b128 v[144:147], v241 offset:16384
  s_waitcnt vmcnt(6) lgkmcnt(4)
  v_mfma_f32_32x32x16_bf16 v[0:15], v[128:131], v[168:171], v[0:15]
  ds_read_b128 v[148:151], v241 offset:20480
  s_waitcnt lgkmcnt(4)
  v_mfma_f32_32x32x16_bf16 v[32:47], v[132:135], v[168:171], v[32:47]
  ds_read_b128 v[152:155], v241 offset:24576
  buffer_load_dwordx4 v[200:203], v249, s[28:31], s39 offen offset:2048
  buffer_load_dwordx4 v[204:207], v249, s[28:31], s39 offen offset:3072
  s_add_u32 s39, s39, 4096
  s_waitcnt lgkmcnt(4)
  v_mfma_f32_32x32x16_bf16 v[64:79], v[136:139], v[168:171], v[64:79]
  ds_read_b128 v[156:159], v241 offset:28672
  s_waitcnt lgkmcnt(4)
  v_mfma_f32_32x32x16_bf16 v[96:111], v[140:143], v[168:171], v[96:111]
  ds_read_b128 v[128:131], v242 offset:0
  s_waitcnt lgkmcnt(4)
  v_mfma_f32_32x32x16_bf16 v[16:31], v[144:147], v[172:175], v[16:31]
  ds_read_b128 v[132:135], v242 offset:4096
  s_waitcnt lgkmcnt(4)
  v_mfma_f32_32x32x16_bf16 v[48:63], v[148:151], v[172:175], v[48:63]
  ds_read_b128 v[136:139], v242 offset:8192
  buffer_load_dwordx4 v[208:211], v249, s[28:31], s39 offen offset:0
  buffer_load_dwordx4 v[212:215], v249, s[28:31], s39 offen offset:1024
  s_waitcnt lgkmcnt(4)
  v_mfma_f32_32x32x16_bf16 v[80:95], v[152:155], v[172:175], v[80:95]
  ds_read_b128 v[140:143], v242 offset:12288
  s_waitcnt lgkmcnt(4)
  v_mfma_f32_32x32x16_bf16 v[112:127], v[156:159], v[172:175], v[112:127]
  ds_read_b128 v[144:147], v242 offset:16384
  s_waitcnt vmcnt(8) lgkmcnt(4)
  v_mfma_f32_32x32x16_bf16 v[0:15], v[128:131], v[176:179], v[0:15]
  ds_read_b128 v[148:151], v242 offset:20480
  s_waitcnt lgkmcnt(4)
  v_mfma_f32_32x32x16_bf16 v[32:47], v[132:135], v[176:179], v[32:47]
  ds_read_b128 v[152:155], v242 offset:24576
  buffer_load_dwordx4 v[216:219], v249, s[28:31], s39 offen offset:2048
  buffer_load_dwordx4 v[220:223], v249, s[28:31], s39 offen offset:3072
  s_add_u32 s39, s39, 4096
  s_waitcnt lgkmcnt(4)
  v_mfma_f32_32x32x16_bf16 v[64:79], v[136:139], v[176:179], v[64:79]
  ds_read_b128 v[156:159], v242 offset:28672
  s_waitcnt lgkmcnt(4)
  v_mfma_f32_32x32x16_bf16 v[96:111], v[140:143], v[176:179], v[96:111]
  ds_read_b128 v[128:131], v243 offset:0
  s_waitcnt lgkmcnt(4)
  v_mfma_f32_32x32x16_bf16 v[16:31], v[144:147], v[180:183], v[16:31]
  ds_read_b128 v[132:135], v243 offset:4096
  s_waitcnt lgkmcnt(4)
  v_mfma_f32_32x32x16_bf16 v[48:63], v[148:151], v[180:183], v[48:63]
  ds_read_b128 v[136:139], v243 offset:8192
  buffer_load_dwordx4 v[224:227], v249, s[28:31], s39 offen offset:0
  buffer_load_dwordx4 v[228:231], v249, s[28:31], s39 offen offset:1024
  s_waitcnt lgkmcnt(4)
  v_mfma_f32_32x32x16_bf16 v[80:95], v[152:155], v[180:183], v[80:95]
  ds_read_b128 v[140:143], v243 offset:12288
  s_waitcnt lgkmcnt(4)
  v_mfma_f32_32x32x16_bf16 v[112:127], v[156:159], v[180:183], v[112:127]
  ds_read_b128 v[144:147], v243 offset:16384
  s_waitcnt vmcnt(10) lgkmcnt(4)
  v_mfma_f32_32x32x16_bf16 v[0:15], v[128:131], v[184:187], v[0:15]
  ds_read_b128 v[148:151], v243 offset:20480
  s_waitcnt lgkmcnt(4)
  v_mfma_f32_32x32x16_bf16 v[32:47], v[132:135], v[184:187], v[32:47]
  ds_read_b128 v[152:155], v243 offset:24576
  buffer_load_dwordx4 v[232:235], v249, s[28:31], s39 offen offset:2048
  buffer_load_dwordx4 v[236:239], v249, s[28:31], s39 offen offset:3072
  s_add_u32 s39, s39, 4096
  s_waitcnt lgkmcnt(4)
  v_mfma_f32_32x32x16_bf16 v[64:79], v[136:139], v[184:187], v[64:79]
  ds_read_b128 v[156:159], v243 offset:28672
  s_waitcnt lgkmcnt(4)
  v_mfma_f32_32x32x16_bf16 v[96:111], v[140:143], v[184:187], v[96:111]
  s_barrier
  ds_read_b128 v[128:131], v240 offset:32768
  s_waitcnt lgkmcnt(4)
  v_mfma_f32_32x32x16_bf16 v[16:31], v[144:147], v[188:191], v[16:31]
  ds_read_b128 v[132:135], v240 offset:36864
  s_waitcnt lgkmcnt(4)
  v_mfma_f32_32x32x16_bf16 v[48:63], v[148:151], v[188:191], v[48:63]
  ds_read_b128 v[136:139], v240 offset:40960
  buffer_load_dwordx4 v[160:163], v249, s[28:31], s39 offen offset:0
  buffer_load_dwordx4 v[164:167], v249, s[28:31], s39 offen offset:1024
  s_waitcnt lgkmcnt(4)
  v_mfma_f32_32x32x16_bf16 v[80:95], v[152:155], v[188:191], v[80:95]
  ds_read_b128 v[140:143], v240 offset:45056
  s_waitcnt lgkmcnt(4)
  v_mfma_f32_32x32x16_bf16 v[112:127], v[156:159], v[188:191], v[112:127]
  ds_read_b128 v[144:147], v240 offset:49152
  s_waitcnt vmcnt(12) lgkmcnt(4)
  v_mfma_f32_32x32x16_bf16 v[0:15], v[128:131], v[192:195], v[0:15]
  ds_read_b128 v[148:151], v240 offset:53248
  buffer_load_dword v250, v251, s[56:59], 0 offen sc1
  s_waitcnt lgkmcnt(4)
  v_mfma_f32_32x32x16_bf16 v[32:47], v[132:135], v[192:195], v[32:47]
  ds_read_b128 v[152:155], v240 offset:57344
  buffer_load_dwordx4 v[168:171], v249, s[28:31], s39 offen offset:2048
  buffer_load_dwordx4 v[172:175], v249, s[28:31], s39 offen offset:3072
  s_add_u32 s39, s39, 4096
  s_waitcnt lgkmcnt(4)
  v_mfma_f32_32x32x16_bf16 v[64:79], v[136:139], v[192:195], v[64:79]
  ds_read_b128 v[156:159], v240 offset:61440
  v_add_u32 v240, 65536, v240
  s_waitcnt lgkmcnt(4)
  v_mfma_f32_32x32x16_bf16 v[96:111], v[140:143], v[192:195], v[96:111]
  ds_read_b128 v[128:131], v241 offset:32768
  s_waitcnt lgkmcnt(4)
  v_mfma_f32_32x32x16_bf16 v[16:31], v[144:147], v[196:199], v[16:31]
  ds_read_b128 v[132:135], v241 offset:36864
  s_waitcnt lgkmcnt(4)
  v_mfma_f32_32x32x16_bf16 v[48:63], v[148:151], v[196:199], v[48:63]
  ds_read_b128 v[136:139], v241 offset:40960
  buffer_load_dwordx4 v[176:179], v249, s[28:31], s39 offen offset:0
  buffer_load_dwordx4 v[180:183], v249, s[28:31], s39 offen offset:1024
  s_waitcnt lgkmcnt(4)
  v_mfma_f32_32x32x16_bf16 v[80:95], v[152:155], v[196:199], v[80:95]
  ds_read_b128 v[140:143], v241 offset:45056
  s_waitcnt lgkmcnt(4)
  v_mfma_f32_32x32x16_bf16 v[112:127], v[156:159], v[196:199], v[112:127]
  ds_read_b128 v[144:147], v241 offset:49152
  s_waitcnt vmcnt(15) lgkmcnt(4)
  v_mfma_f32_32x32x16_bf16 v[0:15], v[128:131], v[200:203], v[0:15]
  ds_read_b128 v[148:151], v241 offset:53248
  s_waitcnt lgkmcnt(4)
  v_mfma_f32_32x32x16_bf16 v[32:47], v[132:135], v[200:203], v[32:47]
  ds_read_b128 v[152:155], v241 offset:57344
  buffer_load_dwordx4 v[184:187], v249, s[28:31], s39 offen offset:2048
  buffer_load_dwordx4 v[188:191], v249, s[28:31], s39 offen offset:3072
  s_add_u32 s39, s39, 4096
  s_waitcnt lgkmcnt(4)
  v_mfma_f32_32x32x16_bf16 v[64:79], v[136:139], v[200:203], v[64:79]
  ds_read_b128 v[156:159], v241 offset:61440
  v_add_u32 v241, 65536, v241
  s_waitcnt lgkmcnt(4)
  v_mfma_f32_32x32x16_bf16 v[96:111], v[140:143], v[200:203], v[96:111]
  ds_read_b128 v[128:131], v242 offset:32768
  s_waitcnt lgkmcnt(4)
  v_mfma_f32_32x32x16_bf16 v[16:31], v[144:147], v[204:207], v[16:31]
  ds_read_b128 v[132:135], v242 offset:36864
  s_waitcnt lgkmcnt(4)
  v_mfma_f32_32x32x16_bf16 v[48:63], v[148:151], v[204:207], v[48:63]
  ds_read_b128 v[136:139], v242 offset:40960
  s_waitcnt lgkmcnt(4)
  v_mfma_f32_32x32x16_bf16 v[80:95], v[152:155], v[204:207], v[80:95]
  ds_read_b128 v[140:143], v242 offset:45056
  s_waitcnt lgkmcnt(4)
  v_mfma_f32_32x32x16_bf16 v[112:127], v[156:159], v[204:207], v[112:127]
  ds_read_b128 v[144:147], v242 offset:49152
  s_waitcnt vmcnt(15) lgkmcnt(4)
  v_mfma_f32_32x32x16_bf16 v[0:15], v[128:131], v[208:211], v[0:15]
  ds_read_b128 v[148:151], v242 offset:53248
  s_waitcnt lgkmcnt(4)
  v_mfma_f32_32x32x16_bf16 v[32:47], v[132:135], v[208:211], v[32:47]
  ds_read_b128 v[152:155], v242 offset:57344
  s_waitcnt lgkmcnt(4)
  v_mfma_f32_32x32x16_bf16 v[64:79], v[136:139], v[208:211], v[64:79]
  ds_read_b128 v[156:159], v242 offset:61440
  v_add_u32 v242, 65536, v242
  s_waitcnt lgkmcnt(4)
  v_mfma_f32_32x32x16_bf16 v[96:111], v[140:143], v[208:211], v[96:111]
  ds_read_b128 v[128:131], v243 offset:32768
  s_waitcnt lgkmcnt(4)
  v_mfma_f32_32x32x16_bf16 v[16:31], v[144:147], v[212:215], v[16:31]
  ds_read_b128 v[132:135], v243 offset:36864
  s_waitcnt lgkmcnt(4)
  v_mfma_f32_32x32x16_bf16 v[48:63], v[148:151], v[212:215], v[48:63]
  ds_read_b128 v[136:139], v243 offset:40960
  s_waitcnt lgkmcnt(4)
  v_mfma_f32_32x32x16_bf16 v[80:95], v[152:155], v[212:215], v[80:95]
  ds_read_b128 v[140:143], v243 offset:45056
  s_waitcnt lgkmcnt(4)
  v_mfma_f32_32x32x16_bf16 v[112:127], v[156:159], v[212:215], v[112:127]
  ds_read_b128 v[144:147], v243 offset:49152
  s_waitcnt vmcnt(13) lgkmcnt(4)
  v_mfma_f32_32x32x16_bf16 v[0:15], v[128:131], v[216:219], v[0:15]
  ds_read_b128 v[148:151], v243 offset:53248
  s_waitcnt vmcnt(6)
  s_mov_b32 s3, 0
  s_branch pl7_chk
pl7:
  buffer_load_dword v250, v251, s[56:59], 0 offen sc1
  s_waitcnt vmcnt(0)
pl7_chk:
  v_cmp_eq_u32 vcc, 0, v250
  s_add_u32 s3, s3, 1
  s_cbranch_vccz pl7_ok
  s_sleep 8
  s_cmp_lt_u32 s3, 200000
  s_cbranch_scc1 pl7
pl7_ok:
  s_mov_b32 exec_lo, 0x10000
  s_mov_b32 exec_hi, 0x10000
  buffer_store_dwordx4 v[244:247], v253, s[24:27], s63 offen sc1
  s_mov_b64 exec, -1
  s_waitcnt lgkmcnt(4)
  v_mfma_f32_32x32x16_bf16 v[32:47], v[132:135], v[216:219], v[32:47]
  ds_read_b128 v[152:155], v243 offset:57344
  s_waitcnt lgkmcnt(4)
  v_mfma_f32_32x32x16_bf16 v[64:79], v[136:139], v[216:219], v[64:79]
  ds_read_b128 v[156:159], v243 offset:61440
  v_add_u32 v243, 65536, v243
  s_waitcnt lgkmcnt(4)
  v_mfma_f32_32x32x16_bf16 v[96:111], v[140:143], v[216:219], v[96:111]
  s_barrier
  ds_read_b128 v[128:131], v240 offset:0
  s_waitcnt lgkmcnt(4)
  v_mfma_f32_32x32x16_bf16 v[16:31], v[144:147], v[220:223], v[16:31]
  ds_read_b128 v[132:135], v240 offset:4096
  s_waitcnt lgkmcnt(4)
  v_mfma_f32_32x32x16_bf16 v[48:63], v[148:151], v[220:223], v[48:63]
  ds_read_b128 v[136:139], v240 offset:8192
  s_waitcnt lgkmcnt(4)
  v_mfma_f32_32x32x16_bf16 v[80:95], v[152:155], v[220:223], v[80:95]
  ds_read_b128 v[140:143], v240 offset:12288
  s_waitcnt lgkmcnt(4)
  v_mfma_f32_32x32x16_bf16 v[112:127], v[156:159], v[220:223], v[112:127]
  ds_read_b128 v[144:147], v240 offset:16384
  s_waitcnt vmcnt(12) lgkmcnt(4)
  v_mfma_f32_32x32x16_bf16 v[0:15], v[128:131], v[224:227], v[0:15]
  ds_read_b128 v[148:151], v240 offset:20480
  s_waitcnt lgkmcnt(4)
  v_mfma_f32_32x32x16_bf16 v[32:47], v[132:135], v[224:227], v[32:47]
  ds_read_b128 v[152:155], v240 offset:24576
  s_waitcnt lgkmcnt(4)
  v_mfma_f32_32x32x16_bf16 v[64:79], v[136:139], v[224:227], v[64:79]
  ds_read_b128 v[156:159], v240 offset:28672
  s_waitcnt lgkmcnt(4)
  v_mfma_f32_32x32x16_bf16 v[96:111], v[140:143], v[224:227], v[96:111]
  ds_read_b128 v[128:131], v241 offset:0
  s_waitcnt lgkmcnt(4)
  v_mfma_f32_32x32x16_bf16 v[16:31], v[144:147], v[228:231], v[16:31]
  ds_read_b128 v[132:135], v241 offset:4096
  s_waitcnt lgkmcnt(4)
  v_mfma_f32_32x32x16_bf16 v[48:63], v[148:151], v[228:231], v[48:63]
  ds_read_b128 v[136:139], v241 offset:8192
  s_waitcnt lgkmcnt(4)
  v_mfma_f32_32x32x16_bf16 v[80:95], v[152:155], v[228:231], v[80:95]
  ds_read_b128 v[140:143], v241 offset:12288
  s_waitcnt lgkmcnt(4)
  v_mfma_f32_32x32x16_bf16 v[112:127], v[156:159], v[228:231], v[112:127]
  ds_read_b128 v[144:147], v241 offset:16384
  s_waitcnt vmcnt(10) lgkmcnt(4)
  v_mfma_f32_32x32x16_bf16 v[0:15], v[128:131], v[232:235], v[0:15]
  ds_read_b128 v[148:151], v241 offset:20480
  s_waitcnt lgkmcnt(4)
  v_mfma_f32_32x32x16_bf16 v[32:47], v[132:135], v[232:235], v[32:47]
  ds_read_b128 v[152:155], v241 offset:24576
  s_waitcnt lgkmcnt(4)
  v_mfma_f32_32x32x16_bf16 v[64:79], v[136:139], v[232:235], v[64:79]
  ds_read_b128 v[156:159], v241 offset:28672
  s_waitcnt lgkmcnt(4)
  v_mfma_f32_32x32x16_bf16 v[96:111], v[140:143], v[232:235], v[96:111]
  ds_read_b128 v[128:131], v242 offset:0
  s_waitcnt lgkmcnt(4)
  v_mfma_f32_32x32x16_bf16 v[16:31], v[144:147], v[236:239], v[16:31]
  ds_read_b128 v[132:135], v242 offset:4096
  s_waitcnt lgkmcnt(4)
  v_mfma_f32_32x32x16_bf16 v[48:63], v[148:151], v[236:239], v[48:63]
  ds_read_b128 v[136:139], v242 offset:8192
  s_waitcnt lgkmcnt(4)
  v_mfma_f32_32x32x16_bf16 v[80:95], v[152:155], v[236:239], v[80:95]
  ds_read_b128 v[140:143], v242 offset:12288
  s_waitcnt lgkmcnt(4)
  v_mfma_f32_32x32x16_bf16 v[112:127], v[156:159], v[236:239], v[112:127]
  ds_read_b128 v[144:147], v242 offset:16384
  s_waitcnt vmcnt(8) lgkmcnt(4)
  v_mfma_f32_32x32x16_bf16 v[0:15], v[128:131], v[160:163], v[0:15]
  ds_read_b128 v[148:151], v242 offset:20480
  s_waitcnt lgkmcnt(4)
  v_mfma_f32_32x32x16_bf16 v[32:47], v[132:135], v[160:163], v[32:47]
  ds_read_b128 v[152:155], v242 offset:24576
  s_waitcnt lgkmcnt(4)
  v_mfma_f32_32x32x16_bf16 v[64:79], v[136:139], v[160:163], v[64:79]
  ds_read_b128 v[156:159], v242 offset:28672
  s_waitcnt lgkmcnt(4)
  v_mfma_f32_32x32x16_bf16 v[96:111], v[140:143], v[160:163], v[96:111]
  ds_read_b128 v[128:131], v243 offset:0
  s_waitcnt lgkmcnt(4)
  v_mfma_f32_32x32x16_bf16 v[16:31], v[144:147], v[164:167], v[16:31]
  ds_read_b128 v[132:135], v243 offset:4096
  s_waitcnt lgkmcnt(4)
  v_mfma_f32_32x32x16_bf16 v[48:63], v[148:151], v[164:167], v[48:63]
  ds_read_b128 v[136:139], v243 offset:8192
  s_waitcnt lgkmcnt(4)
  v_mfma_f32_32x32x16_bf16 v[80:95], v[152:155], v[164:167], v[80:95]
  ds_read_b128 v[140:143], v243 offset:12288
  s_waitcnt lgkmcnt(4)
  v_mfma_f32_32x32x16_bf16 v[112:127], v[156:159], v[164:167], v[112:127]
  ds_read_b128 v[144:147], v243 offset:16384
  s_waitcnt vmcnt(5) lgkmcnt(4)
  v_mfma_f32_32x32x16_bf16 v[0:15], v[128:131], v[168:171], v[0:15]
  ds_read_b128 v[148:151], v243 offset:20480
  s_waitcnt lgkmcnt(4)
  v_mfma_f32_32x32x16_bf16 v[32:47], v[132:135], v[168:171], v[32:47]
  ds_read_b128 v[152:155], v243 offset:24576
  s_waitcnt lgkmcnt(4)
  v_mfma_f32_32x32x16_bf16 v[64:79], v[136:139], v[168:171], v[64:79]
  ds_read_b128 v[156:159], v243 offset:28672
  s_waitcnt lgkmcnt(4)
  v_mfma_f32_32x32x16_bf16 v[96:111], v[140:143], v[168:171], v[96:111]
  s_barrier
  ds_read_b128 v[128:131], v240 offset:32768
  s_waitcnt lgkmcnt(4)
  v_mfma_f32_32x32x16_bf16 v[16:31], v[144:147], v[172:175], v[16:31]
  ds_read_b128 v[132:135], v240 offset:36864
  s_waitcnt lgkmcnt(4)
  v_mfma_f32_32x32x16_bf16 v[48:63], v[148:151], v[172:175], v[48:63]
  ds_read_b128 v[136:139], v240 offset:40960
  s_waitcnt lgkmcnt(4)
  v_mfma_f32_32x32x16_bf16 v[80:95], v[152:155], v[172:175], v[80:95]
  ds_read_b128 v[140:143], v240 offset:45056
  s_waitcnt lgkmcnt(4)
  v_mfma_f32_32x32x16_bf16 v[112:127], v[156:159], v[172:175], v[112:127]
  ds_read_b128 v[144:147], v242 offset:32768
  s_waitcnt vmcnt(3) lgkmcnt(4)
  v_mfma_f32_32x32x16_bf16 v[0:15], v[128:131], v[176:179], v[0:15]
  ds_read_b128 v[148:151], v242 offset:36864
  s_waitcnt lgkmcnt(4)
  v_mfma_f32_32x32x16_bf16 v[32:47], v[132:135], v[176:179], v[32:47]
  ds_read_b128 v[152:155], v242 offset:40960
  s_waitcnt lgkmcnt(4)
  v_mfma_f32_32x32x16_bf16 v[64:79], v[136:139], v[176:179], v[64:79]
  ds_read_b128 v[156:159], v242 offset:45056
  s_waitcnt lgkmcnt(4)
  v_mfma_f32_32x32x16_bf16 v[96:111], v[140:143], v[176:179], v[96:111]
  ds_read_b128 v[128:131], v241 offset:32768
  s_waitcnt lgkmcnt(4)
  v_mfma_f32_32x32x16_bf16 v[16:31], v[144:147], v[180:183], v[16:31]
  ds_read_b128 v[132:135], v241 offset:36864
  s_waitcnt lgkmcnt(4)
  v_mfma_f32_32x32x16_bf16 v[48:63], v[148:151], v[180:183], v[48:63]
  ds_read_b128 v[136:139], v241 offset:40960
  s_waitcnt lgkmcnt(4)
  v_mfma_f32_32x32x16_bf16 v[80:95], v[152:155], v[180:183], v[80:95]
  ds_read_b128 v[140:143], v241 offset:45056
  s_waitcnt lgkmcnt(4)
  v_mfma_f32_32x32x16_bf16 v[112:127], v[156:159], v[180:183], v[112:127]
  ds_read_b128 v[144:147], v243 offset:32768
  s_waitcnt vmcnt(1) lgkmcnt(4)
  v_mfma_f32_32x32x16_bf16 v[0:15], v[128:131], v[184:187], v[0:15]
  ds_read_b128 v[148:151], v243 offset:36864
  s_waitcnt lgkmcnt(4)
  v_mfma_f32_32x32x16_bf16 v[32:47], v[132:135], v[184:187], v[32:47]
  ds_read_b128 v[152:155], v243 offset:40960
  s_waitcnt lgkmcnt(4)
  v_mfma_f32_32x32x16_bf16 v[64:79], v[136:139], v[184:187], v[64:79]
  ds_read_b128 v[156:159], v243 offset:45056
  s_waitcnt lgkmcnt(4)
  v_mfma_f32_32x32x16_bf16 v[96:111], v[140:143], v[184:187], v[96:111]
  s_waitcnt lgkmcnt(3)
  v_mfma_f32_32x32x16_bf16 v[16:31], v[144:147], v[188:191], v[16:31]
  s_waitcnt lgkmcnt(2)
  v_mfma_f32_32x32x16_bf16 v[48:63], v[148:151], v[188:191], v[48:63]
  s_waitcnt lgkmcnt(1)
  v_mfma_f32_32x32x16_bf16 v[80:95], v[152:155], v[188:191], v[80:95]
  s_waitcnt lgkmcnt(0)
  v_mfma_f32_32x32x16_bf16 v[112:127], v[156:159], v[188:191], v[112:127]
  ds_read_b128 v[224:227], v252 offset:0
  ds_read_b128 v[228:231], v252 offset:1024
  ds_read_b128 v[232:235], v252 offset:2048
  ds_read_b128 v[236:239], v252 offset:3072
  ds_read_b128 v[240:243], v252 offset:4096
  ds_read_b128 v[244:247], v252 offset:5120
  v_add_u32 v253, 122880, v253
  s_barrier
  ds_read_b128 v[192:195], v253 offset:0
  ds_read_b128 v[196:199], v253 offset:32
  ds_read_b128 v[200:203], v253 offset:64
  ds_read_b128 v[204:207], v253 offset:96
  s_cmp_lg_u32 s62, 0
  s_cbranch_scc1 fa_nv
  s_mov_b32 exec_lo, 1
  s_mov_b32 exec_hi, 1
  ds_read_b128 v[0:3], v253 offset:512
  ds_read_b128 v[4:7], v253 offset:544
  ds_read_b128 v[8:11], v253 offset:576
  ds_read_b128 v[12:15], v253 offset:608
  ds_read_b128 v[32:35], v253 offset:640
  ds_read_b128 v[36:39], v253 offset:672
  ds_read_b128 v[40:43], v253 offset:704
  ds_read_b128 v[44:47], v253 offset:736
  ds_read_b128 v[64:67], v253 offset:768
  ds_read_b128 v[68:71], v253 offset:800
  ds_read_b128 v[72:75], v253 offset:832
  ds_read_b128 v[76:79], v253 offset:864
  ds_read_b128 v[96:99], v253 offset:896
  ds_read_b128 v[100:103], v253 offset:928
  ds_read_b128 v[104:107], v253 offset:960
  ds_read_b128 v[108:111], v253 offset:992
  s_mov_b64 exec, -1
  s_waitcnt lgkmcnt(0)
fa_nv:
  ds_read_b128 v[208:211], v253 offset:128
  ds_read_b128 v[212:215], v253 offset:160
  ds_read_b128 v[216:219], v253 offset:192
  ds_read_b128 v[220:223], v253 offset:224
  s_mov_b32 s28, s55
  s_waitcnt lgkmcnt(4)
  v_pk_mul_f32 v[16:17], v[16:17], v[192:193]
  v_pk_mul_f32 v[18:19], v[18:19], v[194:195]
  v_pk_mul_f32 v[20:21], v[20:21], v[196:197]
  v_pk_mul_f32 v[22:23], v[22:23], v[198:199]
  v_pk_mul_f32 v[24:25], v[24:25], v[200:201]
  v_pk_mul_f32 v[26:27], v[26:27], v[202:203]
  v_pk_mul_f32 v[28:29], v[28:29], v[204:205]
  v_pk_mul_f32 v[30:31], v[30:31], v[206:207]
  v_cvt_pk_bf16_f32 v136, v16, v17
  v_cvt_pk_bf16_f32 v137, v18, v19
  v_cvt_pk_bf16_f32 v138, v20, v21
  v_cvt_pk_bf16_f32 v139, v22, v23
  v_cvt_pk_bf16_f32 v140, v24, v25
  v_cvt_pk_bf16_f32 v141, v26, v27
  v_cvt_pk_bf16_f32 v142, v28, v29
  v_cvt_pk_bf16_f32 v143, v30, v31
  v_pk_mul_f32 v[0:1], v[0:1], v[192:193]
  v_pk_mul_f32 v[2:3], v[2:3], v[194:195]
  v_pk_mul_f32 v[4:5], v[4:5], v[196:197]
  v_pk_mul_f32 v[6:7], v[6:7], v[198:199]
  v_pk_mul_f32 v[8:9], v[8:9], v[200:201]
  v_pk_mul_f32 v[10:11], v[10:11], v[202:203]
  v_pk_mul_f32 v[12:13], v[12:13], v[204:205]
  v_pk_mul_f32 v[14:15], v[14:15], v[206:207]
  v_cvt_pk_bf16_f32 v128, v0, v1
  v_cvt_pk_bf16_f32 v129, v2, v3
  v_cvt_pk_bf16_f32 v130, v4, v5
  v_cvt_pk_bf16_f32 v131, v6, v7
  v_cvt_pk_bf16_f32 v132, v8, v9
  v_cvt_pk_bf16_f32 v133, v10, v11
  v_cvt_pk_bf16_f32 v134, v12, v13
  v_cvt_pk_bf16_f32 v135, v14, v15
  v_mfma_f32_32x32x16_bf16 v[16:31], v[224:227], v[136:139], 0
  s_waitcnt lgkmcnt(0)
  ds_read_b128 v[192:195], v253 offset:256
  ds_read_b128 v[196:199], v253 offset:288
  ds_read_b128 v[200:203], v253 offset:320
  ds_read_b128 v[204:207], v253 offset:352
  v_mul_f32 v48, v48, v208
  v_mfma_f32_32x32x16_bf16 v[0:15], v[224:227], v[128:131], 0
  v_mul_f32 v49, v49, v209
  v_mul_f32 v50, v50, v210
  v_mul_f32 v51, v51, v211
  v_mul_f32 v52, v52, v212
  v_mul_f32 v53, v53, v213
  v_mul_f32 v54, v54, v214
  v_mul_f32 v55, v55, v215
  v_mfma_f32_32x32x16_bf16 v[16:31], v[228:231], v[140:143], v[16:31]
  v_mul_f32 v56, v56, v216
  v_mul_f32 v57, v57, v217
  v_mul_f32 v58, v58, v218
  v_mul_f32 v59, v59, v219
  v_mul_f32 v60, v60, v220
  v_mul_f32 v61, v61, v221
  v_mfma_f32_32x32x16_bf16 v[0:15], v[228:231], v[132:135], v[0:15]
  v_mul_f32 v62, v62, v222
  v_mul_f32 v63, v63, v223
  v_cvt_pk_bf16_f32 v152, v48, v49
  v_cvt_pk_bf16_f32 v153, v50, v51
  v_cvt_pk_bf16_f32 v154, v52, v53
  v_cvt_pk_bf16_f32 v155, v54, v55
  v_cvt_pk_bf16_f32 v156, v56, v57
  v_mfma_f32_32x32x16_bf16 v[16:31], v[240:243], v[128:131], v[16:31]
  v_cvt_pk_bf16_f32 v157, v58, v59
  v_cvt_pk_bf16_f32 v158, v60, v61
  v_cvt_pk_bf16_f32 v159, v62, v63
  v_mul_f32 v32, v32, v208
  v_mul_f32 v33, v33, v209
  v_mul_f32 v34, v34, v210
  v_mul_f32 v35, v35, v211
  v_mfma_f32_32x32x16_bf16 v[0:15], v[232:235], v[136:139], v[0:15]
  v_mul_f32 v36, v36, v212
  v_mul_f32 v37, v37, v213
  v_mul_f32 v38, v38, v214
  v_mul_f32 v39, v39, v215
  v_mul_f32 v40, v40, v216
  v_mul_f32 v41, v41, v217
  v_mfma_f32_32x32x16_bf16 v[16:31], v[244:247], v[132:135], v[16:31]
  v_mul_f32 v42, v42, v218
  v_mul_f32 v43, v43, v219
  v_mul_f32 v44, v44, v220
  v_mul_f32 v45, v45, v221
  v_mul_f32 v46, v46, v222
  v_mul_f32 v47, v47, v223
  v_cvt_pk_bf16_f32 v144, v32, v33
  v_mfma_f32_32x32x16_bf16 v[0:15], v[236:239], v[140:143], v[0:15]
  v_cvt_pk_bf16_f32 v145, v34, v35
  v_cvt_pk_bf16_f32 v146, v36, v37
  v_cvt_pk_bf16_f32 v147, v38, v39
  v_cvt_pk_bf16_f32 v148, v40, v41
  v_cvt_pk_bf16_f32 v149, v42, v43
  v_cvt_pk_bf16_f32 v150, v44, v45
  v_cvt_pk_bf16_f32 v151, v46, v47
  v_mfma_f32_32x32x16_bf16 v[48:63], v[224:227], v[152:155], 0
  s_waitcnt lgkmcnt(0)
  ds_read_b128 v[208:211], v253 offset:384
  ds_read_b128 v[212:215], v253 offset:416
  ds_read_b128 v[216:219], v253 offset:448
  ds_read_b128 v[220:223], v253 offset:480
  v_mul_f32 v80, v80, v192
  v_mfma_f32_32x32x16_bf16 v[32:47], v[224:227], v[144:147], 0
  v_mul_f32 v81, v81, v193
  v_mul_f32 v82, v82, v194
  v_mul_f32 v83, v83, v195
  v_mul_f32 v84, v84, v196
  v_mul_f32 v85, v85, v197
  v_mul_f32 v86, v86, v198
  v_mul_f32 v87, v87, v199
  v_mfma_f32_32x32x16_bf16 v[48:63], v[228:231], v[156:159], v[48:63]
  v_mul_f32 v88, v88, v200
  v_mul_f32 v89, v89, v201
  v_mul_f32 v90, v90, v202
  v_mul_f32 v91, v91, v203
  v_mul_f32 v92, v92, v204
  v_mul_f32 v93, v93, v205
  v_mfma_f32_32x32x16_bf16 v[32:47], v[228:231], v[148:151], v[32:47]
  v_mul_f32 v94, v94, v206
  v_mul_f32 v95, v95, v207
  v_cvt_pk_bf16_f32 v136, v80, v81
  v_cvt_pk_bf16_f32 v137, v82, v83
  v_cvt_pk_bf16_f32 v138, v84, v85
  v_cvt_pk_bf16_f32 v139, v86, v87
  v_cvt_pk_bf16_f32 v140, v88, v89
  v_mfma_f32_32x32x16_bf16 v[48:63], v[240:243], v[144:147], v[48:63]
  v_cvt_pk_bf16_f32 v141, v90, v91
  v_cvt_pk_bf16_f32 v142, v92, v93
  v_cvt_pk_bf16_f32 v143, v94, v95
  v_mul_f32 v64, v64, v192
  v_mul_f32 v65, v65, v193
  v_mul_f32 v66, v66, v194
  v_mul_f32 v67, v67, v195
  v_mfma_f32_32x32x16_bf16 v[32:47], v[232:235], v[152:155], v[32:47]
  v_mul_f32 v68, v68, v196
  v_mul_f32 v69, v69, v197
  v_mul_f32 v70, v70, v198
  v_mul_f32 v71, v71, v199
  v_mul_f32 v72, v72, v200
  v_mul_f32 v73, v73, v201
  v_mfma_f32_32x32x16_bf16 v[48:63], v[244:247], v[148:151], v[48:63]
  v_mul_f32 v74, v74, v202
  v_mul_f32 v75, v75, v203
  v_mul_f32 v76, v76, v204
  v_mul_f32 v77, v77, v205
  v_mul_f32 v78, v78, v206
  v_mul_f32 v79, v79, v207
  v_cvt_pk_bf16_f32 v128, v64, v65
  v_mfma_f32_32x32x16_bf16 v[32:47], v[236:239], v[156:159], v[32:47]
  v_cvt_pk_bf16_f32 v129, v66, v67
  v_cvt_pk_bf16_f32 v130, v68, v69
  v_cvt_pk_bf16_f32 v131, v70, v71
  v_cvt_pk_bf16_f32 v132, v72, v73
  v_cvt_pk_bf16_f32 v133, v74, v75
  v_cvt_pk_bf16_f32 v134, v76, v77
  v_cvt_pk_bf16_f32 v135, v78, v79
  v_mfma_f32_32x32x16_bf16 v[80:95], v[224:227], v[136:139], 0
  s_waitcnt lgkmcnt(0)
  v_mul_f32 v112, v112, v208
  v_mul_f32 v113, v113, v209
  v_mul_f32 v114, v114, v210
  v_mul_f32 v115, v115, v211
  v_mul_f32 v116, v116, v212
  v_mul_f32 v117, v117, v213
  v_mfma_f32_32x32x16_bf16 v[64:79], v[224:227], v[128:131], 0
  v_mul_f32 v118, v118, v214
  v_mul_f32 v119, v119, v215
  v_mul_f32 v120, v120, v216
  v_mul_f32 v121, v121, v217
  v_mul_f32 v122, v122, v218
  v_mul_f32 v123, v123, v219
  v_mul_f32 v124, v124, v220
  v_mul_f32 v125, v125, v221
  v_mfma_f32_32x32x16_bf16 v[80:95], v[228:231], v[140:143], v[80:95]
  v_mul_f32 v126, v126, v222
  v_mul_f32 v127, v127, v223
  v_cvt_pk_bf16_f32 v152, v112, v113
  v_cvt_pk_bf16_f32 v153, v114, v115
  v_cvt_pk_bf16_f32 v154, v116, v117
  v_cvt_pk_bf16_f32 v155, v118, v119
  v_cvt_pk_bf16_f32 v156, v120, v121
  v_mfma_f32_32x32x16_bf16 v[64:79], v[228:231], v[132:135], v[64:79]
  v_cvt_pk_bf16_f32 v157, v122, v123
  v_cvt_pk_bf16_f32 v158, v124, v125
  v_cvt_pk_bf16_f32 v159, v126, v127
  v_mul_f32 v96, v96, v208
  v_mul_f32 v97, v97, v209
  v_mul_f32 v98, v98, v210
  v_mul_f32 v99, v99, v211
  v_mul_f32 v100, v100, v212
  v_mfma_f32_32x32x16_bf16 v[80:95], v[240:243], v[128:131], v[80:95]
  v_mul_f32 v101, v101, v213
  v_mul_f32 v102, v102, v214
  v_mul_f32 v103, v103, v215
  v_mul_f32 v104, v104, v216
  v_mul_f32 v105, v105, v217
  v_mul_f32 v106, v106, v218
  v_mul_f32 v107, v107, v219
  v_mul_f32 v108, v108, v220
  v_mfma_f32_32x32x16_bf16 v[64:79], v[232:235], v[136:139], v[64:79]
  v_mul_f32 v109, v109, v221
  v_mul_f32 v110, v110, v222
  v_mul_f32 v111, v111, v223
  v_cvt_pk_bf16_f32 v144, v96, v97
  v_cvt_pk_bf16_f32 v145, v98, v99
  v_cvt_pk_bf16_f32 v146, v100, v101
  v_cvt_pk_bf16_f32 v147, v102, v103
  v_mfma_f32_32x32x16_bf16 v[80:95], v[244:247], v[132:135], v[80:95]
  v_cvt_pk_bf16_f32 v148, v104, v105
  v_cvt_pk_bf16_f32 v149, v106, v107
  v_cvt_pk_bf16_f32 v150, v108, v109
  v_cvt_pk_bf16_f32 v151, v110, v111
  v_cvt_pk_bf16_f32 v160, v0, v32
  v_cvt_pk_bf16_f32 v161, v1, v33
  v_cvt_pk_bf16_f32 v162, v16, v48
  v_cvt_pk_bf16_f32 v163, v17, v49
  v_mfma_f32_32x32x16_bf16 v[64:79], v[236:239], v[140:143], v[64:79]
  buffer_store_dwordx4 v[160:163], v248, s[24:27], s28 offen sc1
  s_add_u32 s28, s28, 131072
  v_cvt_pk_bf16_f32 v164, v2, v34
  v_cvt_pk_bf16_f32 v165, v3, v35
  v_cvt_pk_bf16_f32 v166, v18, v50
  v_cvt_pk_bf16_f32 v167, v19, v51
  buffer_store_dwordx4 v[164:167], v248, s[24:27], s28 offen sc1
  s_add_u32 s28, s28, 393216
  v_mfma_f32_32x32x16_bf16 v[112:127], v[224:227], v[152:155], 0
  v_cvt_pk_bf16_f32 v168, v4, v36
  v_cvt_pk_bf16_f32 v169, v5, v37
  v_cvt_pk_bf16_f32 v170, v20, v52
  v_cvt_pk_bf16_f32 v171, v21, v53
  v_mfma_f32_32x32x16_bf16 v[96:111], v[224:227], v[144:147], 0
  buffer_store_dwordx4 v[168:171], v248, s[24:27], s28 offen sc1
  s_add_u32 s28, s28, 131072
  v_cvt_pk_bf16_f32 v172, v6, v38
  v_cvt_pk_bf16_f32 v173, v7, v39
  v_cvt_pk_bf16_f32 v174, v22, v54
  v_mfma_f32_32x32x16_bf16 v[112:127], v[228:231], v[156:159], v[112:127]
  v_cvt_pk_bf16_f32 v175, v23, v55
  buffer_store_dwordx4 v[172:175], v248, s[24:27], s28 offen sc1
  s_add_u32 s28, s28, 393216
  v_cvt_pk_bf16_f32 v176, v8, v40
  v_mfma_f32_32x32x16_bf16 v[96:111], v[228:231], v[148:151], v[96:111]
  v_cvt_pk_bf16_f32 v177, v9, v41
  v_cvt_pk_bf16_f32 v178, v24, v56
  v_cvt_pk_bf16_f32 v179, v25, v57
  buffer_store_dwordx4 v[176:179], v248, s[24:27], s28 offen sc1
  s_add_u32 s28, s28, 131072
  v_mfma_f32_32x32x16_bf16 v[112:127], v[240:243], v[144:147], v[112:127]
  v_cvt_pk_bf16_f32 v180, v10, v42
  v_cvt_pk_bf16_f32 v181, v11, v43
  v_cvt_pk_bf16_f32 v182, v26, v58
  v_cvt_pk_bf16_f32 v183, v27, v59
  v_mfma_f32_32x32x16_bf16 v[96:111], v[232:235], v[152:155], v[96:111]
  buffer_store_dwordx4 v[180:183], v248, s[24:27], s28 offen sc1
  s_add_u32 s28, s28, 393216
  v_cvt_pk_bf16_f32 v184, v12, v44
  v_cvt_pk_bf16_f32 v185, v13, v45
  v_cvt_pk_bf16_f32 v186, v28, v60
  v_mfma_f32_32x32x16_bf16 v[112:127], v[244:247], v[148:151], v[112:127]
  v_cvt_pk_bf16_f32 v187, v29, v61
  buffer_store_dwordx4 v[184:187], v248, s[24:27], s28 offen sc1
  s_add_u32 s28, s28, 131072
  v_cvt_pk_bf16_f32 v188, v14, v46
  v_mfma_f32_32x32x16_bf16 v[96:111], v[236:239], v[156:159], v[96:111]
  v_cvt_pk_bf16_f32 v189, v15, v47
  v_cvt_pk_bf16_f32 v190, v30, v62
  v_cvt_pk_bf16_f32 v191, v31, v63
  buffer_store_dwordx4 v[188:191], v248, s[24:27], s28 offen sc1
  s_add_u32 s28, s55, 4096
  s_nop 6
  v_cvt_pk_bf16_f32 v192, v64, v96
  v_cvt_pk_bf16_f32 v193, v65, v97
  v_cvt_pk_bf16_f32 v194, v80, v112
  v_cvt_pk_bf16_f32 v195, v81, v113
  buffer_store_dwordx4 v[192:195], v248, s[24:27], s28 offen sc1
  s_add_u32 s28, s28, 131072
  v_cvt_pk_bf16_f32 v196, v66, v98
  v_cvt_pk_bf16_f32 v197, v67, v99
  v_cvt_pk_bf16_f32 v198, v82, v114
  v_cvt_pk_bf16_f32 v199, v83, v115
  buffer_store_dwordx4 v[196:199], v248, s[24:27], s28 offen sc1
  s_add_u32 s28, s28, 393216
  v_cvt_pk_bf16_f32 v200, v68, v100
  v_cvt_pk_bf16_f32 v201, v69, v101
  v_cvt_pk_bf16_f32 v202, v84, v116
  v_cvt_pk_bf16_f32 v203, v85, v117
  buffer_store_dwordx4 v[200:203], v248, s[24:27], s28 offen sc1
  s_add_u32 s28, s28, 131072
  v_cvt_pk_bf16_f32 v204, v70, v102
  v_cvt_pk_bf16_f32 v205, v71, v103
  v_cvt_pk_bf16_f32 v206, v86, v118
  v_cvt_pk_bf16_f32 v207, v87, v119
  buffer_store_dwordx4 v[204:207], v248, s[24:27], s28 offen sc1
  s_add_u32 s28, s28, 393216
  v_cvt_pk_bf16_f32 v208, v72, v104
  v_cvt_pk_bf16_f32 v209, v73, v105
  v_cvt_pk_bf16_f32 v210, v88, v120
  v_cvt_pk_bf16_f32 v211, v89, v121
  buffer_store_dwordx4 v[208:211], v248, s[24:27], s28 offen sc1
  s_add_u32 s28, s28, 131072
  v_cvt_pk_bf16_f32 v212, v74, v106
  v_cvt_pk_bf16_f32 v213, v75, v107
  v_cvt_pk_bf16_f32 v214, v90, v122
  v_cvt_pk_bf16_f32 v215, v91, v123
  buffer_store_dwordx4 v[212:215], v248, s[24:27], s28 offen sc1
  s_add_u32 s28, s28, 393216
  v_cvt_pk_bf16_f32 v216, v76, v108
  v_cvt_pk_bf16_f32 v217, v77, v109
  v_cvt_pk_bf16_f32 v218, v92, v124
  v_cvt_pk_bf16_f32 v219, v93, v125
  buffer_store_dwordx4 v[216:219], v248, s[24:27], s28 offen sc1
  s_add_u32 s28, s28, 131072
  v_cvt_pk_bf16_f32 v220, v78, v110
  v_cvt_pk_bf16_f32 v221, v79, v111
  v_cvt_pk_bf16_f32 v222, v94, v126
  v_cvt_pk_bf16_f32 v223, v95, v127
  buffer_store_dwordx4 v[220:223], v248, s[24:27], s28 offen sc1
  s_setprio 0
  s_lshl2_add_u32 s14, s12, s13
  s_and_b32 s15, s14, 1
  s_lshr_b32 s14, s14, 1
  s_and_b32 s16, s14, 1
  s_mul_i32 s18, s15, 7
  s_add_u32 s18, s18, s17
  s_sub_u32 s44, 0, s14
  s_cmp_eq_u32 s14, 0
  s_cselect_b32 s44, 16, s44
  v_and_b32 v244, 15, v254
  v_lshrrev_b32 v245, 4, v254
  s_lshl2_add_u32 s60, s40, s60
  v_mov_b32 v252, 1
  v_mov_b32 v253, 0
  s_mov_b64 exec, 1
  s_waitcnt vmcnt(0)
  buffer_store_dword v252, v253, s[24:27], s60 offen sc1
  s_mov_b64 exec, -1
  s_branch amid_main
f_end:
  s_endpgm

code_end:
.section .rodata,"a"
.p2align 6
.amdhsa_kernel f_kernel
  .amdhsa_next_free_vgpr 256
  .amdhsa_next_free_sgpr 102
  .amdhsa_accum_offset 256
  .amdhsa_group_segment_fixed_size 0
  .amdhsa_kernarg_size 80
  .amdhsa_user_sgpr_count 2
  .amdhsa_user_sgpr_kernarg_segment_ptr 1
  .amdhsa_system_sgpr_workgroup_id_x 1
.end_amdhsa_kernel
.set c896_0, 0x3f80
.set c896_1, 0x3f80
.set c896_2, 0x3f80
.set c896_3, 0x3f80
.set c896_4, 0x3f80
.set c896_5, 0x3f80
.set c896_6, 0x3f80
.set c896_7, 0x3f80
.set c896_8, 0x3f80
.set c896_9, 0x3f7f
.set c896_10, 0x3f7f
.set c896_11, 0x3f7f
.set c896_12, 0x3f7f
.set c896_13, 0x3f7f
.set c896_14, 0x3f7f
.set c896_15, 0x3f7f
.set c896_16, 0x3f7e
.set c896_17, 0x3f7e
.set c896_18, 0x3f7e
.set c896_19, 0x3f7e
.set c896_20, 0x3f7d
.set c896_21, 0x3f7d
.set c896_22, 0x3f7d
.set c896_23, 0x3f7d
.set c896_24, 0x3f7c
.set c896_25, 0x3f7c
.set c896_26, 0x3f7c
.set c896_27, 0x3f7b
.set c896_28, 0x3f7b
.set c896_29, 0x3f7b
.set c896_30, 0x3f7a
.set c896_31, 0x3f7a
.set c896_32, 0x3f7a
.set c896_33, 0x3f79
.set c896_34, 0x3f79
.set c896_35, 0x3f78
.set c896_36, 0x3f78
.set c896_37, 0x3f77
.set c896_38, 0x3f77
.set c896_39, 0x3f76
.set c896_40, 0x3f76
.set c896_41, 0x3f75
.set c896_42, 0x3f75
.set c896_43, 0x3f74
.set c896_44, 0x3f74
.set c896_45, 0x3f73
.set c896_46, 0x3f73
.set c896_47, 0x3f72
.set c896_48, 0x3f72
.set c896_49, 0x3f71
.set c896_50, 0x3f70
.set c896_51, 0x3f70
.set c896_52, 0x3f6f
.set c896_53, 0x3f6f
.set c896_54, 0x3f6e
.set c896_55, 0x3f6d
.set c896_56, 0x3f6d
.set c896_57, 0x3f6c
.set c896_58, 0x3f6b
.set c896_59, 0x3f6a
.set c896_60, 0x3f6a
.set c896_61, 0x3f69
.set c896_62, 0x3f68
.set c896_63, 0x3f67
.set c896_64, 0x3f67
.set c896_65, 0x3f66
.set c896_66, 0x3f65
.set c896_67, 0x3f64
.set c896_68, 0x3f63
.set c896_69, 0x3f63
.set c896_70, 0x3f62
.set c896_71, 0x3f61
.set c896_72, 0x3f60
.set c896_73, 0x3f5f
.set c896_74, 0x3f5e
.set c896_75, 0x3f5d
.set c896_76, 0x3f5c
.set c896_77, 0x3f5c
.set c896_78, 0x3f5b
.set c896_79, 0x3f5a
.set c896_80, 0x3f59
.set c896_81, 0x3f58
.set c896_82, 0x3f57
.set c896_83, 0x3f56
.set c896_84, 0x3f55
.set c896_85, 0x3f54
.set c896_86, 0x3f53
.set c896_87, 0x3f52
.set c896_88, 0x3f51
.set c896_89, 0x3f50
.set c896_90, 0x3f4f
.set c896_91, 0x3f4e
.set c896_92, 0x3f4d
.set c896_93, 0x3f4b
.set c896_94, 0x3f4a
.set c896_95, 0x3f49
.set c896_96, 0x3f48
.set c896_97, 0x3f47
.set c896_98, 0x3f46
.set c896_99, 0x3f45
.set c896_100, 0x3f44
.set c896_101, 0x3f42
.set c896_102, 0x3f41
.set c896_103, 0x3f40
.set c896_104, 0x3f3f
.set c896_105, 0x3f3e
.set c896_106, 0x3f3c
.set c896_107, 0x3f3b
.set c896_108, 0x3f3a
.set c896_109, 0x3f39
.set c896_110, 0x3f38
.set c896_111, 0x3f36
.set c896_112, 0x3f35
.set c896_113, 0x3f34
.set c896_114, 0x3f32
.set c896_115, 0x3f31
.set c896_116, 0x3f30
.set c896_117, 0x3f2f
.set c896_118, 0x3f2d
.set c896_119, 0x3f2c
.set c896_120, 0x3f2b
.set c896_121, 0x3f29
.set c896_122, 0x3f28
.set c896_123, 0x3f27
.set c896_124, 0x3f25
.set c896_125, 0x3f24
.set c896_126, 0x3f22
.set c896_127, 0x3f21
.set c896_128, 0x3f20
.set c896_129, 0x3f1e
.set c896_130, 0x3f1d
.set c896_131, 0x3f1b
.set c896_132, 0x3f1a
.set c896_133, 0x3f18
.set c896_134, 0x3f17
.set c896_135, 0x3f16
.set c896_136, 0x3f14
.set c896_137, 0x3f13
.set c896_138, 0x3f11
.set c896_139, 0x3f10
.set c896_140, 0x3f0e
.set c896_141, 0x3f0d
.set c896_142, 0x3f0b
.set c896_143, 0x3f0a
.set c896_144, 0x3f08
.set c896_145, 0x3f07
.set c896_146, 0x3f05
.set c896_147, 0x3f04
.set c896_148, 0x3f02
.set c896_149, 0x3f01
.set c896_150, 0x3efe
.set c896_151, 0x3efb
.set c896_152, 0x3ef8
.set c896_153, 0x3ef5
.set c896_154, 0x3ef1
.set c896_155, 0x3eee
.set c896_156, 0x3eeb
.set c896_157, 0x3ee8
.set c896_158, 0x3ee5
.set c896_159, 0x3ee1
.set c896_160, 0x3ede
.set c896_161, 0x3edb
.set c896_162, 0x3ed8
.set c896_163, 0x3ed4
.set c896_164, 0x3ed1
.set c896_165, 0x3ece
.set c896_166, 0x3ecb
.set c896_167, 0x3ec7
.set c896_168, 0x3ec4
.set c896_169, 0x3ec1
.set c896_170, 0x3ebd
.set c896_171, 0x3eba
.set c896_172, 0x3eb7
.set c896_173, 0x3eb3
.set c896_174, 0x3eb0
.set c896_175, 0x3eac
.set c896_176, 0x3ea9
.set c896_177, 0x3ea6
.set c896_178, 0x3ea2
.set c896_179, 0x3e9f
.set c896_180, 0x3e9b
.set c896_181, 0x3e98
.set c896_182, 0x3e95
.set c896_183, 0x3e91
.set c896_184, 0x3e8e
.set c896_185, 0x3e8a
.set c896_186, 0x3e87
.set c896_187, 0x3e83
.set c896_188, 0x3e80
.set c896_189, 0x3e79
.set c896_190, 0x3e72
.set c896_191, 0x3e6b
.set c896_192, 0x3e64
.set c896_193, 0x3e5d
.set c896_194, 0x3e56
.set c896_195, 0x3e4f
.set c896_196, 0x3e48
.set c896_197, 0x3e41
.set c896_198, 0x3e3a
.set c896_199, 0x3e33
.set c896_200, 0x3e2c
.set c896_201, 0x3e24
.set c896_202, 0x3e1d
.set c896_203, 0x3e16
.set c896_204, 0x3e0f
.set c896_205, 0x3e08
.set c896_206, 0x3e01
.set c896_207, 0x3df4
.set c896_208, 0x3de5
.set c896_209, 0x3dd7
.set c896_210, 0x3dc9
.set c896_211, 0x3dba
.set c896_212, 0x3dac
.set c896_213, 0x3d9e
.set c896_214, 0x3d8f
.set c896_215, 0x3d81
.set c896_216, 0x3d66
.set c896_217, 0x3d49
.set c896_218, 0x3d2c
.set c896_219, 0x3d10
.set c896_220, 0x3ce6
.set c896_221, 0x3cac
.set c896_222, 0x3c66
.set c896_223, 0x3be6
.set c896_224, 0x0000
.set c896_225, 0xbbe6
.set c896_226, 0xbc66
.set c896_227, 0xbcac
.set c896_228, 0xbce6
.set c896_229, 0xbd10
.set c896_230, 0xbd2c
.set c896_231, 0xbd49
.set c896_232, 0xbd66
.set c896_233, 0xbd81
.set c896_234, 0xbd8f
.set c896_235, 0xbd9e
.set c896_236, 0xbdac
.set c896_237, 0xbdba
.set c896_238, 0xbdc9
.set c896_239, 0xbdd7
.set c896_240, 0xbde5
.set c896_241, 0xbdf4
.set c896_242, 0xbe01
.set c896_243, 0xbe08
.set c896_244, 0xbe0f
.set c896_245, 0xbe16
.set c896_246, 0xbe1d
.set c896_247, 0xbe24
.set c896_248, 0xbe2c
.set c896_249, 0xbe33
.set c896_250, 0xbe3a
.set c896_251, 0xbe41
.set c896_252, 0xbe48
.set c896_253, 0xbe4f
.set c896_254, 0xbe56
.set c896_255, 0xbe5d
.set c896_256, 0xbe64
.set c896_257, 0xbe6b
.set c896_258, 0xbe72
.set c896_259, 0xbe79
.set c896_260, 0xbe80
.set c896_261, 0xbe83
.set c896_262, 0xbe87
.set c896_263, 0xbe8a
.set c896_264, 0xbe8e
.set c896_265, 0xbe91
.set c896_266, 0xbe95
.set c896_267, 0xbe98
.set c896_268, 0xbe9b
.set c896_269, 0xbe9f
.set c896_270, 0xbea2
.set c896_271, 0xbea6
.set c896_272, 0xbea9
.set c896_273, 0xbeac
.set c896_274, 0xbeb0
.set c896_275, 0xbeb3
.set c896_276, 0xbeb7
.set c896_277, 0xbeba
.set c896_278, 0xbebd
.set c896_279, 0xbec1
.set c896_280, 0xbec4
.set c896_281, 0xbec7
.set c896_282, 0xbecb
.set c896_283, 0xbece
.set c896_284, 0xbed1
.set c896_285, 0xbed4
.set c896_286, 0xbed8
.set c896_287, 0xbedb
.set c896_288, 0xbede
.set c896_289, 0xbee1
.set c896_290, 0xbee5
.set c896_291, 0xbee8
.set c896_292, 0xbeeb
.set c896_293, 0xbeee
.set c896_294, 0xbef1
.set c896_295, 0xbef5
.set c896_296, 0xbef8
.set c896_297, 0xbefb
.set c896_298, 0xbefe
.set c896_299, 0xbf01
.set c896_300, 0xbf02
.set c896_301, 0xbf04
.set c896_302, 0xbf05
.set c896_303, 0xbf07
.set c896_304, 0xbf08
.set c896_305, 0xbf0a
.set c896_306, 0xbf0b
.set c896_307, 0xbf0d
.set c896_308, 0xbf0e
.set c896_309, 0xbf10
.set c896_310, 0xbf11
.set c896_311, 0xbf13
.set c896_312, 0xbf14
.set c896_313, 0xbf16
.set c896_314, 0xbf17
.set c896_315, 0xbf18
.set c896_316, 0xbf1a
.set c896_317, 0xbf1b
.set c896_318, 0xbf1d
.set c896_319, 0xbf1e
.set c896_320, 0xbf20
.set c896_321, 0xbf21
.set c896_322, 0xbf22
.set c896_323, 0xbf24
.set c896_324, 0xbf25
.set c896_325, 0xbf27
.set c896_326, 0xbf28
.set c896_327, 0xbf29
.set c896_328, 0xbf2b
.set c896_329, 0xbf2c
.set c896_330, 0xbf2d
.set c896_331, 0xbf2f
.set c896_332, 0xbf30
.set c896_333, 0xbf31
.set c896_334, 0xbf32
.set c896_335, 0xbf34
.set c896_336, 0xbf35
.set c896_337, 0xbf36
.set c896_338, 0xbf38
.set c896_339, 0xbf39
.set c896_340, 0xbf3a
.set c896_341, 0xbf3b
.set c896_342, 0xbf3c
.set c896_343, 0xbf3e
.set c896_344, 0xbf3f
.set c896_345, 0xbf40
.set c896_346, 0xbf41
.set c896_347, 0xbf42
.set c896_348, 0xbf44
.set c896_349, 0xbf45
.set c896_350, 0xbf46
.set c896_351, 0xbf47
.set c896_352, 0xbf48
.set c896_353, 0xbf49
.set c896_354, 0xbf4a
.set c896_355, 0xbf4b
.set c896_356, 0xbf4d
.set c896_357, 0xbf4e
.set c896_358, 0xbf4f
.set c896_359, 0xbf50
.set c896_360, 0xbf51
.set c896_361, 0xbf52
.set c896_362, 0xbf53
.set c896_363, 0xbf54
.set c896_364, 0xbf55
.set c896_365, 0xbf56
.set c896_366, 0xbf57
.set c896_367, 0xbf58
.set c896_368, 0xbf59
.set c896_369, 0xbf5a
.set c896_370, 0xbf5b
.set c896_371, 0xbf5c
.set c896_372, 0xbf5c
.set c896_373, 0xbf5d
.set c896_374, 0xbf5e
.set c896_375, 0xbf5f
.set c896_376, 0xbf60
.set c896_377, 0xbf61
.set c896_378, 0xbf62
.set c896_379, 0xbf63
.set c896_380, 0xbf63
.set c896_381, 0xbf64
.set c896_382, 0xbf65
.set c896_383, 0xbf66
.set c896_384, 0xbf67
.set c896_385, 0xbf67
.set c896_386, 0xbf68
.set c896_387, 0xbf69
.set c896_388, 0xbf6a
.set c896_389, 0xbf6a
.set c896_390, 0xbf6b
.set c896_391, 0xbf6c
.set c896_392, 0xbf6d
.set c896_393, 0xbf6d
.set c896_394, 0xbf6e
.set c896_395, 0xbf6f
.set c896_396, 0xbf6f
.set c896_397, 0xbf70
.set c896_398, 0xbf70
.set c896_399, 0xbf71
.set c896_400, 0xbf72
.set c896_401, 0xbf72
.set c896_402, 0xbf73
.set c896_403, 0xbf73
.set c896_404, 0xbf74
.set c896_405, 0xbf74
.set c896_406, 0xbf75
.set c896_407, 0xbf75
.set c896_408, 0xbf76
.set c896_409, 0xbf76
.set c896_410, 0xbf77
.set c896_411, 0xbf77
.set c896_412, 0xbf78
.set c896_413, 0xbf78
.set c896_414, 0xbf79
.set c896_415, 0xbf79
.set c896_416, 0xbf7a
.set c896_417, 0xbf7a
.set c896_418, 0xbf7a
.set c896_419, 0xbf7b
.set c896_420, 0xbf7b
.set c896_421, 0xbf7b
.set c896_422, 0xbf7c
.set c896_423, 0xbf7c
.set c896_424, 0xbf7c
.set c896_425, 0xbf7d
.set c896_426, 0xbf7d
.set c896_427, 0xbf7d
.set c896_428, 0xbf7d
.set c896_429, 0xbf7e
.set c896_430, 0xbf7e
.set c896_431, 0xbf7e
.set c896_432, 0xbf7e
.set c896_433, 0xbf7f
.set c896_434, 0xbf7f
.set c896_435, 0xbf7f
.set c896_436, 0xbf7f
.set c896_437, 0xbf7f
.set c896_438, 0xbf7f
.set c896_439, 0xbf7f
.set c896_440, 0xbf80
.set c896_441, 0xbf80
.set c896_442, 0xbf80
.set c896_443, 0xbf80
.set c896_444, 0xbf80
.set c896_445, 0xbf80
.set c896_446, 0xbf80
.set c896_447, 0xbf80
.set c896_448, 0xbf80
.set c896_449, 0xbf80
.set c896_450, 0xbf80
.set c896_451, 0xbf80
.set c896_452, 0xbf80
.set c896_453, 0xbf80
.set c896_454, 0xbf80
.set c896_455, 0xbf80
.set c896_456, 0xbf80
.set c896_457, 0xbf7f
.set c896_458, 0xbf7f
.set c896_459, 0xbf7f
.set c896_460, 0xbf7f
.set c896_461, 0xbf7f
.set c896_462, 0xbf7f
.set c896_463, 0xbf7f
.set c896_464, 0xbf7e
.set c896_465, 0xbf7e
.set c896_466, 0xbf7e
.set c896_467, 0xbf7e
.set c896_468, 0xbf7d
.set c896_469, 0xbf7d
.set c896_470, 0xbf7d
.set c896_471, 0xbf7d
.set c896_472, 0xbf7c
.set c896_473, 0xbf7c
.set c896_474, 0xbf7c
.set c896_475, 0xbf7b
.set c896_476, 0xbf7b
.set c896_477, 0xbf7b
.set c896_478, 0xbf7a
.set c896_479, 0xbf7a
.set c896_480, 0xbf7a
.set c896_481, 0xbf79
.set c896_482, 0xbf79
.set c896_483, 0xbf78
.set c896_484, 0xbf78
.set c896_485, 0xbf77
.set c896_486, 0xbf77
.set c896_487, 0xbf76
.set c896_488, 0xbf76
.set c896_489, 0xbf75
.set c896_490, 0xbf75
.set c896_491, 0xbf74
.set c896_492, 0xbf74
.set c896_493, 0xbf73
.set c896_494, 0xbf73
.set c896_495, 0xbf72
.set c896_496, 0xbf72
.set c896_497, 0xbf71
.set c896_498, 0xbf70
.set c896_499, 0xbf70
.set c896_500, 0xbf6f
.set c896_501, 0xbf6f
.set c896_502, 0xbf6e
.set c896_503, 0xbf6d
.set c896_504, 0xbf6d
.set c896_505, 0xbf6c
.set c896_506, 0xbf6b
.set c896_507, 0xbf6a
.set c896_508, 0xbf6a
.set c896_509, 0xbf69
.set c896_510, 0xbf68
.set c896_511, 0xbf67
.set c896_512, 0xbf67
.set c896_513, 0xbf66
.set c896_514, 0xbf65
.set c896_515, 0xbf64
.set c896_516, 0xbf63
.set c896_517, 0xbf63
.set c896_518, 0xbf62
.set c896_519, 0xbf61
.set c896_520, 0xbf60
.set c896_521, 0xbf5f
.set c896_522, 0xbf5e
.set c896_523, 0xbf5d
.set c896_524, 0xbf5c
.set c896_525, 0xbf5c
.set c896_526, 0xbf5b
.set c896_527, 0xbf5a
.set c896_528, 0xbf59
.set c896_529, 0xbf58
.set c896_530, 0xbf57
.set c896_531, 0xbf56
.set c896_532, 0xbf55
.set c896_533, 0xbf54
.set c896_534, 0xbf53
.set c896_535, 0xbf52
.set c896_536, 0xbf51
.set c896_537, 0xbf50
.set c896_538, 0xbf4f
.set c896_539, 0xbf4e
.set c896_540, 0xbf4d
.set c896_541, 0xbf4b
.set c896_542, 0xbf4a
.set c896_543, 0xbf49
.set c896_544, 0xbf48
.set c896_545, 0xbf47
.set c896_546, 0xbf46
.set c896_547, 0xbf45
.set c896_548, 0xbf44
.set c896_549, 0xbf42
.set c896_550, 0xbf41
.set c896_551, 0xbf40
.set c896_552, 0xbf3f
.set c896_553, 0xbf3e
.set c896_554, 0xbf3c
.set c896_555, 0xbf3b
.set c896_556, 0xbf3a
.set c896_557, 0xbf39
.set c896_558, 0xbf38
.set c896_559, 0xbf36
.set c896_560, 0xbf35
.set c896_561, 0xbf34
.set c896_562, 0xbf32
.set c896_563, 0xbf31
.set c896_564, 0xbf30
.set c896_565, 0xbf2f
.set c896_566, 0xbf2d
.set c896_567, 0xbf2c
.set c896_568, 0xbf2b
.set c896_569, 0xbf29
.set c896_570, 0xbf28
.set c896_571, 0xbf27
.set c896_572, 0xbf25
.set c896_573, 0xbf24
.set c896_574, 0xbf22
.set c896_575, 0xbf21
.set c896_576, 0xbf20
.set c896_577, 0xbf1e
.set c896_578, 0xbf1d
.set c896_579, 0xbf1b
.set c896_580, 0xbf1a
.set c896_581, 0xbf18
.set c896_582, 0xbf17
.set c896_583, 0xbf16
.set c896_584, 0xbf14
.set c896_585, 0xbf13
.set c896_586, 0xbf11
.set c896_587, 0xbf10
.set c896_588, 0xbf0e
.set c896_589, 0xbf0d
.set c896_590, 0xbf0b
.set c896_591, 0xbf0a
.set c896_592, 0xbf08
.set c896_593, 0xbf07
.set c896_594, 0xbf05
.set c896_595, 0xbf04
.set c896_596, 0xbf02
.set c896_597, 0xbf01
.set c896_598, 0xbefe
.set c896_599, 0xbefb
.set c896_600, 0xbef8
.set c896_601, 0xbef5
.set c896_602, 0xbef1
.set c896_603, 0xbeee
.set c896_604, 0xbeeb
.set c896_605, 0xbee8
.set c896_606, 0xbee5
.set c896_607, 0xbee1
.set c896_608, 0xbede
.set c896_609, 0xbedb
.set c896_610, 0xbed8
.set c896_611, 0xbed4
.set c896_612, 0xbed1
.set c896_613, 0xbece
.set c896_614, 0xbecb
.set c896_615, 0xbec7
.set c896_616, 0xbec4
.set c896_617, 0xbec1
.set c896_618, 0xbebd
.set c896_619, 0xbeba
.set c896_620, 0xbeb7
.set c896_621, 0xbeb3
.set c896_622, 0xbeb0
.set c896_623, 0xbeac
.set c896_624, 0xbea9
.set c896_625, 0xbea6
.set c896_626, 0xbea2
.set c896_627, 0xbe9f
.set c896_628, 0xbe9b
.set c896_629, 0xbe98
.set c896_630, 0xbe95
.set c896_631, 0xbe91
.set c896_632, 0xbe8e
.set c896_633, 0xbe8a
.set c896_634, 0xbe87
.set c896_635, 0xbe83
.set c896_636, 0xbe80
.set c896_637, 0xbe79
.set c896_638, 0xbe72
.set c896_639, 0xbe6b
.set c896_640, 0xbe64
.set c896_641, 0xbe5d
.set c896_642, 0xbe56
.set c896_643, 0xbe4f
.set c896_644, 0xbe48
.set c896_645, 0xbe41
.set c896_646, 0xbe3a
.set c896_647, 0xbe33
.set c896_648, 0xbe2c
.set c896_649, 0xbe24
.set c896_650, 0xbe1d
.set c896_651, 0xbe16
.set c896_652, 0xbe0f
.set c896_653, 0xbe08
.set c896_654, 0xbe01
.set c896_655, 0xbdf4
.set c896_656, 0xbde5
.set c896_657, 0xbdd7
.set c896_658, 0xbdc9
.set c896_659, 0xbdba
.set c896_660, 0xbdac
.set c896_661, 0xbd9e
.set c896_662, 0xbd8f
.set c896_663, 0xbd81
.set c896_664, 0xbd66
.set c896_665, 0xbd49
.set c896_666, 0xbd2c
.set c896_667, 0xbd10
.set c896_668, 0xbce6
.set c896_669, 0xbcac
.set c896_670, 0xbc66
.set c896_671, 0xbbe6
.set c896_672, 0x0000
.set c896_673, 0x3be6
.set c896_674, 0x3c66
.set c896_675, 0x3cac
.set c896_676, 0x3ce6
.set c896_677, 0x3d10
.set c896_678, 0x3d2c
.set c896_679, 0x3d49
.set c896_680, 0x3d66
.set c896_681, 0x3d81
.set c896_682, 0x3d8f
.set c896_683, 0x3d9e
.set c896_684, 0x3dac
.set c896_685, 0x3dba
.set c896_686, 0x3dc9
.set c896_687, 0x3dd7
.set c896_688, 0x3de5
.set c896_689, 0x3df4
.set c896_690, 0x3e01
.set c896_691, 0x3e08
.set c896_692, 0x3e0f
.set c896_693, 0x3e16
.set c896_694, 0x3e1d
.set c896_695, 0x3e24
.set c896_696, 0x3e2c
.set c896_697, 0x3e33
.set c896_698, 0x3e3a
.set c896_699, 0x3e41
.set c896_700, 0x3e48
.set c896_701, 0x3e4f
.set c896_702, 0x3e56
.set c896_703, 0x3e5d
.set c896_704, 0x3e64
.set c896_705, 0x3e6b
.set c896_706, 0x3e72
.set c896_707, 0x3e79
.set c896_708, 0x3e80
.set c896_709, 0x3e83
.set c896_710, 0x3e87
.set c896_711, 0x3e8a
.set c896_712, 0x3e8e
.set c896_713, 0x3e91
.set c896_714, 0x3e95
.set c896_715, 0x3e98
.set c896_716, 0x3e9b
.set c896_717, 0x3e9f
.set c896_718, 0x3ea2
.set c896_719, 0x3ea6
.set c896_720, 0x3ea9
.set c896_721, 0x3eac
.set c896_722, 0x3eb0
.set c896_723, 0x3eb3
.set c896_724, 0x3eb7
.set c896_725, 0x3eba
.set c896_726, 0x3ebd
.set c896_727, 0x3ec1
.set c896_728, 0x3ec4
.set c896_729, 0x3ec7
.set c896_730, 0x3ecb
.set c896_731, 0x3ece
.set c896_732, 0x3ed1
.set c896_733, 0x3ed4
.set c896_734, 0x3ed8
.set c896_735, 0x3edb
.set c896_736, 0x3ede
.set c896_737, 0x3ee1
.set c896_738, 0x3ee5
.set c896_739, 0x3ee8
.set c896_740, 0x3eeb
.set c896_741, 0x3eee
.set c896_742, 0x3ef1
.set c896_743, 0x3ef5
.set c896_744, 0x3ef8
.set c896_745, 0x3efb
.set c896_746, 0x3efe
.set c896_747, 0x3f01
.set c896_748, 0x3f02
.set c896_749, 0x3f04
.set c896_750, 0x3f05
.set c896_751, 0x3f07
.set c896_752, 0x3f08
.set c896_753, 0x3f0a
.set c896_754, 0x3f0b
.set c896_755, 0x3f0d
.set c896_756, 0x3f0e
.set c896_757, 0x3f10
.set c896_758, 0x3f11
.set c896_759, 0x3f13
.set c896_760, 0x3f14
.set c896_761, 0x3f16
.set c896_762, 0x3f17
.set c896_763, 0x3f18
.set c896_764, 0x3f1a
.set c896_765, 0x3f1b
.set c896_766, 0x3f1d
.set c896_767, 0x3f1e
.set c896_768, 0x3f20
.set c896_769, 0x3f21
.set c896_770, 0x3f22
.set c896_771, 0x3f24
.set c896_772, 0x3f25
.set c896_773, 0x3f27
.set c896_774, 0x3f28
.set c896_775, 0x3f29
.set c896_776, 0x3f2b
.set c896_777, 0x3f2c
.set c896_778, 0x3f2d
.set c896_779, 0x3f2f
.set c896_780, 0x3f30
.set c896_781, 0x3f31
.set c896_782, 0x3f32
.set c896_783, 0x3f34
.set c896_784, 0x3f35
.set c896_785, 0x3f36
.set c896_786, 0x3f38
.set c896_787, 0x3f39
.set c896_788, 0x3f3a
.set c896_789, 0x3f3b
.set c896_790, 0x3f3c
.set c896_791, 0x3f3e
.set c896_792, 0x3f3f
.set c896_793, 0x3f40
.set c896_794, 0x3f41
.set c896_795, 0x3f42
.set c896_796, 0x3f44
.set c896_797, 0x3f45
.set c896_798, 0x3f46
.set c896_799, 0x3f47
.set c896_800, 0x3f48
.set c896_801, 0x3f49
.set c896_802, 0x3f4a
.set c896_803, 0x3f4b
.set c896_804, 0x3f4d
.set c896_805, 0x3f4e
.set c896_806, 0x3f4f
.set c896_807, 0x3f50
.set c896_808, 0x3f51
.set c896_809, 0x3f52
.set c896_810, 0x3f53
.set c896_811, 0x3f54
.set c896_812, 0x3f55
.set c896_813, 0x3f56
.set c896_814, 0x3f57
.set c896_815, 0x3f58
.set c896_816, 0x3f59
.set c896_817, 0x3f5a
.set c896_818, 0x3f5b
.set c896_819, 0x3f5c
.set c896_820, 0x3f5c
.set c896_821, 0x3f5d
.set c896_822, 0x3f5e
.set c896_823, 0x3f5f
.set c896_824, 0x3f60
.set c896_825, 0x3f61
.set c896_826, 0x3f62
.set c896_827, 0x3f63
.set c896_828, 0x3f63
.set c896_829, 0x3f64
.set c896_830, 0x3f65
.set c896_831, 0x3f66
.set c896_832, 0x3f67
.set c896_833, 0x3f67
.set c896_834, 0x3f68
.set c896_835, 0x3f69
.set c896_836, 0x3f6a
.set c896_837, 0x3f6a
.set c896_838, 0x3f6b
.set c896_839, 0x3f6c
.set c896_840, 0x3f6d
.set c896_841, 0x3f6d
.set c896_842, 0x3f6e
.set c896_843, 0x3f6f
.set c896_844, 0x3f6f
.set c896_845, 0x3f70
.set c896_846, 0x3f70
.set c896_847, 0x3f71
.set c896_848, 0x3f72
.set c896_849, 0x3f72
.set c896_850, 0x3f73
.set c896_851, 0x3f73
.set c896_852, 0x3f74
.set c896_853, 0x3f74
.set c896_854, 0x3f75
.set c896_855, 0x3f75
.set c896_856, 0x3f76
.set c896_857, 0x3f76
.set c896_858, 0x3f77
.set c896_859, 0x3f77
.set c896_860, 0x3f78
.set c896_861, 0x3f78
.set c896_862, 0x3f79
.set c896_863, 0x3f79
.set c896_864, 0x3f7a
.set c896_865, 0x3f7a
.set c896_866, 0x3f7a
.set c896_867, 0x3f7b
.set c896_868, 0x3f7b
.set c896_869, 0x3f7b
.set c896_870, 0x3f7c
.set c896_871, 0x3f7c
.set c896_872, 0x3f7c
.set c896_873, 0x3f7d
.set c896_874, 0x3f7d
.set c896_875, 0x3f7d
.set c896_876, 0x3f7d
.set c896_877, 0x3f7e
.set c896_878, 0x3f7e
.set c896_879, 0x3f7e
.set c896_880, 0x3f7e
.set c896_881, 0x3f7f
.set c896_882, 0x3f7f
.set c896_883, 0x3f7f
.set c896_884, 0x3f7f
.set c896_885, 0x3f7f
.set c896_886, 0x3f7f
.set c896_887, 0x3f7f
.set c896_888, 0x3f80
.set c896_889, 0x3f80
.set c896_890, 0x3f80
.set c896_891, 0x3f80
.set c896_892, 0x3f80
.set c896_893, 0x3f80
.set c896_894, 0x3f80
.set c896_895, 0x3f80
.set c896_896, 0
.set c896_897, 0x3f00
.set c896_898, 0xbf00
.altmacro
.macro e4q QA,QB,QC,QD
.quad c896_\QA | (c896_\QB << 16) | (c896_\QC << 32) | (c896_\QD << 48)
.endm
.macro frow K0,N,Q0,DQ,PH
.set qk, \K0
.rept \N
e4q %((qk*(\Q0)+\PH)%896), %((qk*(\Q0+\DQ)+\PH)%896), %((qk*(\Q0+2*(\DQ))+\PH)%896), %((qk*(\Q0+3*(\DQ))+\PH)%896)
e4q %((qk*(\Q0+4*(\DQ))+\PH)%896), %((qk*(\Q0+5*(\DQ))+\PH)%896), %((qk*(\Q0+6*(\DQ))+\PH)%896), %((qk*(\Q0+7*(\DQ))+\PH)%896)
.set qk, qk+1
.endr
.endm
.p2align 8
tabF:
e4q 897,897,897,897
e4q 897,897,897,897
frow 1,31,447,-2,0
e4q 897,897,897,897
e4q 897,897,897,897
frow 1,31,431,-2,0
frow 0,32,447,-2,224
frow 0,32,431,-2,224
e4q 897,897,897,897
e4q 897,897,897,897
frow 1,31,415,-2,0
e4q 897,897,897,897
e4q 897,897,897,897
frow 1,31,399,-2,0
frow 0,32,415,-2,224
frow 0,32,399,-2,224
e4q 897,897,897,897
e4q 897,897,897,897
frow 1,31,383,-2,0
e4q 897,897,897,897
e4q 897,897,897,897
frow 1,31,367,-2,0
frow 0,32,383,-2,224
frow 0,32,367,-2,224
e4q 897,897,897,897
e4q 897,897,897,897
frow 1,31,351,-2,0
e4q 897,897,897,897
e4q 897,897,897,897
frow 1,31,335,-2,0
frow 0,32,351,-2,224
frow 0,32,335,-2,224
e4q 897,897,897,897
e4q 897,897,897,897
frow 1,31,319,-2,0
e4q 897,897,897,897
e4q 897,897,897,897
frow 1,31,303,-2,0
frow 0,32,319,-2,224
frow 0,32,303,-2,224
e4q 897,897,897,897
e4q 897,897,897,897
frow 1,31,287,-2,0
e4q 897,897,897,897
e4q 897,897,897,897
frow 1,31,271,-2,0
frow 0,32,287,-2,224
frow 0,32,271,-2,224
e4q 897,897,897,897
e4q 897,897,897,897
frow 1,31,255,-2,0
e4q 897,897,897,897
e4q 897,897,897,897
frow 1,31,239,-2,0
frow 0,32,255,-2,224
frow 0,32,239,-2,224
e4q 897,897,897,897
e4q 897,897,897,897
frow 1,31,223,-2,0
e4q 897,897,897,897
e4q 897,897,897,897
frow 1,31,207,-2,0
frow 0,32,223,-2,224
frow 0,32,207,-2,224
e4q 897,897,897,897
e4q 897,897,897,897
frow 1,31,191,-2,0
e4q 897,897,897,897
e4q 897,897,897,897
frow 1,31,175,-2,0
frow 0,32,191,-2,224
frow 0,32,175,-2,224
e4q 897,897,897,897
e4q 897,897,897,897
frow 1,31,159,-2,0
e4q 897,897,897,897
e4q 897,897,897,897
frow 1,31,143,-2,0
frow 0,32,159,-2,224
frow 0,32,143,-2,224
e4q 897,897,897,897
e4q 897,897,897,897
frow 1,31,127,-2,0
e4q 897,897,897,897
e4q 897,897,897,897
frow 1,31,111,-2,0
frow 0,32,127,-2,224
frow 0,32,111,-2,224
e4q 897,897,897,897
e4q 897,897,897,897
frow 1,31,95,-2,0
e4q 897,897,897,897
e4q 897,897,897,897
frow 1,31,79,-2,0
frow 0,32,95,-2,224
frow 0,32,79,-2,224
e4q 897,897,897,897
e4q 897,897,897,897
frow 1,31,63,-2,0
e4q 897,897,897,897
e4q 897,897,897,897
frow 1,31,47,-2,0
frow 0,32,1,2,224
frow 0,32,17,2,224
e4q 897,897,897,897
e4q 897,897,897,897
frow 1,31,31,-2,0
e4q 897,897,897,897
e4q 897,897,897,897
frow 1,31,15,-2,0
frow 0,32,33,2,224
frow 0,32,49,2,224
frow 32,32,447,-2,0
frow 32,32,431,-2,0
frow 32,32,447,-2,224
frow 32,32,431,-2,224
frow 32,32,415,-2,0
frow 32,32,399,-2,0
frow 32,32,415,-2,224
frow 32,32,399,-2,224
frow 32,32,383,-2,0
frow 32,32,367,-2,0
frow 32,32,383,-2,224
frow 32,32,367,-2,224
frow 32,32,351,-2,0
frow 32,32,335,-2,0
frow 32,32,351,-2,224
frow 32,32,335,-2,224
frow 32,32,319,-2,0
frow 32,32,303,-2,0
frow 32,32,319,-2,224
frow 32,32,303,-2,224
frow 32,32,287,-2,0
frow 32,32,271,-2,0
frow 32,32,287,-2,224
frow 32,32,271,-2,224
frow 32,32,255,-2,0
frow 32,32,239,-2,0
frow 32,32,255,-2,224
frow 32,32,239,-2,224
frow 32,32,223,-2,0
frow 32,32,207,-2,0
frow 32,32,223,-2,224
frow 32,32,207,-2,224
frow 32,32,191,-2,0
frow 32,32,175,-2,0
frow 32,32,191,-2,224
frow 32,32,175,-2,224
frow 32,32,159,-2,0
frow 32,32,143,-2,0
frow 32,32,159,-2,224
frow 32,32,143,-2,224
frow 32,32,127,-2,0
frow 32,32,111,-2,0
frow 32,32,127,-2,224
frow 32,32,111,-2,224
frow 32,32,95,-2,0
frow 32,32,79,-2,0
frow 32,32,95,-2,224
frow 32,32,79,-2,224
frow 32,32,63,-2,0
frow 32,32,47,-2,0
frow 32,32,1,2,224
frow 32,32,17,2,224
frow 32,32,31,-2,0
frow 32,32,15,-2,0
frow 32,32,33,2,224
frow 32,32,49,2,224
frow 64,32,447,-2,0
frow 64,32,431,-2,0
frow 64,32,447,-2,224
frow 64,32,431,-2,224
frow 64,32,415,-2,0
frow 64,32,399,-2,0
frow 64,32,415,-2,224
frow 64,32,399,-2,224
frow 64,32,383,-2,0
frow 64,32,367,-2,0
frow 64,32,383,-2,224
frow 64,32,367,-2,224
frow 64,32,351,-2,0
frow 64,32,335,-2,0
frow 64,32,351,-2,224
frow 64,32,335,-2,224
frow 64,32,319,-2,0
frow 64,32,303,-2,0
frow 64,32,319,-2,224
frow 64,32,303,-2,224
frow 64,32,287,-2,0
frow 64,32,271,-2,0
frow 64,32,287,-2,224
frow 64,32,271,-2,224
frow 64,32,255,-2,0
frow 64,32,239,-2,0
frow 64,32,255,-2,224
frow 64,32,239,-2,224
frow 64,32,223,-2,0
frow 64,32,207,-2,0
frow 64,32,223,-2,224
frow 64,32,207,-2,224
frow 64,32,191,-2,0
frow 64,32,175,-2,0
frow 64,32,191,-2,224
frow 64,32,175,-2,224
frow 64,32,159,-2,0
frow 64,32,143,-2,0
frow 64,32,159,-2,224
frow 64,32,143,-2,224
frow 64,32,127,-2,0
frow 64,32,111,-2,0
frow 64,32,127,-2,224
frow 64,32,111,-2,224
frow 64,32,95,-2,0
frow 64,32,79,-2,0
frow 64,32,95,-2,224
frow 64,32,79,-2,224
frow 64,32,63,-2,0
frow 64,32,47,-2,0
frow 64,32,1,2,224
frow 64,32,17,2,224
frow 64,32,31,-2,0
frow 64,32,15,-2,0
frow 64,32,33,2,224
frow 64,32,49,2,224
frow 96,16,447,-2,0
.zero 256
frow 96,16,431,-2,0
.zero 256
frow 96,16,447,-2,224
.zero 256
frow 96,16,431,-2,224
.zero 256
frow 96,16,415,-2,0
.zero 256
frow 96,16,399,-2,0
.zero 256
frow 96,16,415,-2,224
.zero 256
frow 96,16,399,-2,224
.zero 256
frow 96,16,383,-2,0
.zero 256
frow 96,16,367,-2,0
.zero 256
frow 96,16,383,-2,224
.zero 256
frow 96,16,367,-2,224
.zero 256
frow 96,16,351,-2,0
.zero 256
frow 96,16,335,-2,0
.zero 256
frow 96,16,351,-2,224
.zero 256
frow 96,16,335,-2,224
.zero 256
frow 96,16,319,-2,0
.zero 256
frow 96,16,303,-2,0
.zero 256
frow 96,16,319,-2,224
.zero 256
frow 96,16,303,-2,224
.zero 256
frow 96,16,287,-2,0
.zero 256
frow 96,16,271,-2,0
.zero 256
frow 96,16,287,-2,224
.zero 256
frow 96,16,271,-2,224
.zero 256
frow 96,16,255,-2,0
.zero 256
frow 96,16,239,-2,0
.zero 256
frow 96,16,255,-2,224
.zero 256
frow 96,16,239,-2,224
.zero 256
frow 96,16,223,-2,0
.zero 256
frow 96,16,207,-2,0
.zero 256
frow 96,16,223,-2,224
.zero 256
frow 96,16,207,-2,224
.zero 256
frow 96,16,191,-2,0
.zero 256
frow 96,16,175,-2,0
.zero 256
frow 96,16,191,-2,224
.zero 256
frow 96,16,175,-2,224
.zero 256
frow 96,16,159,-2,0
.zero 256
frow 96,16,143,-2,0
.zero 256
frow 96,16,159,-2,224
.zero 256
frow 96,16,143,-2,224
.zero 256
frow 96,16,127,-2,0
.zero 256
frow 96,16,111,-2,0
.zero 256
frow 96,16,127,-2,224
.zero 256
frow 96,16,111,-2,224
.zero 256
frow 96,16,95,-2,0
.zero 256
frow 96,16,79,-2,0
.zero 256
frow 96,16,95,-2,224
.zero 256
frow 96,16,79,-2,224
.zero 256
frow 96,16,63,-2,0
.zero 256
frow 96,16,47,-2,0
.zero 256
frow 96,16,1,2,224
.zero 256
frow 96,16,17,2,224
.zero 256
frow 96,16,31,-2,0
.zero 256
frow 96,16,15,-2,0
.zero 256
frow 96,16,33,2,224
.zero 256
frow 96,16,49,2,224
.zero 256
frow 112,32,447,-2,0
frow 112,32,431,-2,0
frow 112,32,447,-2,224
frow 112,32,431,-2,224
frow 112,32,415,-2,0
frow 112,32,399,-2,0
frow 112,32,415,-2,224
frow 112,32,399,-2,224
frow 112,32,383,-2,0
frow 112,32,367,-2,0
frow 112,32,383,-2,224
frow 112,32,367,-2,224
frow 112,32,351,-2,0
frow 112,32,335,-2,0
frow 112,32,351,-2,224
frow 112,32,335,-2,224
frow 112,32,319,-2,0
frow 112,32,303,-2,0
frow 112,32,319,-2,224
frow 112,32,303,-2,224
frow 112,32,287,-2,0
frow 112,32,271,-2,0
frow 112,32,287,-2,224
frow 112,32,271,-2,224
frow 112,32,255,-2,0
frow 112,32,239,-2,0
frow 112,32,255,-2,224
frow 112,32,239,-2,224
frow 112,32,223,-2,0
frow 112,32,207,-2,0
frow 112,32,223,-2,224
frow 112,32,207,-2,224
frow 112,32,191,-2,0
frow 112,32,175,-2,0
frow 112,32,191,-2,224
frow 112,32,175,-2,224
frow 112,32,159,-2,0
frow 112,32,143,-2,0
frow 112,32,159,-2,224
frow 112,32,143,-2,224
frow 112,32,127,-2,0
frow 112,32,111,-2,0
frow 112,32,127,-2,224
frow 112,32,111,-2,224
frow 112,32,95,-2,0
frow 112,32,79,-2,0
frow 112,32,95,-2,224
frow 112,32,79,-2,224
frow 112,32,63,-2,0
frow 112,32,47,-2,0
frow 112,32,1,2,224
frow 112,32,17,2,224
frow 112,32,31,-2,0
frow 112,32,15,-2,0
frow 112,32,33,2,224
frow 112,32,49,2,224
frow 144,32,447,-2,0
frow 144,32,431,-2,0
frow 144,32,447,-2,224
frow 144,32,431,-2,224
frow 144,32,415,-2,0
frow 144,32,399,-2,0
frow 144,32,415,-2,224
frow 144,32,399,-2,224
frow 144,32,383,-2,0
frow 144,32,367,-2,0
frow 144,32,383,-2,224
frow 144,32,367,-2,224
frow 144,32,351,-2,0
frow 144,32,335,-2,0
frow 144,32,351,-2,224
frow 144,32,335,-2,224
frow 144,32,319,-2,0
frow 144,32,303,-2,0
frow 144,32,319,-2,224
frow 144,32,303,-2,224
frow 144,32,287,-2,0
frow 144,32,271,-2,0
frow 144,32,287,-2,224
frow 144,32,271,-2,224
frow 144,32,255,-2,0
frow 144,32,239,-2,0
frow 144,32,255,-2,224
frow 144,32,239,-2,224
frow 144,32,223,-2,0
frow 144,32,207,-2,0
frow 144,32,223,-2,224
frow 144,32,207,-2,224
frow 144,32,191,-2,0
frow 144,32,175,-2,0
frow 144,32,191,-2,224
frow 144,32,175,-2,224
frow 144,32,159,-2,0
frow 144,32,143,-2,0
frow 144,32,159,-2,224
frow 144,32,143,-2,224
frow 144,32,127,-2,0
frow 144,32,111,-2,0
frow 144,32,127,-2,224
frow 144,32,111,-2,224
frow 144,32,95,-2,0
frow 144,32,79,-2,0
frow 144,32,95,-2,224
frow 144,32,79,-2,224
frow 144,32,63,-2,0
frow 144,32,47,-2,0
frow 144,32,1,2,224
frow 144,32,17,2,224
frow 144,32,31,-2,0
frow 144,32,15,-2,0
frow 144,32,33,2,224
frow 144,32,49,2,224
frow 176,32,447,-2,0
frow 176,32,431,-2,0
frow 176,32,447,-2,224
frow 176,32,431,-2,224
frow 176,32,415,-2,0
frow 176,32,399,-2,0
frow 176,32,415,-2,224
frow 176,32,399,-2,224
frow 176,32,383,-2,0
frow 176,32,367,-2,0
frow 176,32,383,-2,224
frow 176,32,367,-2,224
frow 176,32,351,-2,0
frow 176,32,335,-2,0
frow 176,32,351,-2,224
frow 176,32,335,-2,224
frow 176,32,319,-2,0
frow 176,32,303,-2,0
frow 176,32,319,-2,224
frow 176,32,303,-2,224
frow 176,32,287,-2,0
frow 176,32,271,-2,0
frow 176,32,287,-2,224
frow 176,32,271,-2,224
frow 176,32,255,-2,0
frow 176,32,239,-2,0
frow 176,32,255,-2,224
frow 176,32,239,-2,224
frow 176,32,223,-2,0
frow 176,32,207,-2,0
frow 176,32,223,-2,224
frow 176,32,207,-2,224
frow 176,32,191,-2,0
frow 176,32,175,-2,0
frow 176,32,191,-2,224
frow 176,32,175,-2,224
frow 176,32,159,-2,0
frow 176,32,143,-2,0
frow 176,32,159,-2,224
frow 176,32,143,-2,224
frow 176,32,127,-2,0
frow 176,32,111,-2,0
frow 176,32,127,-2,224
frow 176,32,111,-2,224
frow 176,32,95,-2,0
frow 176,32,79,-2,0
frow 176,32,95,-2,224
frow 176,32,79,-2,224
frow 176,32,63,-2,0
frow 176,32,47,-2,0
frow 176,32,1,2,224
frow 176,32,17,2,224
frow 176,32,31,-2,0
frow 176,32,15,-2,0
frow 176,32,33,2,224
frow 176,32,49,2,224
frow 208,16,447,-2,0
.zero 256
frow 208,16,431,-2,0
.zero 256
frow 208,16,447,-2,224
e4q 897,898,897,898
e4q 897,898,897,898
.zero 240
frow 208,16,431,-2,224
e4q 897,898,897,898
e4q 897,898,897,898
.zero 240
frow 208,16,415,-2,0
.zero 256
frow 208,16,399,-2,0
.zero 256
frow 208,16,415,-2,224
e4q 897,898,897,898
e4q 897,898,897,898
.zero 240
frow 208,16,399,-2,224
e4q 897,898,897,898
e4q 897,898,897,898
.zero 240
frow 208,16,383,-2,0
.zero 256
frow 208,16,367,-2,0
.zero 256
frow 208,16,383,-2,224
e4q 897,898,897,898
e4q 897,898,897,898
.zero 240
frow 208,16,367,-2,224
e4q 897,898,897,898
e4q 897,898,897,898
.zero 240
frow 208,16,351,-2,0
.zero 256
frow 208,16,335,-2,0
.zero 256
frow 208,16,351,-2,224
e4q 897,898,897,898
e4q 897,898,897,898
.zero 240
frow 208,16,335,-2,224
e4q 897,898,897,898
e4q 897,898,897,898
.zero 240
frow 208,16,319,-2,0
.zero 256
frow 208,16,303,-2,0
.zero 256
frow 208,16,319,-2,224
e4q 897,898,897,898
e4q 897,898,897,898
.zero 240
frow 208,16,303,-2,224
e4q 897,898,897,898
e4q 897,898,897,898
.zero 240
frow 208,16,287,-2,0
.zero 256
frow 208,16,271,-2,0
.zero 256
frow 208,16,287,-2,224
e4q 897,898,897,898
e4q 897,898,897,898
.zero 240
frow 208,16,271,-2,224
e4q 897,898,897,898
e4q 897,898,897,898
.zero 240
frow 208,16,255,-2,0
.zero 256
frow 208,16,239,-2,0
.zero 256
frow 208,16,255,-2,224
e4q 897,898,897,898
e4q 897,898,897,898
.zero 240
frow 208,16,239,-2,224
e4q 897,898,897,898
e4q 897,898,897,898
.zero 240
frow 208,16,223,-2,0
.zero 256
frow 208,16,207,-2,0
.zero 256
frow 208,16,223,-2,224
e4q 897,898,897,898
e4q 897,898,897,898
.zero 240
frow 208,16,207,-2,224
e4q 897,898,897,898
e4q 897,898,897,898
.zero 240
frow 208,16,191,-2,0
.zero 256
frow 208,16,175,-2,0
.zero 256
frow 208,16,191,-2,224
e4q 897,898,897,898
e4q 897,898,897,898
.zero 240
frow 208,16,175,-2,224
e4q 897,898,897,898
e4q 897,898,897,898
.zero 240
frow 208,16,159,-2,0
.zero 256
frow 208,16,143,-2,0
.zero 256
frow 208,16,159,-2,224
e4q 897,898,897,898
e4q 897,898,897,898
.zero 240
frow 208,16,143,-2,224
e4q 897,898,897,898
e4q 897,898,897,898
.zero 240
frow 208,16,127,-2,0
.zero 256
frow 208,16,111,-2,0
.zero 256
frow 208,16,127,-2,224
e4q 897,898,897,898
e4q 897,898,897,898
.zero 240
frow 208,16,111,-2,224
e4q 897,898,897,898
e4q 897,898,897,898
.zero 240
frow 208,16,95,-2,0
.zero 256
frow 208,16,79,-2,0
.zero 256
frow 208,16,95,-2,224
e4q 897,898,897,898
e4q 897,898,897,898
.zero 240
frow 208,16,79,-2,224
e4q 897,898,897,898
e4q 897,898,897,898
.zero 240
frow 208,16,63,-2,0
.zero 256
frow 208,16,47,-2,0
.zero 256
frow 208,16,1,2,224
e4q 898,897,898,897
e4q 898,897,898,897
.zero 240
frow 208,16,17,2,224
e4q 898,897,898,897
e4q 898,897,898,897
.zero 240
frow 208,16,31,-2,0
.zero 256
frow 208,16,15,-2,0
.zero 256
frow 208,16,33,2,224
e4q 898,897,898,897
e4q 898,897,898,897
.zero 240
frow 208,16,49,2,224
e4q 898,897,898,897
e4q 898,897,898,897
.zero 240
.noaltmacro
```
